```python
import torch

def _softmax(x, axis=-1):
    return torch.softmax(x, dim=axis)
def _gelu(x):
    return torch.nn.functional.gelu(x, approximate="tanh")
def _silu(x):
    return torch.nn.functional.silu(x)
def _sigmoid(x):
    return torch.sigmoid(x)
def _layernorm(x, axis=-1, eps=1e-5):
    m = x.mean(dim=axis, keepdim=True)
    v = x.var(dim=axis, keepdim=True, unbiased=False)
    return (x - m) / torch.sqrt(v + eps)
def _scatter_add(tgt, idx, src, axis=0):
    return tgt.clone().index_add_(axis, idx, src)
def _segment_sum(src, seg, n):
    out = torch.zeros((n,) + src.shape[1:], dtype=src.dtype)
    return out.index_add_(0, seg, src)
def _pad(x, pw):
    flat = tuple(v for pair in reversed(pw) for v in pair)
    return torch.nn.functional.pad(x, flat)

kernel_name = 'standalone__gqa_block_cached__sampling'

def setup_inputs():

    _w = (lambda a: (lambda t: t.to(torch.bfloat16) if t.is_floating_point() else t)(torch.as_tensor(a)))
    B, Sq, D = 32, 16, 512
    Hq, Hkv, Sk, Dh = 32, 8, 2048, 128
    assert Hq % Hkv == 0, (Hq, Hkv)
    return {
        "x": _w((lambda *s: torch.randn(*s, dtype=torch.bfloat16) * 0.8)(B, Sq, D)),
        "k_cache": _w((lambda *s: torch.randn(*s, dtype=torch.bfloat16) * 0.8)(B, Hkv, Sk, Dh)),
        "v_cache": _w((lambda *s: torch.randn(*s, dtype=torch.bfloat16) * 0.05)(B, Hkv, Sk, Dh)),
        "wq": _w((lambda *s: torch.randn(*s, dtype=torch.bfloat16) * 0.8)(D, Hq * Dh) * (D ** -0.5)),
        "wo": _w((lambda *s: torch.randn(*s, dtype=torch.bfloat16) * 0.05)(Hq * Dh, D) * ((Hq * Dh) ** -0.5)),
    }

def reference(x, k_cache, v_cache, wq, wo):
    B, Sq, D = x.shape
    Hq, Dh = 32, 128
    Hkv = k_cache.shape[1]
    rep = Hq // Hkv
    q = (lambda x, *d: x.permute(*d))((x @ wq).reshape(B, Sq, Hq, Dh), 0, 2, 1, 3)
    k = (lambda x, n, axis: torch.repeat_interleave(x, n, dim=axis))(k_cache, rep, axis=1)
    v = (lambda x, n, axis: torch.repeat_interleave(x, n, dim=axis))(v_cache, rep, axis=1)
    scores = torch.einsum("bhqd,bhkd->bhqk", q, k) * (Dh ** -0.5)
    p = _softmax(scores, axis=-1)
    o = torch.einsum("bhqk,bhkd->bhqd", p, v)
    return (lambda x, *d: x.permute(*d))(o, 0, 2, 1, 3).reshape(B, Sq, Hq * Dh) @ wo
```

```asm
; @launch grid=(256,1,1) block=(512,1,1) lds=163840
.amdgcn_target "amdgcn-amd-amdhsa--gfx950"
.text
.globl standalone__gqa_block_cached__sampling_kernel
.p2align 8
.type standalone__gqa_block_cached__sampling_kernel,@function
standalone__gqa_block_cached__sampling_kernel:
  s_cmp_ge_u32 s2, 256
  s_cbranch_scc1 L_end
  s_load_dwordx16 s[4:19], s[0:1], 0
  s_memrealtime s[92:93]
  v_lshrrev_b32 v1, 6, v0
  v_and_b32 v0, 63, v0
  v_readfirstlane_b32 s3, v1
  s_lshr_b32 s32, s2, 3
  s_and_b32 s33, s2, 7
  v_lshrrev_b32 v1, 4, v0
  v_and_b32 v2, 15, v0
  s_cmp_ge_u32 s3, 4
  s_cbranch_scc1 L_loader
  s_lshl_b32 s34, s3, 2
  s_add_u32 s34, s34, 163824
  v_mov_b32 v137, s34
  v_mov_b32 v3, 0
  ds_write_b32 v137, v3
  v_mov_b32 v136, 163808
  s_lshr_b32 s50, s32, 1
  s_lshl_b32 s86, s50, 3
  s_add_u32 s86, s86, s33
  s_bitcmp1_b32 s32, 0
  s_cbranch_scc1 L_codd
  v_lshlrev_b32 v14, 4, v0
  s_lshl_b32 s34, s3, 6
  v_xor_b32 v14, s34, v14
  v_xor_b32 v15, 16, v14
  v_xor_b32 v16, 32, v14
  v_xor_b32 v17, 48, v14
  v_lshlrev_b32 v132, 4, v2
  v_lshl_add_u32 v84, v1, 16, v132
  v_add_u32 v85, 8192, v84
  v_add_u32 v86, 16384, v84
  v_add_u32 v87, 24576, v84
  v_add_u32 v88, 32768, v84
  v_add_u32 v89, 40960, v84
  v_add_u32 v90, 49152, v84
  v_add_u32 v91, 57344, v84
  s_lshl_b32 s34, s33, 2
  s_add_u32 s34, s34, s3
  s_lshl_b32 s34, s34, 8
  s_lshl_b32 s35, s32, 14
  s_lshl_b32 s36, s3, 12
  s_add_u32 m0, s36, 131072
  s_add_u32 s37, s36, 16384
  s_lshl_b32 s48, s50, 6
  s_waitcnt lgkmcnt(0)
  s_add_u32 s20, s10, s34
  s_addc_u32 s21, s11, 0
  s_sub_u32 s22, 0x400000, s34
  s_mov_b32 s23, 0x20000
  s_add_u32 s24, s4, s35
  s_addc_u32 s25, s5, 0
  s_mov_b32 s26, 32768
  s_mov_b32 s27, 0x20000
  buffer_load_dwordx4 v14, s[24:27], s36 offen offset:0 lds
  buffer_load_dwordx4 v15, s[24:27], s36 offen offset:1024 lds
  buffer_load_dwordx4 v16, s[24:27], s36 offen offset:2048 lds
  buffer_load_dwordx4 v17, s[24:27], s36 offen offset:3072 lds
  s_add_u32 m0, s36, 114688
  s_nop 0
  buffer_load_dwordx4 v14, s[24:27], s37 offen offset:0 lds
  buffer_load_dwordx4 v15, s[24:27], s37 offen offset:1024 lds
  buffer_load_dwordx4 v16, s[24:27], s37 offen offset:2048 lds
  buffer_load_dwordx4 v17, s[24:27], s37 offen offset:3072 lds
  s_lshl_b32 s47, s50, 18
  s_add_u32 s50, s50, 1
  s_and_b32 s50, s50, 15
  buffer_load_dwordx4 v[52:55], v84, s[20:23], s47 offen
  buffer_load_dwordx4 v[56:59], v85, s[20:23], s47 offen
  buffer_load_dwordx4 v[60:63], v86, s[20:23], s47 offen
  buffer_load_dwordx4 v[64:67], v87, s[20:23], s47 offen
  buffer_load_dwordx4 v[68:71], v88, s[20:23], s47 offen
  buffer_load_dwordx4 v[72:75], v89, s[20:23], s47 offen
  buffer_load_dwordx4 v[76:79], v90, s[20:23], s47 offen
  buffer_load_dwordx4 v[80:83], v91, s[20:23], s47 offen
  s_lshl_b32 s47, s50, 18
  s_add_u32 s50, s50, 1
  s_and_b32 s50, s50, 15
  buffer_load_dwordx4 v[208:211], v84, s[20:23], s47 offen
  buffer_load_dwordx4 v[212:215], v85, s[20:23], s47 offen
  buffer_load_dwordx4 v[216:219], v86, s[20:23], s47 offen
  buffer_load_dwordx4 v[220:223], v87, s[20:23], s47 offen
  buffer_load_dwordx4 v[224:227], v88, s[20:23], s47 offen
  buffer_load_dwordx4 v[228:231], v89, s[20:23], s47 offen
  buffer_load_dwordx4 v[232:235], v90, s[20:23], s47 offen
  buffer_load_dwordx4 v[236:239], v91, s[20:23], s47 offen
  s_mov_b32 s44, 0x05040100
  s_mov_b32 s45, 0x07060302
  s_mov_b32 s46, 0x3e0293ee
  v_xor_b32 v132, v1, v2
  v_lshlrev_b32 v132, 4, v132
  v_lshl_add_u32 v132, v2, 10, v132
  v_add_u32 v12, 114688, v132
  v_lshrrev_b32 v132, 3, v2
  v_mul_u32_u24 v132, 12, v132
  v_and_b32 v133, 3, v2
  v_or_b32 v132, v132, v133
  v_lshlrev_b32 v133, 2, v1
  v_xor_b32 v132, v132, v133
  v_lshlrev_b32 v132, 4, v132
  v_lshl_add_u32 v108, v2, 8, v132
  v_xor_b32 v109, 16, v108
  v_xor_b32 v110, 32, v108
  v_xor_b32 v111, 48, v108
  v_lshrrev_b32 v132, 2, v0
  v_and_b32 v133, 7, v132
  v_lshlrev_b32 v133, 5, v133
  v_lshl_add_u32 v133, v132, 8, v133
  v_and_b32 v132, 3, v0
  v_lshl_add_u32 v112, v132, 3, v133
  v_xor_b32 v113, 32, v112
  v_xor_b32 v114, 64, v112
  v_xor_b32 v115, 96, v112
  v_xor_b32 v116, 128, v112
  v_xor_b32 v117, 160, v112
  v_xor_b32 v118, 192, v112
  v_xor_b32 v119, 224, v112
  s_mul_i32 s34, s32, 131072
  s_add_u32 s54, s18, s34
  s_addc_u32 s55, s19, 0
  s_mul_i32 s34, s32, 2048
  s_add_u32 s34, s34, 12582912
  s_add_u32 s56, s18, s34
  s_addc_u32 s57, s19, 0
  s_lshl_b32 s52, s3, 14
  s_add_u32 s52, s52, 65536
  s_lshl_b32 s34, s33, 19
  s_lshl_b32 s35, s3, 7
  s_add_u32 s34, s34, s35
  s_add_u32 s28, s12, s34
  s_addc_u32 s29, s13, 0
  s_sub_u32 s30, 0x80000, s35
  s_mov_b32 s31, 0x20000
  s_mov_b32 s61, 360448
  v_lshlrev_b32 v132, 1, v1
  v_and_b32 v133, 7, v0
  v_xor_b32 v132, v132, v133
  v_lshlrev_b32 v132, 4, v132
  v_lshrrev_b32 v133, 3, v0
  v_lshl_add_u32 v138, v133, 10, v132
  v_add_u32 v139, 7168, v138
  v_lshrrev_b32 v132, 2, v0
  v_bfe_u32 v133, v0, 3, 2
  v_lshlrev_b32 v133, 5, v133
  v_lshl_add_u32 v132, v132, 7, v133
  v_and_b32 v133, 3, v0
  v_lshl_add_u32 v132, v133, 3, v132
  v_add_u32 v140, s52, v132
  v_xor_b32 v141, 32, v140
  v_xor_b32 v142, 64, v140
  v_xor_b32 v143, 96, v140
  v_lshlrev_b32 v132, 4, v0
  v_add_u32 v1, 32768, v132
  v_mov_b32 v128, 0
  v_mov_b32 v129, 0
  v_mov_b32 v130, 0
  v_mov_b32 v131, 0
  s_mov_b32 s82, 0xff800000
  s_mov_b32 s83, 0xff800000
  s_lshl_b32 s34, s86, 14
  s_lshl_b32 s35, s3, 12
  s_add_u32 s34, s34, s35
  s_add_u32 s34, s34, 16777216
  s_add_u32 s88, s18, s34
  s_addc_u32 s89, s19, 0
  s_mul_i32 s34, s86, 128
  s_add_u32 s34, s34, 20971520
  s_add_u32 s90, s18, s34
  s_addc_u32 s91, s19, 0
  v_mov_b32 v8, 0
  v_mov_b32 v9, 0
  v_mov_b32 v10, 0
  v_mov_b32 v11, 0
  v_mov_b32 v92, 0
  v_mov_b32 v93, 0
  v_mov_b32 v94, 0
  v_mov_b32 v95, 0
  v_mov_b32 v96, 0
  v_mov_b32 v97, 0
  v_mov_b32 v98, 0
  v_mov_b32 v99, 0
  v_mov_b32 v100, 0
  v_mov_b32 v101, 0
  v_mov_b32 v102, 0
  v_mov_b32 v103, 0
  v_mov_b32 v104, 0
  v_mov_b32 v105, 0
  v_mov_b32 v106, 0
  v_mov_b32 v107, 0
  v_mov_b32 v240, 0
  v_mov_b32 v241, 0
  v_mov_b32 v242, 0
  v_mov_b32 v243, 0
  v_mov_b32 v244, 0
  v_mov_b32 v245, 0
  v_mov_b32 v246, 0
  v_mov_b32 v247, 0
  v_mov_b32 v248, 0
  v_mov_b32 v249, 0
  v_mov_b32 v250, 0
  v_mov_b32 v251, 0
  v_mov_b32 v252, 0
  v_mov_b32 v253, 0
  v_mov_b32 v254, 0
  v_mov_b32 v255, 0
  v_mov_b32 v124, 0
  v_mov_b32 v125, 0
  v_mov_b32 v126, 0
  v_mov_b32 v127, 0
  v_mov_b32 v20, 0
  v_mov_b32 v21, 0
  v_mov_b32 v22, 0
  v_mov_b32 v23, 0
  v_mov_b32 v24, 0
  v_mov_b32 v25, 0
  v_mov_b32 v26, 0
  v_mov_b32 v27, 0
  v_mov_b32 v28, 0
  v_mov_b32 v29, 0
  v_mov_b32 v30, 0
  v_mov_b32 v31, 0
  v_mov_b32 v32, 0
  v_mov_b32 v33, 0
  v_mov_b32 v34, 0
  v_mov_b32 v35, 0
  v_mov_b32 v36, 0
  v_mov_b32 v37, 0
  v_mov_b32 v38, 0
  v_mov_b32 v39, 0
  v_mov_b32 v40, 0
  v_mov_b32 v41, 0
  v_mov_b32 v42, 0
  v_mov_b32 v43, 0
  v_mov_b32 v44, 0
  v_mov_b32 v45, 0
  v_mov_b32 v46, 0
  v_mov_b32 v47, 0
  v_mov_b32 v48, 0
  v_mov_b32 v49, 0
  v_mov_b32 v50, 0
  v_mov_b32 v51, 0
  v_mov_b32 v176, 0
  v_mov_b32 v177, 0
  v_mov_b32 v178, 0
  v_mov_b32 v179, 0
  v_mov_b32 v180, 0
  v_mov_b32 v181, 0
  v_mov_b32 v182, 0
  v_mov_b32 v183, 0
  v_mov_b32 v184, 0
  v_mov_b32 v185, 0
  v_mov_b32 v186, 0
  v_mov_b32 v187, 0
  v_mov_b32 v188, 0
  v_mov_b32 v189, 0
  v_mov_b32 v190, 0
  v_mov_b32 v191, 0
  v_mov_b32 v192, 0
  v_mov_b32 v193, 0
  v_mov_b32 v194, 0
  v_mov_b32 v195, 0
  v_mov_b32 v196, 0
  v_mov_b32 v197, 0
  v_mov_b32 v198, 0
  v_mov_b32 v199, 0
  v_mov_b32 v200, 0
  v_mov_b32 v201, 0
  v_mov_b32 v202, 0
  v_mov_b32 v203, 0
  v_mov_b32 v204, 0
  v_mov_b32 v205, 0
  v_mov_b32 v206, 0
  v_mov_b32 v207, 0
  s_mov_b32 s80, 0
  s_barrier
  s_waitcnt vmcnt(16)
  v_mov_b32 v3, 1
  ds_write_b32 v137, v3
  s_mov_b32 s40, 1
  s_mov_b32 s39, 0
  s_cmp_ge_i32 s39, s40
  s_cbranch_scc1 L_go1
  s_mov_b32 s43, 1048576
L_poll1:
  ds_read_b128 v[132:135], v136 offset:16
  s_waitcnt lgkmcnt(0)
  v_min3_u32 v132, v132, v133, v134
  v_min_u32 v132, v132, v135
  s_sub_u32 s43, s43, 1
  v_readfirstlane_b32 s39, v132
  s_cbranch_scc1 L_end
  s_cmp_ge_i32 s39, s40
  s_cbranch_scc1 L_go1
  s_sleep 1
  s_branch L_poll1
L_go1:
  s_mov_b32 s38, 7
.p2align 3
L_qloop:
  s_waitcnt lgkmcnt(0)
  v_xor_b32 v13, s48, v12
  s_add_u32 s48, s48, 64
  s_and_b32 s48, s48, 0x3ff
  ds_read_b128 v[4:7], v13 offset:16384
  ds_read_b128 v[120:123], v13
  s_lshl_b32 s47, s50, 18
  s_add_u32 s50, s50, 1
  s_and_b32 s50, s50, 15
  s_waitcnt vmcnt(14)
  v_perm_b32 v144, v56, v52, s44
  v_perm_b32 v148, v56, v52, s45
  v_mfma_f32_16x16x32_bf16 v[92:95], v[176:179], v[8:11], v[92:95]
  v_perm_b32 v152, v57, v53, s44
  v_perm_b32 v156, v57, v53, s45
  v_mfma_f32_16x16x32_bf16 v[20:23], v[176:179], v[124:127], v[20:23]
  v_perm_b32 v160, v58, v54, s44
  v_perm_b32 v164, v58, v54, s45
  v_mfma_f32_16x16x32_bf16 v[96:99], v[180:183], v[8:11], v[96:99]
  v_perm_b32 v168, v59, v55, s44
  v_perm_b32 v172, v59, v55, s45
  v_mfma_f32_16x16x32_bf16 v[24:27], v[180:183], v[124:127], v[24:27]
  buffer_load_dwordx4 v[52:55], v84, s[20:23], s47 offen
  buffer_load_dwordx4 v[56:59], v85, s[20:23], s47 offen
  s_waitcnt vmcnt(14)
  v_perm_b32 v145, v64, v60, s44
  v_perm_b32 v149, v64, v60, s45
  v_mfma_f32_16x16x32_bf16 v[100:103], v[184:187], v[8:11], v[100:103]
  v_perm_b32 v153, v65, v61, s44
  v_perm_b32 v157, v65, v61, s45
  v_mfma_f32_16x16x32_bf16 v[28:31], v[184:187], v[124:127], v[28:31]
  v_perm_b32 v161, v66, v62, s44
  v_perm_b32 v165, v66, v62, s45
  v_mfma_f32_16x16x32_bf16 v[104:107], v[188:191], v[8:11], v[104:107]
  v_perm_b32 v169, v67, v63, s44
  v_perm_b32 v173, v67, v63, s45
  v_mfma_f32_16x16x32_bf16 v[32:35], v[188:191], v[124:127], v[32:35]
  buffer_load_dwordx4 v[60:63], v86, s[20:23], s47 offen
  buffer_load_dwordx4 v[64:67], v87, s[20:23], s47 offen
  s_waitcnt vmcnt(14)
  v_perm_b32 v146, v72, v68, s44
  v_perm_b32 v150, v72, v68, s45
  v_mfma_f32_16x16x32_bf16 v[240:243], v[192:195], v[8:11], v[240:243]
  v_perm_b32 v154, v73, v69, s44
  v_perm_b32 v158, v73, v69, s45
  v_mfma_f32_16x16x32_bf16 v[36:39], v[192:195], v[124:127], v[36:39]
  v_perm_b32 v162, v74, v70, s44
  v_perm_b32 v166, v74, v70, s45
  v_mfma_f32_16x16x32_bf16 v[244:247], v[196:199], v[8:11], v[244:247]
  v_perm_b32 v170, v75, v71, s44
  v_perm_b32 v174, v75, v71, s45
  v_mfma_f32_16x16x32_bf16 v[40:43], v[196:199], v[124:127], v[40:43]
  buffer_load_dwordx4 v[68:71], v88, s[20:23], s47 offen
  buffer_load_dwordx4 v[72:75], v89, s[20:23], s47 offen
  s_waitcnt vmcnt(14)
  v_perm_b32 v147, v80, v76, s44
  v_perm_b32 v151, v80, v76, s45
  v_mfma_f32_16x16x32_bf16 v[248:251], v[200:203], v[8:11], v[248:251]
  v_perm_b32 v155, v81, v77, s44
  v_perm_b32 v159, v81, v77, s45
  v_mfma_f32_16x16x32_bf16 v[44:47], v[200:203], v[124:127], v[44:47]
  v_perm_b32 v163, v82, v78, s44
  v_perm_b32 v167, v82, v78, s45
  v_mfma_f32_16x16x32_bf16 v[252:255], v[204:207], v[8:11], v[252:255]
  v_perm_b32 v171, v83, v79, s44
  v_perm_b32 v175, v83, v79, s45
  v_mfma_f32_16x16x32_bf16 v[48:51], v[204:207], v[124:127], v[48:51]
  buffer_load_dwordx4 v[76:79], v90, s[20:23], s47 offen
  buffer_load_dwordx4 v[80:83], v91, s[20:23], s47 offen
  s_waitcnt lgkmcnt(0)
  v_xor_b32 v13, s48, v12
  s_add_u32 s48, s48, 64
  s_and_b32 s48, s48, 0x3ff
  ds_read_b128 v[8:11], v13 offset:16384
  ds_read_b128 v[124:127], v13
  s_lshl_b32 s47, s50, 18
  s_add_u32 s50, s50, 1
  s_and_b32 s50, s50, 15
  s_waitcnt vmcnt(14)
  v_perm_b32 v176, v212, v208, s44
  v_perm_b32 v180, v212, v208, s45
  v_mfma_f32_16x16x32_bf16 v[92:95], v[144:147], v[4:7], v[92:95]
  v_perm_b32 v184, v213, v209, s44
  v_perm_b32 v188, v213, v209, s45
  v_mfma_f32_16x16x32_bf16 v[20:23], v[144:147], v[120:123], v[20:23]
  v_perm_b32 v192, v214, v210, s44
  v_perm_b32 v196, v214, v210, s45
  v_mfma_f32_16x16x32_bf16 v[96:99], v[148:151], v[4:7], v[96:99]
  v_perm_b32 v200, v215, v211, s44
  v_perm_b32 v204, v215, v211, s45
  v_mfma_f32_16x16x32_bf16 v[24:27], v[148:151], v[120:123], v[24:27]
  buffer_load_dwordx4 v[208:211], v84, s[20:23], s47 offen
  buffer_load_dwordx4 v[212:215], v85, s[20:23], s47 offen
  s_waitcnt vmcnt(14)
  v_perm_b32 v177, v220, v216, s44
  v_perm_b32 v181, v220, v216, s45
  v_mfma_f32_16x16x32_bf16 v[100:103], v[152:155], v[4:7], v[100:103]
  v_perm_b32 v185, v221, v217, s44
  v_perm_b32 v189, v221, v217, s45
  v_mfma_f32_16x16x32_bf16 v[28:31], v[152:155], v[120:123], v[28:31]
  v_perm_b32 v193, v222, v218, s44
  v_perm_b32 v197, v222, v218, s45
  v_mfma_f32_16x16x32_bf16 v[104:107], v[156:159], v[4:7], v[104:107]
  v_perm_b32 v201, v223, v219, s44
  v_perm_b32 v205, v223, v219, s45
  v_mfma_f32_16x16x32_bf16 v[32:35], v[156:159], v[120:123], v[32:35]
  buffer_load_dwordx4 v[216:219], v86, s[20:23], s47 offen
  buffer_load_dwordx4 v[220:223], v87, s[20:23], s47 offen
  s_waitcnt vmcnt(14)
  v_perm_b32 v178, v228, v224, s44
  v_perm_b32 v182, v228, v224, s45
  v_mfma_f32_16x16x32_bf16 v[240:243], v[160:163], v[4:7], v[240:243]
  v_perm_b32 v186, v229, v225, s44
  v_perm_b32 v190, v229, v225, s45
  v_mfma_f32_16x16x32_bf16 v[36:39], v[160:163], v[120:123], v[36:39]
  v_perm_b32 v194, v230, v226, s44
  v_perm_b32 v198, v230, v226, s45
  v_mfma_f32_16x16x32_bf16 v[244:247], v[164:167], v[4:7], v[244:247]
  v_perm_b32 v202, v231, v227, s44
  v_perm_b32 v206, v231, v227, s45
  v_mfma_f32_16x16x32_bf16 v[40:43], v[164:167], v[120:123], v[40:43]
  buffer_load_dwordx4 v[224:227], v88, s[20:23], s47 offen
  buffer_load_dwordx4 v[228:231], v89, s[20:23], s47 offen
  s_waitcnt vmcnt(14)
  v_perm_b32 v179, v236, v232, s44
  v_perm_b32 v183, v236, v232, s45
  v_mfma_f32_16x16x32_bf16 v[248:251], v[168:171], v[4:7], v[248:251]
  v_perm_b32 v187, v237, v233, s44
  v_perm_b32 v191, v237, v233, s45
  v_mfma_f32_16x16x32_bf16 v[44:47], v[168:171], v[120:123], v[44:47]
  v_perm_b32 v195, v238, v234, s44
  v_perm_b32 v199, v238, v234, s45
  v_mfma_f32_16x16x32_bf16 v[252:255], v[172:175], v[4:7], v[252:255]
  v_perm_b32 v203, v239, v235, s44
  v_perm_b32 v207, v239, v235, s45
  v_mfma_f32_16x16x32_bf16 v[48:51], v[172:175], v[120:123], v[48:51]
  buffer_load_dwordx4 v[232:235], v90, s[20:23], s47 offen
  buffer_load_dwordx4 v[236:239], v91, s[20:23], s47 offen
  s_sub_u32 s38, s38, 1
  s_cmp_lg_u32 s38, 0
  s_cbranch_scc1 L_qloop
  v_mov_b32 v3, 2
  ds_write_b32 v137, v3
  s_waitcnt lgkmcnt(0)
  v_xor_b32 v13, s48, v12
  s_add_u32 s48, s48, 64
  s_and_b32 s48, s48, 0x3ff
  ds_read_b128 v[4:7], v13 offset:16384
  ds_read_b128 v[120:123], v13
  s_waitcnt vmcnt(14)
  v_perm_b32 v144, v56, v52, s44
  v_perm_b32 v148, v56, v52, s45
  v_mfma_f32_16x16x32_bf16 v[92:95], v[176:179], v[8:11], v[92:95]
  v_perm_b32 v152, v57, v53, s44
  v_perm_b32 v156, v57, v53, s45
  v_mfma_f32_16x16x32_bf16 v[20:23], v[176:179], v[124:127], v[20:23]
  v_perm_b32 v160, v58, v54, s44
  v_perm_b32 v164, v58, v54, s45
  v_mfma_f32_16x16x32_bf16 v[96:99], v[180:183], v[8:11], v[96:99]
  v_perm_b32 v168, v59, v55, s44
  v_perm_b32 v172, v59, v55, s45
  v_mfma_f32_16x16x32_bf16 v[24:27], v[180:183], v[124:127], v[24:27]
  s_waitcnt vmcnt(12)
  v_perm_b32 v145, v64, v60, s44
  v_perm_b32 v149, v64, v60, s45
  v_mfma_f32_16x16x32_bf16 v[100:103], v[184:187], v[8:11], v[100:103]
  v_perm_b32 v153, v65, v61, s44
  v_perm_b32 v157, v65, v61, s45
  v_mfma_f32_16x16x32_bf16 v[28:31], v[184:187], v[124:127], v[28:31]
  v_perm_b32 v161, v66, v62, s44
  v_perm_b32 v165, v66, v62, s45
  v_mfma_f32_16x16x32_bf16 v[104:107], v[188:191], v[8:11], v[104:107]
  v_perm_b32 v169, v67, v63, s44
  v_perm_b32 v173, v67, v63, s45
  v_mfma_f32_16x16x32_bf16 v[32:35], v[188:191], v[124:127], v[32:35]
  s_waitcnt vmcnt(10)
  v_perm_b32 v146, v72, v68, s44
  v_perm_b32 v150, v72, v68, s45
  v_mfma_f32_16x16x32_bf16 v[240:243], v[192:195], v[8:11], v[240:243]
  v_perm_b32 v154, v73, v69, s44
  v_perm_b32 v158, v73, v69, s45
  v_mfma_f32_16x16x32_bf16 v[36:39], v[192:195], v[124:127], v[36:39]
  v_perm_b32 v162, v74, v70, s44
  v_perm_b32 v166, v74, v70, s45
  v_mfma_f32_16x16x32_bf16 v[244:247], v[196:199], v[8:11], v[244:247]
  v_perm_b32 v170, v75, v71, s44
  v_perm_b32 v174, v75, v71, s45
  v_mfma_f32_16x16x32_bf16 v[40:43], v[196:199], v[124:127], v[40:43]
  s_waitcnt vmcnt(8)
  v_perm_b32 v147, v80, v76, s44
  v_perm_b32 v151, v80, v76, s45
  v_mfma_f32_16x16x32_bf16 v[248:251], v[200:203], v[8:11], v[248:251]
  v_perm_b32 v155, v81, v77, s44
  v_perm_b32 v159, v81, v77, s45
  v_mfma_f32_16x16x32_bf16 v[44:47], v[200:203], v[124:127], v[44:47]
  v_perm_b32 v163, v82, v78, s44
  v_perm_b32 v167, v82, v78, s45
  v_mfma_f32_16x16x32_bf16 v[252:255], v[204:207], v[8:11], v[252:255]
  v_perm_b32 v171, v83, v79, s44
  v_perm_b32 v175, v83, v79, s45
  v_mfma_f32_16x16x32_bf16 v[48:51], v[204:207], v[124:127], v[48:51]
  s_waitcnt lgkmcnt(0)
  v_xor_b32 v13, s48, v12
  s_add_u32 s48, s48, 64
  s_and_b32 s48, s48, 0x3ff
  ds_read_b128 v[8:11], v13 offset:16384
  ds_read_b128 v[124:127], v13
  s_waitcnt vmcnt(6)
  v_perm_b32 v176, v212, v208, s44
  v_perm_b32 v180, v212, v208, s45
  v_mfma_f32_16x16x32_bf16 v[92:95], v[144:147], v[4:7], v[92:95]
  v_perm_b32 v184, v213, v209, s44
  v_perm_b32 v188, v213, v209, s45
  v_mfma_f32_16x16x32_bf16 v[20:23], v[144:147], v[120:123], v[20:23]
  v_perm_b32 v192, v214, v210, s44
  v_perm_b32 v196, v214, v210, s45
  v_mfma_f32_16x16x32_bf16 v[96:99], v[148:151], v[4:7], v[96:99]
  v_perm_b32 v200, v215, v211, s44
  v_perm_b32 v204, v215, v211, s45
  v_mfma_f32_16x16x32_bf16 v[24:27], v[148:151], v[120:123], v[24:27]
  s_waitcnt vmcnt(4)
  v_perm_b32 v177, v220, v216, s44
  v_perm_b32 v181, v220, v216, s45
  v_mfma_f32_16x16x32_bf16 v[100:103], v[152:155], v[4:7], v[100:103]
  v_perm_b32 v185, v221, v217, s44
  v_perm_b32 v189, v221, v217, s45
  v_mfma_f32_16x16x32_bf16 v[28:31], v[152:155], v[120:123], v[28:31]
  v_perm_b32 v193, v222, v218, s44
  v_perm_b32 v197, v222, v218, s45
  v_mfma_f32_16x16x32_bf16 v[104:107], v[156:159], v[4:7], v[104:107]
  v_perm_b32 v201, v223, v219, s44
  v_perm_b32 v205, v223, v219, s45
  v_mfma_f32_16x16x32_bf16 v[32:35], v[156:159], v[120:123], v[32:35]
  s_waitcnt vmcnt(2)
  v_perm_b32 v178, v228, v224, s44
  v_perm_b32 v182, v228, v224, s45
  v_mfma_f32_16x16x32_bf16 v[240:243], v[160:163], v[4:7], v[240:243]
  v_perm_b32 v186, v229, v225, s44
  v_perm_b32 v190, v229, v225, s45
  v_mfma_f32_16x16x32_bf16 v[36:39], v[160:163], v[120:123], v[36:39]
  v_perm_b32 v194, v230, v226, s44
  v_perm_b32 v198, v230, v226, s45
  v_mfma_f32_16x16x32_bf16 v[244:247], v[164:167], v[4:7], v[244:247]
  v_perm_b32 v202, v231, v227, s44
  v_perm_b32 v206, v231, v227, s45
  v_mfma_f32_16x16x32_bf16 v[40:43], v[164:167], v[120:123], v[40:43]
  s_waitcnt vmcnt(0)
  v_perm_b32 v179, v236, v232, s44
  v_perm_b32 v183, v236, v232, s45
  v_mfma_f32_16x16x32_bf16 v[248:251], v[168:171], v[4:7], v[248:251]
  v_perm_b32 v187, v237, v233, s44
  v_perm_b32 v191, v237, v233, s45
  v_mfma_f32_16x16x32_bf16 v[44:47], v[168:171], v[120:123], v[44:47]
  v_perm_b32 v195, v238, v234, s44
  v_perm_b32 v199, v238, v234, s45
  v_mfma_f32_16x16x32_bf16 v[252:255], v[172:175], v[4:7], v[252:255]
  v_perm_b32 v203, v239, v235, s44
  v_perm_b32 v207, v239, v235, s45
  v_mfma_f32_16x16x32_bf16 v[48:51], v[172:175], v[120:123], v[48:51]
  s_waitcnt lgkmcnt(0)
  v_mov_b32 v3, 3
  ds_write_b32 v137, v3
  s_memrealtime s[94:95]
  v_mfma_f32_16x16x32_bf16 v[20:23], v[176:179], v[124:127], v[20:23]
  v_mfma_f32_16x16x32_bf16 v[24:27], v[180:183], v[124:127], v[24:27]
  v_mfma_f32_16x16x32_bf16 v[28:31], v[184:187], v[124:127], v[28:31]
  v_mfma_f32_16x16x32_bf16 v[32:35], v[188:191], v[124:127], v[32:35]
  v_mfma_f32_16x16x32_bf16 v[36:39], v[192:195], v[124:127], v[36:39]
  v_mfma_f32_16x16x32_bf16 v[40:43], v[196:199], v[124:127], v[40:43]
  v_mfma_f32_16x16x32_bf16 v[44:47], v[200:203], v[124:127], v[44:47]
  v_mfma_f32_16x16x32_bf16 v[48:51], v[204:207], v[124:127], v[48:51]
  v_mfma_f32_16x16x32_bf16 v[92:95], v[176:179], v[8:11], v[92:95]
  v_mfma_f32_16x16x32_bf16 v[96:99], v[180:183], v[8:11], v[96:99]
  v_mfma_f32_16x16x32_bf16 v[100:103], v[184:187], v[8:11], v[100:103]
  v_mfma_f32_16x16x32_bf16 v[104:107], v[188:191], v[8:11], v[104:107]
  v_mfma_f32_16x16x32_bf16 v[240:243], v[192:195], v[8:11], v[240:243]
  v_mfma_f32_16x16x32_bf16 v[244:247], v[196:199], v[8:11], v[244:247]
  v_mfma_f32_16x16x32_bf16 v[248:251], v[200:203], v[8:11], v[248:251]
  v_mfma_f32_16x16x32_bf16 v[252:255], v[204:207], v[8:11], v[252:255]
  s_mov_b32 s47, s46
  v_lshlrev_b32 v13, 4, v0
  v_pk_mul_f32 v[20:21], v[20:21], s[46:47]
  v_pk_mul_f32 v[22:23], v[22:23], s[46:47]
  v_pk_mul_f32 v[24:25], v[24:25], s[46:47]
  v_pk_mul_f32 v[26:27], v[26:27], s[46:47]
  v_pk_mul_f32 v[28:29], v[28:29], s[46:47]
  v_pk_mul_f32 v[30:31], v[30:31], s[46:47]
  v_pk_mul_f32 v[32:33], v[32:33], s[46:47]
  v_pk_mul_f32 v[34:35], v[34:35], s[46:47]
  v_pk_mul_f32 v[36:37], v[36:37], s[46:47]
  v_pk_mul_f32 v[38:39], v[38:39], s[46:47]
  v_pk_mul_f32 v[40:41], v[40:41], s[46:47]
  v_pk_mul_f32 v[42:43], v[42:43], s[46:47]
  v_pk_mul_f32 v[44:45], v[44:45], s[46:47]
  v_pk_mul_f32 v[46:47], v[46:47], s[46:47]
  v_pk_mul_f32 v[48:49], v[48:49], s[46:47]
  v_pk_mul_f32 v[50:51], v[50:51], s[46:47]
  v_cvt_pk_bf16_f32 v52, v20, v24
  v_cvt_pk_bf16_f32 v53, v28, v32
  v_cvt_pk_bf16_f32 v54, v36, v40
  v_cvt_pk_bf16_f32 v55, v44, v48
  global_store_dwordx4 v13, v[52:55], s[88:89] offset:0 sc1
  v_cvt_pk_bf16_f32 v56, v21, v25
  v_cvt_pk_bf16_f32 v57, v29, v33
  v_cvt_pk_bf16_f32 v58, v37, v41
  v_cvt_pk_bf16_f32 v59, v45, v49
  global_store_dwordx4 v13, v[56:59], s[88:89] offset:1024 sc1
  v_cvt_pk_bf16_f32 v60, v22, v26
  v_cvt_pk_bf16_f32 v61, v30, v34
  v_cvt_pk_bf16_f32 v62, v38, v42
  v_cvt_pk_bf16_f32 v63, v46, v50
  global_store_dwordx4 v13, v[60:63], s[88:89] offset:2048 sc1
  v_cvt_pk_bf16_f32 v64, v23, v27
  v_cvt_pk_bf16_f32 v65, v31, v35
  v_cvt_pk_bf16_f32 v66, v39, v43
  v_cvt_pk_bf16_f32 v67, v47, v51
  global_store_dwordx4 v13, v[64:67], s[88:89] offset:3072 sc1
  v_pk_mul_f32 v[92:93], v[92:93], s[46:47]
  v_pk_mul_f32 v[94:95], v[94:95], s[46:47]
  v_pk_mul_f32 v[96:97], v[96:97], s[46:47]
  v_pk_mul_f32 v[98:99], v[98:99], s[46:47]
  v_pk_mul_f32 v[100:101], v[100:101], s[46:47]
  v_pk_mul_f32 v[102:103], v[102:103], s[46:47]
  v_pk_mul_f32 v[104:105], v[104:105], s[46:47]
  v_pk_mul_f32 v[106:107], v[106:107], s[46:47]
  v_pk_mul_f32 v[240:241], v[240:241], s[46:47]
  v_pk_mul_f32 v[242:243], v[242:243], s[46:47]
  v_pk_mul_f32 v[244:245], v[244:245], s[46:47]
  v_pk_mul_f32 v[246:247], v[246:247], s[46:47]
  v_pk_mul_f32 v[248:249], v[248:249], s[46:47]
  v_pk_mul_f32 v[250:251], v[250:251], s[46:47]
  v_pk_mul_f32 v[252:253], v[252:253], s[46:47]
  v_pk_mul_f32 v[254:255], v[254:255], s[46:47]
  v_cvt_pk_bf16_f32 v4, v92, v96
  v_cvt_pk_bf16_f32 v5, v100, v104
  v_cvt_pk_bf16_f32 v6, v240, v244
  v_cvt_pk_bf16_f32 v7, v248, v252
  v_cvt_pk_bf16_f32 v8, v93, v97
  v_cvt_pk_bf16_f32 v9, v101, v105
  v_cvt_pk_bf16_f32 v10, v241, v245
  v_cvt_pk_bf16_f32 v11, v249, v253
  v_cvt_pk_bf16_f32 v12, v94, v98
  v_cvt_pk_bf16_f32 v13, v102, v106
  v_cvt_pk_bf16_f32 v14, v242, v246
  v_cvt_pk_bf16_f32 v15, v250, v254
  v_cvt_pk_bf16_f32 v16, v95, v99
  v_cvt_pk_bf16_f32 v17, v103, v107
  v_cvt_pk_bf16_f32 v18, v243, v247
  v_cvt_pk_bf16_f32 v19, v251, v255
  v_mov_b32 v120, 0
  v_mov_b32 v124, 0x3f803f80
  v_mov_b32 v121, 0
  v_mov_b32 v125, 0x3f803f80
  v_mov_b32 v122, 0
  v_mov_b32 v126, 0x3f803f80
  v_mov_b32 v123, 0
  v_mov_b32 v127, 0x3f803f80
  v_mov_b32 v20, 0
  v_mov_b32 v21, 0
  v_mov_b32 v22, 0
  v_mov_b32 v23, 0
  v_mov_b32 v24, 0
  v_mov_b32 v25, 0
  v_mov_b32 v26, 0
  v_mov_b32 v27, 0
  v_mov_b32 v28, 0
  v_mov_b32 v29, 0
  v_mov_b32 v30, 0
  v_mov_b32 v31, 0
  v_mov_b32 v32, 0
  v_mov_b32 v33, 0
  v_mov_b32 v34, 0
  v_mov_b32 v35, 0
  v_mov_b32 v36, 0
  v_mov_b32 v37, 0
  v_mov_b32 v38, 0
  v_mov_b32 v39, 0
  v_mov_b32 v40, 0
  v_mov_b32 v41, 0
  v_mov_b32 v42, 0
  v_mov_b32 v43, 0
  v_mov_b32 v44, 0
  v_mov_b32 v45, 0
  v_mov_b32 v46, 0
  v_mov_b32 v47, 0
  v_mov_b32 v48, 0
  v_mov_b32 v49, 0
  v_mov_b32 v50, 0
  v_mov_b32 v51, 0
  s_mov_b32 s39, 0
  s_mov_b32 s40, 0
  s_mov_b32 s38, 0
  s_mov_b32 s80, 20
  s_waitcnt lgkmcnt(0)
  s_lshl_b32 s34, s3, 3
  v_mov_b32 v132, s34
  v_mov_b32 v134, s94
  v_mov_b32 v135, s95
  s_mov_b64 exec, 1
  s_waitcnt vmcnt(0)
  global_store_dwordx2 v132, v[134:135], s[90:91] sc1
  s_mov_b64 exec, -1
  s_branch L_main
L_codd:
  s_waitcnt lgkmcnt(0)
  s_barrier
  s_mul_i32 s34, s86, 128
  s_add_u32 s34, s34, 20971520
  s_add_u32 s90, s18, s34
  s_addc_u32 s91, s19, 0
  s_cmp_lg_u32 s3, 1
  s_cbranch_scc1 L_nocw
  s_getpc_b64 s[36:37]
L_pc:
  s_sub_u32 s36, s36, L_pc-standalone__gqa_block_cached__sampling_kernel
  s_subb_u32 s37, s37, 0
  s_mul_i32 s34, s50, 3072
  v_lshl_add_u32 v132, v0, 7, s34
  v_min_u32 v132, L_end-standalone__gqa_block_cached__sampling_kernel, v132
  s_mov_b64 exec, 0xffffff
  global_load_dword v133, v132, s[36:37]
  s_mov_b64 exec, -1
  s_waitcnt vmcnt(0)
L_nocw:
  v_lshrrev_b32 v132, 3, v2
  v_mul_u32_u24 v132, 12, v132
  v_and_b32 v133, 3, v2
  v_or_b32 v132, v132, v133
  v_lshlrev_b32 v133, 2, v1
  v_xor_b32 v132, v132, v133
  v_lshlrev_b32 v132, 4, v132
  v_lshl_add_u32 v108, v2, 8, v132
  v_xor_b32 v109, 16, v108
  v_xor_b32 v110, 32, v108
  v_xor_b32 v111, 48, v108
  v_lshrrev_b32 v132, 2, v0
  v_and_b32 v133, 7, v132
  v_lshlrev_b32 v133, 5, v133
  v_lshl_add_u32 v133, v132, 8, v133
  v_and_b32 v132, 3, v0
  v_lshl_add_u32 v112, v132, 3, v133
  v_xor_b32 v113, 32, v112
  v_xor_b32 v114, 64, v112
  v_xor_b32 v115, 96, v112
  v_xor_b32 v116, 128, v112
  v_xor_b32 v117, 160, v112
  v_xor_b32 v118, 192, v112
  v_xor_b32 v119, 224, v112
  s_mul_i32 s34, s32, 131072
  s_add_u32 s54, s18, s34
  s_addc_u32 s55, s19, 0
  s_mul_i32 s34, s32, 2048
  s_add_u32 s34, s34, 12582912
  s_add_u32 s56, s18, s34
  s_addc_u32 s57, s19, 0
  s_lshl_b32 s52, s3, 14
  s_add_u32 s52, s52, 65536
  s_lshl_b32 s34, s33, 19
  s_lshl_b32 s35, s3, 7
  s_add_u32 s34, s34, s35
  s_add_u32 s28, s12, s34
  s_addc_u32 s29, s13, 0
  s_sub_u32 s30, 0x80000, s35
  s_mov_b32 s31, 0x20000
  s_mov_b32 s61, 360448
  v_lshlrev_b32 v132, 1, v1
  v_and_b32 v133, 7, v0
  v_xor_b32 v132, v132, v133
  v_lshlrev_b32 v132, 4, v132
  v_lshrrev_b32 v133, 3, v0
  v_lshl_add_u32 v138, v133, 10, v132
  v_add_u32 v139, 7168, v138
  v_lshrrev_b32 v132, 2, v0
  v_bfe_u32 v133, v0, 3, 2
  v_lshlrev_b32 v133, 5, v133
  v_lshl_add_u32 v132, v132, 7, v133
  v_and_b32 v133, 3, v0
  v_lshl_add_u32 v132, v133, 3, v132
  v_add_u32 v140, s52, v132
  v_xor_b32 v141, 32, v140
  v_xor_b32 v142, 64, v140
  v_xor_b32 v143, 96, v140
  v_lshlrev_b32 v132, 4, v0
  v_add_u32 v1, 32768, v132
  v_mov_b32 v128, 0
  v_mov_b32 v129, 0
  v_mov_b32 v130, 0
  v_mov_b32 v131, 0
  s_mov_b32 s82, 0xff800000
  s_mov_b32 s83, 0xff800000
  s_lshl_b32 s34, s86, 14
  s_lshl_b32 s35, s3, 12
  s_add_u32 s34, s34, s35
  s_add_u32 s34, s34, 16777216
  s_add_u32 s88, s18, s34
  s_addc_u32 s89, s19, 0
  v_mov_b32 v120, 0
  v_mov_b32 v124, 0x3f803f80
  v_mov_b32 v121, 0
  v_mov_b32 v125, 0x3f803f80
  v_mov_b32 v122, 0
  v_mov_b32 v126, 0x3f803f80
  v_mov_b32 v123, 0
  v_mov_b32 v127, 0x3f803f80
  v_mov_b32 v20, 0
  v_mov_b32 v21, 0
  v_mov_b32 v22, 0
  v_mov_b32 v23, 0
  v_mov_b32 v24, 0
  v_mov_b32 v25, 0
  v_mov_b32 v26, 0
  v_mov_b32 v27, 0
  v_mov_b32 v28, 0
  v_mov_b32 v29, 0
  v_mov_b32 v30, 0
  v_mov_b32 v31, 0
  v_mov_b32 v32, 0
  v_mov_b32 v33, 0
  v_mov_b32 v34, 0
  v_mov_b32 v35, 0
  v_mov_b32 v36, 0
  v_mov_b32 v37, 0
  v_mov_b32 v38, 0
  v_mov_b32 v39, 0
  v_mov_b32 v40, 0
  v_mov_b32 v41, 0
  v_mov_b32 v42, 0
  v_mov_b32 v43, 0
  v_mov_b32 v44, 0
  v_mov_b32 v45, 0
  v_mov_b32 v46, 0
  v_mov_b32 v47, 0
  v_mov_b32 v48, 0
  v_mov_b32 v49, 0
  v_mov_b32 v50, 0
  v_mov_b32 v51, 0
  s_mov_b32 s39, 0
  s_mov_b32 s40, 0
  s_mov_b32 s38, 0
  v_mov_b32 v3, 3
  s_mov_b32 s80, 20
  s_mov_b32 s87, 2
  s_add_u32 s40, s40, 1
  s_cmp_ge_i32 s39, s40
  s_cbranch_scc1 L_go2
  s_mov_b32 s43, 1048576
L_poll2:
  ds_read_b128 v[132:135], v136 offset:0
  s_waitcnt lgkmcnt(0)
  v_min3_u32 v132, v132, v133, v134
  v_min_u32 v132, v132, v135
  s_sub_u32 s43, s43, 1
  v_readfirstlane_b32 s39, v132
  s_cbranch_scc1 L_end
  s_cmp_ge_i32 s39, s40
  s_cbranch_scc1 L_go2
  s_sleep 1
  s_branch L_poll2
L_go2:
  ds_read_b128 v[144:147], v108 offset:0
  ds_read_b128 v[148:151], v109 offset:0
  ds_read_b128 v[152:155], v110 offset:0
  ds_read_b128 v[156:159], v111 offset:0
  ds_read_b128 v[160:163], v108 offset:4096
  ds_read_b128 v[164:167], v109 offset:4096
  ds_read_b128 v[168:171], v110 offset:4096
  ds_read_b128 v[172:175], v111 offset:4096
  ds_read_b128 v[176:179], v108 offset:8192
  ds_read_b128 v[180:183], v109 offset:8192
  ds_read_b128 v[184:187], v110 offset:8192
  ds_read_b128 v[188:191], v111 offset:8192
  ds_read_b128 v[192:195], v108 offset:12288
  ds_read_b128 v[196:199], v109 offset:12288
  ds_read_b128 v[200:203], v110 offset:12288
  ds_read_b128 v[204:207], v111 offset:12288
  s_waitcnt lgkmcnt(0)
  v_add_u32 v3, 1, v3
  ds_write_b32 v137, v3
  v_mov_b32 v4, 163776
  s_mov_b32 s36, 0
  s_mov_b32 s37, 1
  s_cmp_ge_i32 s36, s37
  s_cbranch_scc1 L_go3
  s_mov_b32 s43, 1048576
L_poll3:
  ds_read_b128 v[132:135], v4 offset:0
  s_waitcnt lgkmcnt(0)
  v_min3_u32 v132, v132, v133, v134
  v_min_u32 v132, v132, v135
  s_sub_u32 s43, s43, 1
  v_readfirstlane_b32 s36, v132
  s_cbranch_scc1 L_end
  s_cmp_ge_i32 s36, s37
  s_cbranch_scc1 L_go3
  s_sleep 1
  s_branch L_poll3
L_go3:
  s_lshl_b32 s34, s3, 3
  v_mov_b32 v4, s34
  v_lshlrev_b32 v135, 4, v0
  s_mov_b32 s43, 1048576
  s_sub_u32 s94, s92, 2000
  s_subb_u32 s95, s93, 0
L_qp:
  global_load_dwordx2 v[132:133], v4, s[90:91] sc1
  s_sub_u32 s43, s43, 1
  s_cbranch_scc1 L_end
  s_waitcnt vmcnt(0)
  v_subrev_co_u32 v132, vcc, s94, v132
  v_mov_b32 v134, s95
  s_nop 0
  v_subb_co_u32 v133, vcc, v133, v134, vcc
  v_lshrrev_b32 v132, 24, v132
  v_or_b32 v132, v132, v133
  v_cmp_ne_u32 vcc, 0, v132
  s_cbranch_vccz L_qok
  s_sleep 8
  s_branch L_qp
L_qok:
  global_load_dwordx4 v[4:7], v135, s[88:89] offset:0 sc1
  global_load_dwordx4 v[8:11], v135, s[88:89] offset:1024 sc1
  global_load_dwordx4 v[12:15], v135, s[88:89] offset:2048 sc1
  global_load_dwordx4 v[16:19], v135, s[88:89] offset:3072 sc1
  s_waitcnt vmcnt(0)
  s_branch L_estep
L_main:
  s_mov_b32 s87, 2
  s_add_u32 s40, s40, 1
  s_cmp_ge_i32 s39, s40
  s_cbranch_scc1 L_go4
  s_mov_b32 s43, 1048576
L_poll4:
  ds_read_b128 v[132:135], v136 offset:0
  s_waitcnt lgkmcnt(0)
  v_min3_u32 v132, v132, v133, v134
  v_min_u32 v132, v132, v135
  s_sub_u32 s43, s43, 1
  v_readfirstlane_b32 s39, v132
  s_cbranch_scc1 L_end
  s_cmp_ge_i32 s39, s40
  s_cbranch_scc1 L_go4
  s_sleep 1
  s_branch L_poll4
L_go4:
  ds_read_b128 v[144:147], v108 offset:0
  ds_read_b128 v[148:151], v109 offset:0
  ds_read_b128 v[152:155], v110 offset:0
  ds_read_b128 v[156:159], v111 offset:0
  ds_read_b128 v[160:163], v108 offset:4096
  ds_read_b128 v[164:167], v109 offset:4096
  ds_read_b128 v[168:171], v110 offset:4096
  ds_read_b128 v[172:175], v111 offset:4096
  ds_read_b128 v[176:179], v108 offset:8192
  ds_read_b128 v[180:183], v109 offset:8192
  ds_read_b128 v[184:187], v110 offset:8192
  ds_read_b128 v[188:191], v111 offset:8192
  ds_read_b128 v[192:195], v108 offset:12288
  ds_read_b128 v[196:199], v109 offset:12288
  ds_read_b128 v[200:203], v110 offset:12288
  ds_read_b128 v[204:207], v111 offset:12288
  s_waitcnt lgkmcnt(0)
  v_add_u32 v3, 1, v3
  ds_write_b32 v137, v3
.p2align 3
L_estep:
  s_add_u32 s40, s40, 1
  s_cmp_ge_i32 s39, s40
  s_cbranch_scc1 L_go5
  s_mov_b32 s43, 1048576
L_poll5:
  ds_read_b128 v[132:135], v136 offset:0
  s_waitcnt lgkmcnt(0)
  v_min3_u32 v132, v132, v133, v134
  v_min_u32 v132, v132, v135
  s_sub_u32 s43, s43, 1
  v_readfirstlane_b32 s39, v132
  s_cbranch_scc1 L_end
  s_cmp_ge_i32 s39, s40
  s_cbranch_scc1 L_go5
  s_sleep 1
  s_branch L_poll5
L_go5:
  v_mfma_f32_16x16x32_bf16 v[52:55], v[144:147], v[4:7], v[120:123]
  ds_read_b64_tr_b16 v[76:77], v112 offset:16384
  ds_read_b64_tr_b16 v[78:79], v112 offset:20480
  v_mfma_f32_16x16x32_bf16 v[52:55], v[148:151], v[8:11], v[52:55]
  ds_read_b64_tr_b16 v[80:81], v113 offset:16384
  ds_read_b64_tr_b16 v[82:83], v113 offset:20480
  v_mfma_f32_16x16x32_bf16 v[52:55], v[152:155], v[12:15], v[52:55]
  ds_read_b64_tr_b16 v[84:85], v114 offset:16384
  ds_read_b64_tr_b16 v[86:87], v114 offset:20480
  v_mfma_f32_16x16x32_bf16 v[52:55], v[156:159], v[16:19], v[52:55]
  ds_read_b64_tr_b16 v[88:89], v115 offset:16384
  ds_read_b64_tr_b16 v[90:91], v115 offset:20480
  v_mfma_f32_16x16x32_bf16 v[56:59], v[160:163], v[4:7], v[120:123]
  ds_read_b64_tr_b16 v[92:93], v116 offset:16384
  ds_read_b64_tr_b16 v[94:95], v116 offset:20480
  v_mfma_f32_16x16x32_bf16 v[56:59], v[164:167], v[8:11], v[56:59]
  ds_read_b64_tr_b16 v[96:97], v117 offset:16384
  ds_read_b64_tr_b16 v[98:99], v117 offset:20480
  v_mfma_f32_16x16x32_bf16 v[56:59], v[168:171], v[12:15], v[56:59]
  ds_read_b64_tr_b16 v[100:101], v118 offset:16384
  ds_read_b64_tr_b16 v[102:103], v118 offset:20480
  v_mfma_f32_16x16x32_bf16 v[56:59], v[172:175], v[16:19], v[56:59]
  ds_read_b64_tr_b16 v[104:105], v119 offset:16384
  ds_read_b64_tr_b16 v[106:107], v119 offset:20480
  ds_read_b64_tr_b16 v[208:209], v112 offset:24576
  ds_read_b64_tr_b16 v[210:211], v112 offset:28672
  v_max3_f32 v132, v52, v53, v54
  v_max_f32 v132, v132, v55
  ds_read_b64_tr_b16 v[212:213], v113 offset:24576
  ds_read_b64_tr_b16 v[214:215], v113 offset:28672
  v_max3_f32 v132, v132, v56, v57
  v_max3_f32 v132, v132, v58, v59
  v_cmp_lt_f32 vcc, s82, v132
  s_cbranch_vccnz L_slow0
L_back0_2:
  v_mfma_f32_16x16x32_bf16 v[60:63], v[176:179], v[4:7], v[120:123]
  ds_read_b64_tr_b16 v[216:217], v114 offset:24576
  ds_read_b64_tr_b16 v[218:219], v114 offset:28672
  v_exp_f32 v52, v52
  v_exp_f32 v53, v53
  v_mfma_f32_16x16x32_bf16 v[64:67], v[192:195], v[4:7], v[120:123]
  ds_read_b64_tr_b16 v[220:221], v115 offset:24576
  ds_read_b64_tr_b16 v[222:223], v115 offset:28672
  v_exp_f32 v54, v54
  v_mfma_f32_16x16x32_bf16 v[60:63], v[180:183], v[8:11], v[60:63]
  ds_read_b64_tr_b16 v[224:225], v116 offset:24576
  ds_read_b64_tr_b16 v[226:227], v116 offset:28672
  v_exp_f32 v55, v55
  v_cvt_pk_bf16_f32 v68, v52, v53
  v_mfma_f32_16x16x32_bf16 v[64:67], v[196:199], v[8:11], v[64:67]
  ds_read_b64_tr_b16 v[228:229], v117 offset:24576
  ds_read_b64_tr_b16 v[230:231], v117 offset:28672
  v_exp_f32 v56, v56
  v_mfma_f32_16x16x32_bf16 v[60:63], v[184:187], v[12:15], v[60:63]
  ds_read_b64_tr_b16 v[232:233], v118 offset:24576
  ds_read_b64_tr_b16 v[234:235], v118 offset:28672
  v_exp_f32 v57, v57
  v_cvt_pk_bf16_f32 v69, v54, v55
  v_mfma_f32_16x16x32_bf16 v[64:67], v[200:203], v[12:15], v[64:67]
  ds_read_b64_tr_b16 v[236:237], v119 offset:24576
  ds_read_b64_tr_b16 v[238:239], v119 offset:28672
  v_exp_f32 v58, v58
  v_mfma_f32_16x16x32_bf16 v[60:63], v[188:191], v[16:19], v[60:63]
  v_exp_f32 v59, v59
  v_cvt_pk_bf16_f32 v70, v56, v57
  v_mfma_f32_16x16x32_bf16 v[64:67], v[204:207], v[16:19], v[64:67]
  v_cvt_pk_bf16_f32 v71, v58, v59
  s_waitcnt lgkmcnt(0)
  v_add_u32 v3, 1, v3
  ds_write_b32 v137, v3
  s_add_u32 s40, s40, 1
  s_cmp_ge_i32 s39, s40
  s_cbranch_scc1 L_go6
  s_mov_b32 s43, 1048576
L_poll6:
  ds_read_b128 v[132:135], v136 offset:0
  s_waitcnt lgkmcnt(0)
  v_min3_u32 v132, v132, v133, v134
  v_min_u32 v132, v132, v135
  s_sub_u32 s43, s43, 1
  v_readfirstlane_b32 s39, v132
  s_cbranch_scc1 L_end
  s_cmp_ge_i32 s39, s40
  s_cbranch_scc1 L_go6
  s_sleep 1
  s_branch L_poll6
L_go6:
  v_max3_f32 v132, v60, v61, v62
  v_max_f32 v132, v132, v63
  s_nop 0
  v_max3_f32 v132, v132, v64, v65
  v_max3_f32 v132, v132, v66, v67
  v_cmp_lt_f32 vcc, s82, v132
  s_cbranch_vccnz L_slow1
L_back1_2:
  v_mfma_f32_16x16x32_bf16 v[128:131], v[124:127], v[68:71], v[128:131]
  v_mfma_f32_16x16x32_bf16 v[20:23], v[76:79], v[68:71], v[20:23]
  ds_read_b128 v[144:147], v108 offset:32768
  v_exp_f32 v60, v60
  v_exp_f32 v61, v61
  v_mfma_f32_16x16x32_bf16 v[24:27], v[80:83], v[68:71], v[24:27]
  ds_read_b128 v[148:151], v109 offset:32768
  v_exp_f32 v62, v62
  v_mfma_f32_16x16x32_bf16 v[28:31], v[84:87], v[68:71], v[28:31]
  ds_read_b128 v[152:155], v110 offset:32768
  v_exp_f32 v63, v63
  v_cvt_pk_bf16_f32 v72, v60, v61
  v_mfma_f32_16x16x32_bf16 v[32:35], v[88:91], v[68:71], v[32:35]
  ds_read_b128 v[156:159], v111 offset:32768
  v_exp_f32 v64, v64
  v_mfma_f32_16x16x32_bf16 v[36:39], v[92:95], v[68:71], v[36:39]
  ds_read_b128 v[160:163], v108 offset:36864
  v_exp_f32 v65, v65
  v_cvt_pk_bf16_f32 v73, v62, v63
  v_mfma_f32_16x16x32_bf16 v[40:43], v[96:99], v[68:71], v[40:43]
  ds_read_b128 v[164:167], v109 offset:36864
  v_exp_f32 v66, v66
  v_mfma_f32_16x16x32_bf16 v[44:47], v[100:103], v[68:71], v[44:47]
  ds_read_b128 v[168:171], v110 offset:36864
  v_exp_f32 v67, v67
  v_cvt_pk_bf16_f32 v74, v64, v65
  v_mfma_f32_16x16x32_bf16 v[48:51], v[104:107], v[68:71], v[48:51]
  ds_read_b128 v[172:175], v111 offset:36864
  v_cvt_pk_bf16_f32 v75, v66, v67
  s_add_u32 s38, s38, 1
  s_nop 0
  v_mfma_f32_16x16x32_bf16 v[128:131], v[124:127], v[72:75], v[128:131]
  v_mfma_f32_16x16x32_bf16 v[20:23], v[208:211], v[72:75], v[20:23]
  ds_read_b128 v[176:179], v108 offset:40960
  v_mfma_f32_16x16x32_bf16 v[24:27], v[212:215], v[72:75], v[24:27]
  ds_read_b128 v[180:183], v109 offset:40960
  v_mfma_f32_16x16x32_bf16 v[28:31], v[216:219], v[72:75], v[28:31]
  ds_read_b128 v[184:187], v110 offset:40960
  v_mfma_f32_16x16x32_bf16 v[32:35], v[220:223], v[72:75], v[32:35]
  ds_read_b128 v[188:191], v111 offset:40960
  v_mfma_f32_16x16x32_bf16 v[36:39], v[224:227], v[72:75], v[36:39]
  ds_read_b128 v[192:195], v108 offset:45056
  v_mfma_f32_16x16x32_bf16 v[40:43], v[228:231], v[72:75], v[40:43]
  ds_read_b128 v[196:199], v109 offset:45056
  v_mfma_f32_16x16x32_bf16 v[44:47], v[232:235], v[72:75], v[44:47]
  ds_read_b128 v[200:203], v110 offset:45056
  v_mfma_f32_16x16x32_bf16 v[48:51], v[236:239], v[72:75], v[48:51]
  ds_read_b128 v[204:207], v111 offset:45056
  s_waitcnt lgkmcnt(0)
  v_add_u32 v3, 1, v3
  ds_write_b32 v137, v3
  s_add_u32 s40, s40, 1
  s_cmp_ge_i32 s39, s40
  s_cbranch_scc1 L_go7
  s_mov_b32 s43, 1048576
L_poll7:
  ds_read_b128 v[132:135], v136 offset:0
  s_waitcnt lgkmcnt(0)
  v_min3_u32 v132, v132, v133, v134
  v_min_u32 v132, v132, v135
  s_sub_u32 s43, s43, 1
  v_readfirstlane_b32 s39, v132
  s_cbranch_scc1 L_end
  s_cmp_ge_i32 s39, s40
  s_cbranch_scc1 L_go7
  s_sleep 1
  s_branch L_poll7
L_go7:
  v_mfma_f32_16x16x32_bf16 v[52:55], v[144:147], v[4:7], v[120:123]
  ds_read_b64_tr_b16 v[76:77], v112 offset:49152
  ds_read_b64_tr_b16 v[78:79], v112 offset:53248
  v_mfma_f32_16x16x32_bf16 v[52:55], v[148:151], v[8:11], v[52:55]
  ds_read_b64_tr_b16 v[80:81], v113 offset:49152
  ds_read_b64_tr_b16 v[82:83], v113 offset:53248
  v_mfma_f32_16x16x32_bf16 v[52:55], v[152:155], v[12:15], v[52:55]
  ds_read_b64_tr_b16 v[84:85], v114 offset:49152
  ds_read_b64_tr_b16 v[86:87], v114 offset:53248
  v_mfma_f32_16x16x32_bf16 v[52:55], v[156:159], v[16:19], v[52:55]
  ds_read_b64_tr_b16 v[88:89], v115 offset:49152
  ds_read_b64_tr_b16 v[90:91], v115 offset:53248
  v_mfma_f32_16x16x32_bf16 v[56:59], v[160:163], v[4:7], v[120:123]
  ds_read_b64_tr_b16 v[92:93], v116 offset:49152
  ds_read_b64_tr_b16 v[94:95], v116 offset:53248
  v_mfma_f32_16x16x32_bf16 v[56:59], v[164:167], v[8:11], v[56:59]
  ds_read_b64_tr_b16 v[96:97], v117 offset:49152
  ds_read_b64_tr_b16 v[98:99], v117 offset:53248
  v_mfma_f32_16x16x32_bf16 v[56:59], v[168:171], v[12:15], v[56:59]
  ds_read_b64_tr_b16 v[100:101], v118 offset:49152
  ds_read_b64_tr_b16 v[102:103], v118 offset:53248
  v_mfma_f32_16x16x32_bf16 v[56:59], v[172:175], v[16:19], v[56:59]
  ds_read_b64_tr_b16 v[104:105], v119 offset:49152
  ds_read_b64_tr_b16 v[106:107], v119 offset:53248
  ds_read_b64_tr_b16 v[208:209], v112 offset:57344
  ds_read_b64_tr_b16 v[210:211], v112 offset:61440
  v_max3_f32 v132, v52, v53, v54
  v_max_f32 v132, v132, v55
  ds_read_b64_tr_b16 v[212:213], v113 offset:57344
  ds_read_b64_tr_b16 v[214:215], v113 offset:61440
  v_max3_f32 v132, v132, v56, v57
  v_max3_f32 v132, v132, v58, v59
  v_cmp_lt_f32 vcc, s82, v132
  s_cbranch_vccnz L_slow0
L_back0_3:
  v_mfma_f32_16x16x32_bf16 v[60:63], v[176:179], v[4:7], v[120:123]
  ds_read_b64_tr_b16 v[216:217], v114 offset:57344
  ds_read_b64_tr_b16 v[218:219], v114 offset:61440
  v_exp_f32 v52, v52
  v_exp_f32 v53, v53
  v_mfma_f32_16x16x32_bf16 v[64:67], v[192:195], v[4:7], v[120:123]
  ds_read_b64_tr_b16 v[220:221], v115 offset:57344
  ds_read_b64_tr_b16 v[222:223], v115 offset:61440
  v_exp_f32 v54, v54
  v_mfma_f32_16x16x32_bf16 v[60:63], v[180:183], v[8:11], v[60:63]
  ds_read_b64_tr_b16 v[224:225], v116 offset:57344
  ds_read_b64_tr_b16 v[226:227], v116 offset:61440
  v_exp_f32 v55, v55
  v_cvt_pk_bf16_f32 v68, v52, v53
  v_mfma_f32_16x16x32_bf16 v[64:67], v[196:199], v[8:11], v[64:67]
  ds_read_b64_tr_b16 v[228:229], v117 offset:57344
  ds_read_b64_tr_b16 v[230:231], v117 offset:61440
  v_exp_f32 v56, v56
  v_mfma_f32_16x16x32_bf16 v[60:63], v[184:187], v[12:15], v[60:63]
  ds_read_b64_tr_b16 v[232:233], v118 offset:57344
  ds_read_b64_tr_b16 v[234:235], v118 offset:61440
  v_exp_f32 v57, v57
  v_cvt_pk_bf16_f32 v69, v54, v55
  v_mfma_f32_16x16x32_bf16 v[64:67], v[200:203], v[12:15], v[64:67]
  ds_read_b64_tr_b16 v[236:237], v119 offset:57344
  ds_read_b64_tr_b16 v[238:239], v119 offset:61440
  v_exp_f32 v58, v58
  v_mfma_f32_16x16x32_bf16 v[60:63], v[188:191], v[16:19], v[60:63]
  v_exp_f32 v59, v59
  v_cvt_pk_bf16_f32 v70, v56, v57
  v_mfma_f32_16x16x32_bf16 v[64:67], v[204:207], v[16:19], v[64:67]
  v_cvt_pk_bf16_f32 v71, v58, v59
  s_waitcnt lgkmcnt(0)
  v_add_u32 v3, 1, v3
  ds_write_b32 v137, v3
  s_add_u32 s40, s40, 1
  s_cmp_ge_i32 s39, s40
  s_cbranch_scc1 L_go8
  s_mov_b32 s43, 1048576
L_poll8:
  ds_read_b128 v[132:135], v136 offset:0
  s_waitcnt lgkmcnt(0)
  v_min3_u32 v132, v132, v133, v134
  v_min_u32 v132, v132, v135
  s_sub_u32 s43, s43, 1
  v_readfirstlane_b32 s39, v132
  s_cbranch_scc1 L_end
  s_cmp_ge_i32 s39, s40
  s_cbranch_scc1 L_go8
  s_sleep 1
  s_branch L_poll8
L_go8:
  v_max3_f32 v132, v60, v61, v62
  v_max_f32 v132, v132, v63
  s_nop 0
  v_max3_f32 v132, v132, v64, v65
  v_max3_f32 v132, v132, v66, v67
  v_cmp_lt_f32 vcc, s82, v132
  s_cbranch_vccnz L_slow1
L_back1_3:
  v_mfma_f32_16x16x32_bf16 v[128:131], v[124:127], v[68:71], v[128:131]
  s_cmp_ge_u32 s38, 16
  s_cbranch_scc1 L_notog3
  v_xor_b32 v108, 0x10000, v108
  v_xor_b32 v109, 0x10000, v109
  v_xor_b32 v110, 0x10000, v110
  v_xor_b32 v111, 0x10000, v111
  v_xor_b32 v112, 0x10000, v112
  v_xor_b32 v113, 0x10000, v113
  v_xor_b32 v114, 0x10000, v114
  v_xor_b32 v115, 0x10000, v115
  v_xor_b32 v116, 0x10000, v116
  v_xor_b32 v117, 0x10000, v117
  v_xor_b32 v118, 0x10000, v118
  v_xor_b32 v119, 0x10000, v119
L_notog3:
  v_mfma_f32_16x16x32_bf16 v[20:23], v[76:79], v[68:71], v[20:23]
  ds_read_b128 v[144:147], v108 offset:0
  v_exp_f32 v60, v60
  v_exp_f32 v61, v61
  v_mfma_f32_16x16x32_bf16 v[24:27], v[80:83], v[68:71], v[24:27]
  ds_read_b128 v[148:151], v109 offset:0
  v_exp_f32 v62, v62
  v_mfma_f32_16x16x32_bf16 v[28:31], v[84:87], v[68:71], v[28:31]
  ds_read_b128 v[152:155], v110 offset:0
  v_exp_f32 v63, v63
  v_cvt_pk_bf16_f32 v72, v60, v61
  v_mfma_f32_16x16x32_bf16 v[32:35], v[88:91], v[68:71], v[32:35]
  ds_read_b128 v[156:159], v111 offset:0
  v_exp_f32 v64, v64
  v_mfma_f32_16x16x32_bf16 v[36:39], v[92:95], v[68:71], v[36:39]
  ds_read_b128 v[160:163], v108 offset:4096
  v_exp_f32 v65, v65
  v_cvt_pk_bf16_f32 v73, v62, v63
  v_mfma_f32_16x16x32_bf16 v[40:43], v[96:99], v[68:71], v[40:43]
  ds_read_b128 v[164:167], v109 offset:4096
  v_exp_f32 v66, v66
  v_mfma_f32_16x16x32_bf16 v[44:47], v[100:103], v[68:71], v[44:47]
  ds_read_b128 v[168:171], v110 offset:4096
  v_exp_f32 v67, v67
  v_cvt_pk_bf16_f32 v74, v64, v65
  v_mfma_f32_16x16x32_bf16 v[48:51], v[104:107], v[68:71], v[48:51]
  ds_read_b128 v[172:175], v111 offset:4096
  v_cvt_pk_bf16_f32 v75, v66, v67
  s_add_u32 s38, s38, 1
  s_nop 0
  v_mfma_f32_16x16x32_bf16 v[128:131], v[124:127], v[72:75], v[128:131]
  v_mfma_f32_16x16x32_bf16 v[20:23], v[208:211], v[72:75], v[20:23]
  ds_read_b128 v[176:179], v108 offset:8192
  v_mfma_f32_16x16x32_bf16 v[24:27], v[212:215], v[72:75], v[24:27]
  ds_read_b128 v[180:183], v109 offset:8192
  v_mfma_f32_16x16x32_bf16 v[28:31], v[216:219], v[72:75], v[28:31]
  ds_read_b128 v[184:187], v110 offset:8192
  v_mfma_f32_16x16x32_bf16 v[32:35], v[220:223], v[72:75], v[32:35]
  ds_read_b128 v[188:191], v111 offset:8192
  v_mfma_f32_16x16x32_bf16 v[36:39], v[224:227], v[72:75], v[36:39]
  ds_read_b128 v[192:195], v108 offset:12288
  v_mfma_f32_16x16x32_bf16 v[40:43], v[228:231], v[72:75], v[40:43]
  ds_read_b128 v[196:199], v109 offset:12288
  v_mfma_f32_16x16x32_bf16 v[44:47], v[232:235], v[72:75], v[44:47]
  ds_read_b128 v[200:203], v110 offset:12288
  v_mfma_f32_16x16x32_bf16 v[48:51], v[236:239], v[72:75], v[48:51]
  ds_read_b128 v[204:207], v111 offset:12288
  s_waitcnt lgkmcnt(0)
  v_add_u32 v3, 1, v3
  ds_write_b32 v137, v3
  s_cmp_lt_u32 s38, 18
  s_cbranch_scc1 L_estep
  s_mov_b32 s87, 4
  s_add_u32 s40, s40, 1
  s_cmp_ge_i32 s39, s40
  s_cbranch_scc1 L_go9
  s_mov_b32 s43, 1048576
L_poll9:
  ds_read_b128 v[132:135], v136 offset:0
  s_waitcnt lgkmcnt(0)
  v_min3_u32 v132, v132, v133, v134
  v_min_u32 v132, v132, v135
  s_sub_u32 s43, s43, 1
  v_readfirstlane_b32 s39, v132
  s_cbranch_scc1 L_end
  s_cmp_ge_i32 s39, s40
  s_cbranch_scc1 L_go9
  s_sleep 1
  s_branch L_poll9
L_go9:
  v_mfma_f32_16x16x32_bf16 v[52:55], v[144:147], v[4:7], v[120:123]
  ds_read_b64_tr_b16 v[76:77], v112 offset:16384
  ds_read_b64_tr_b16 v[78:79], v112 offset:20480
  v_mfma_f32_16x16x32_bf16 v[52:55], v[148:151], v[8:11], v[52:55]
  ds_read_b64_tr_b16 v[80:81], v113 offset:16384
  ds_read_b64_tr_b16 v[82:83], v113 offset:20480
  v_mfma_f32_16x16x32_bf16 v[52:55], v[152:155], v[12:15], v[52:55]
  ds_read_b64_tr_b16 v[84:85], v114 offset:16384
  ds_read_b64_tr_b16 v[86:87], v114 offset:20480
  v_mfma_f32_16x16x32_bf16 v[52:55], v[156:159], v[16:19], v[52:55]
  ds_read_b64_tr_b16 v[88:89], v115 offset:16384
  ds_read_b64_tr_b16 v[90:91], v115 offset:20480
  v_mfma_f32_16x16x32_bf16 v[56:59], v[160:163], v[4:7], v[120:123]
  ds_read_b64_tr_b16 v[92:93], v116 offset:16384
  ds_read_b64_tr_b16 v[94:95], v116 offset:20480
  v_mfma_f32_16x16x32_bf16 v[56:59], v[164:167], v[8:11], v[56:59]
  ds_read_b64_tr_b16 v[96:97], v117 offset:16384
  ds_read_b64_tr_b16 v[98:99], v117 offset:20480
  v_mfma_f32_16x16x32_bf16 v[56:59], v[168:171], v[12:15], v[56:59]
  ds_read_b64_tr_b16 v[100:101], v118 offset:16384
  ds_read_b64_tr_b16 v[102:103], v118 offset:20480
  v_mfma_f32_16x16x32_bf16 v[56:59], v[172:175], v[16:19], v[56:59]
  ds_read_b64_tr_b16 v[104:105], v119 offset:16384
  ds_read_b64_tr_b16 v[106:107], v119 offset:20480
  ds_read_b64_tr_b16 v[208:209], v112 offset:24576
  ds_read_b64_tr_b16 v[210:211], v112 offset:28672
  v_max3_f32 v132, v52, v53, v54
  v_max_f32 v132, v132, v55
  ds_read_b64_tr_b16 v[212:213], v113 offset:24576
  ds_read_b64_tr_b16 v[214:215], v113 offset:28672
  v_max3_f32 v132, v132, v56, v57
  v_max3_f32 v132, v132, v58, v59
  v_cmp_lt_f32 vcc, s82, v132
  s_cbranch_vccnz L_slow0
L_back0_4:
  v_mfma_f32_16x16x32_bf16 v[60:63], v[176:179], v[4:7], v[120:123]
  ds_read_b64_tr_b16 v[216:217], v114 offset:24576
  ds_read_b64_tr_b16 v[218:219], v114 offset:28672
  v_exp_f32 v52, v52
  v_exp_f32 v53, v53
  v_mfma_f32_16x16x32_bf16 v[64:67], v[192:195], v[4:7], v[120:123]
  ds_read_b64_tr_b16 v[220:221], v115 offset:24576
  ds_read_b64_tr_b16 v[222:223], v115 offset:28672
  v_exp_f32 v54, v54
  v_mfma_f32_16x16x32_bf16 v[60:63], v[180:183], v[8:11], v[60:63]
  ds_read_b64_tr_b16 v[224:225], v116 offset:24576
  ds_read_b64_tr_b16 v[226:227], v116 offset:28672
  v_exp_f32 v55, v55
  v_cvt_pk_bf16_f32 v68, v52, v53
  v_mfma_f32_16x16x32_bf16 v[64:67], v[196:199], v[8:11], v[64:67]
  ds_read_b64_tr_b16 v[228:229], v117 offset:24576
  ds_read_b64_tr_b16 v[230:231], v117 offset:28672
  v_exp_f32 v56, v56
  v_mfma_f32_16x16x32_bf16 v[60:63], v[184:187], v[12:15], v[60:63]
  ds_read_b64_tr_b16 v[232:233], v118 offset:24576
  ds_read_b64_tr_b16 v[234:235], v118 offset:28672
  v_exp_f32 v57, v57
  v_cvt_pk_bf16_f32 v69, v54, v55
  v_mfma_f32_16x16x32_bf16 v[64:67], v[200:203], v[12:15], v[64:67]
  ds_read_b64_tr_b16 v[236:237], v119 offset:24576
  ds_read_b64_tr_b16 v[238:239], v119 offset:28672
  v_exp_f32 v58, v58
  v_mfma_f32_16x16x32_bf16 v[60:63], v[188:191], v[16:19], v[60:63]
  v_exp_f32 v59, v59
  v_cvt_pk_bf16_f32 v70, v56, v57
  v_mfma_f32_16x16x32_bf16 v[64:67], v[204:207], v[16:19], v[64:67]
  v_cvt_pk_bf16_f32 v71, v58, v59
  s_waitcnt lgkmcnt(0)
  v_add_u32 v3, 1, v3
  ds_write_b32 v137, v3
  s_nop 0
  v_max3_f32 v132, v60, v61, v62
  v_max_f32 v132, v132, v63
  s_nop 0
  v_max3_f32 v132, v132, v64, v65
  v_max3_f32 v132, v132, v66, v67
  v_cmp_lt_f32 vcc, s82, v132
  s_cbranch_vccnz L_slow1
L_back1_4:
  v_mfma_f32_16x16x32_bf16 v[128:131], v[124:127], v[68:71], v[128:131]
  v_mfma_f32_16x16x32_bf16 v[20:23], v[76:79], v[68:71], v[20:23]
  v_exp_f32 v60, v60
  v_exp_f32 v61, v61
  v_mfma_f32_16x16x32_bf16 v[24:27], v[80:83], v[68:71], v[24:27]
  v_exp_f32 v62, v62
  v_mfma_f32_16x16x32_bf16 v[28:31], v[84:87], v[68:71], v[28:31]
  v_exp_f32 v63, v63
  v_cvt_pk_bf16_f32 v72, v60, v61
  v_mfma_f32_16x16x32_bf16 v[32:35], v[88:91], v[68:71], v[32:35]
  v_exp_f32 v64, v64
  v_mfma_f32_16x16x32_bf16 v[36:39], v[92:95], v[68:71], v[36:39]
  v_exp_f32 v65, v65
  v_cvt_pk_bf16_f32 v73, v62, v63
  v_mfma_f32_16x16x32_bf16 v[40:43], v[96:99], v[68:71], v[40:43]
  v_exp_f32 v66, v66
  v_mfma_f32_16x16x32_bf16 v[44:47], v[100:103], v[68:71], v[44:47]
  v_exp_f32 v67, v67
  v_cvt_pk_bf16_f32 v74, v64, v65
  v_mfma_f32_16x16x32_bf16 v[48:51], v[104:107], v[68:71], v[48:51]
  v_cvt_pk_bf16_f32 v75, v66, v67
  s_add_u32 s38, s38, 1
  s_nop 0
  v_mfma_f32_16x16x32_bf16 v[128:131], v[124:127], v[72:75], v[128:131]
  v_mfma_f32_16x16x32_bf16 v[20:23], v[208:211], v[72:75], v[20:23]
  v_mfma_f32_16x16x32_bf16 v[24:27], v[212:215], v[72:75], v[24:27]
  v_mfma_f32_16x16x32_bf16 v[28:31], v[216:219], v[72:75], v[28:31]
  v_mfma_f32_16x16x32_bf16 v[32:35], v[220:223], v[72:75], v[32:35]
  v_mfma_f32_16x16x32_bf16 v[36:39], v[224:227], v[72:75], v[36:39]
  v_mfma_f32_16x16x32_bf16 v[40:43], v[228:231], v[72:75], v[40:43]
  v_mfma_f32_16x16x32_bf16 v[44:47], v[232:235], v[72:75], v[44:47]
  v_mfma_f32_16x16x32_bf16 v[48:51], v[236:239], v[72:75], v[48:51]
  s_mov_b32 s87, 0
  s_branch L_step1
.p2align 3
L_step:
  s_add_u32 s40, s40, 1
  s_cmp_ge_i32 s39, s40
  s_cbranch_scc1 L_go10
  s_mov_b32 s43, 1048576
L_poll10:
  ds_read_b128 v[132:135], v136 offset:0
  s_waitcnt lgkmcnt(0)
  v_min3_u32 v132, v132, v133, v134
  v_min_u32 v132, v132, v135
  s_sub_u32 s43, s43, 1
  v_readfirstlane_b32 s39, v132
  s_cbranch_scc1 L_end
  s_cmp_ge_i32 s39, s40
  s_cbranch_scc1 L_go10
  s_sleep 1
  s_branch L_poll10
L_go10:
  ds_read_b128 v[76:79], v108 offset:0
  ds_read_b128 v[80:83], v109 offset:0
  ds_read_b128 v[84:87], v110 offset:0
  ds_read_b128 v[88:91], v111 offset:0
  ds_read_b128 v[92:95], v108 offset:4096
  ds_read_b128 v[96:99], v109 offset:4096
  ds_read_b128 v[100:103], v110 offset:4096
  ds_read_b128 v[104:107], v111 offset:4096
  s_waitcnt lgkmcnt(4)
  v_mfma_f32_16x16x32_bf16 v[52:55], v[76:79], v[4:7], v[120:123]
  v_mfma_f32_16x16x32_bf16 v[52:55], v[80:83], v[8:11], v[52:55]
  v_mfma_f32_16x16x32_bf16 v[52:55], v[84:87], v[12:15], v[52:55]
  v_mfma_f32_16x16x32_bf16 v[52:55], v[88:91], v[16:19], v[52:55]
  s_waitcnt lgkmcnt(0)
  v_mfma_f32_16x16x32_bf16 v[56:59], v[92:95], v[4:7], v[120:123]
  ds_read_b128 v[76:79], v108 offset:8192
  ds_read_b128 v[92:95], v108 offset:12288
  v_mfma_f32_16x16x32_bf16 v[56:59], v[96:99], v[8:11], v[56:59]
  ds_read_b128 v[80:83], v109 offset:8192
  ds_read_b128 v[96:99], v109 offset:12288
  v_mfma_f32_16x16x32_bf16 v[56:59], v[100:103], v[12:15], v[56:59]
  ds_read_b128 v[84:87], v110 offset:8192
  ds_read_b128 v[100:103], v110 offset:12288
  v_mfma_f32_16x16x32_bf16 v[56:59], v[104:107], v[16:19], v[56:59]
  ds_read_b128 v[88:91], v111 offset:8192
  ds_read_b128 v[104:107], v111 offset:12288
  v_max3_f32 v132, v52, v53, v54
  v_max_f32 v132, v132, v55
  s_nop 3
  v_max3_f32 v132, v132, v56, v57
  v_max3_f32 v132, v132, v58, v59
  v_cmp_lt_f32 vcc, s82, v132
  s_cbranch_vccnz L_slow0
L_back0_0:
  s_waitcnt lgkmcnt(4)
  v_mfma_f32_16x16x32_bf16 v[60:63], v[76:79], v[4:7], v[120:123]
  v_exp_f32 v52, v52
  v_exp_f32 v53, v53
  v_mfma_f32_16x16x32_bf16 v[64:67], v[92:95], v[4:7], v[120:123]
  v_exp_f32 v54, v54
  v_mfma_f32_16x16x32_bf16 v[60:63], v[80:83], v[8:11], v[60:63]
  v_exp_f32 v55, v55
  v_cvt_pk_bf16_f32 v68, v52, v53
  v_mfma_f32_16x16x32_bf16 v[64:67], v[96:99], v[8:11], v[64:67]
  v_exp_f32 v56, v56
  s_waitcnt lgkmcnt(0)
  v_add_u32 v3, 1, v3
  ds_write_b32 v137, v3
  v_mfma_f32_16x16x32_bf16 v[60:63], v[84:87], v[12:15], v[60:63]
  v_exp_f32 v57, v57
  v_cvt_pk_bf16_f32 v69, v54, v55
  v_mfma_f32_16x16x32_bf16 v[64:67], v[100:103], v[12:15], v[64:67]
  v_exp_f32 v58, v58
  v_mfma_f32_16x16x32_bf16 v[60:63], v[88:91], v[16:19], v[60:63]
  v_exp_f32 v59, v59
  v_cvt_pk_bf16_f32 v70, v56, v57
  v_mfma_f32_16x16x32_bf16 v[64:67], v[104:107], v[16:19], v[64:67]
  v_cvt_pk_bf16_f32 v71, v58, v59
  s_nop 3
  v_max3_f32 v132, v60, v61, v62
  v_max_f32 v132, v132, v63
  s_nop 0
  v_max3_f32 v132, v132, v64, v65
  v_max3_f32 v132, v132, v66, v67
  v_cmp_lt_f32 vcc, s82, v132
  s_cbranch_vccnz L_slow1
L_back1_0:
  v_mfma_f32_16x16x32_bf16 v[128:131], v[124:127], v[68:71], v[128:131]
  v_exp_f32 v60, v60
  v_exp_f32 v61, v61
  v_exp_f32 v62, v62
  v_exp_f32 v63, v63
  v_cvt_pk_bf16_f32 v72, v60, v61
  v_exp_f32 v64, v64
  v_exp_f32 v65, v65
  v_cvt_pk_bf16_f32 v73, v62, v63
  v_exp_f32 v66, v66
  v_exp_f32 v67, v67
  v_cvt_pk_bf16_f32 v74, v64, v65
  v_cvt_pk_bf16_f32 v75, v66, v67
  s_cmp_eq_u32 s38, s80
  s_cbranch_scc1 L_jobs
L_jobs_done0:
  s_add_u32 s40, s40, 1
  s_cmp_ge_i32 s39, s40
  s_cbranch_scc1 L_go11
  s_mov_b32 s43, 1048576
L_poll11:
  ds_read_b128 v[132:135], v136 offset:0
  s_waitcnt lgkmcnt(0)
  v_min3_u32 v132, v132, v133, v134
  v_min_u32 v132, v132, v135
  s_sub_u32 s43, s43, 1
  v_readfirstlane_b32 s39, v132
  s_cbranch_scc1 L_end
  s_cmp_ge_i32 s39, s40
  s_cbranch_scc1 L_go11
  s_sleep 1
  s_branch L_poll11
L_go11:
  ds_read_b64_tr_b16 v[76:77], v112 offset:16384
  ds_read_b64_tr_b16 v[78:79], v112 offset:20480
  ds_read_b64_tr_b16 v[80:81], v113 offset:16384
  ds_read_b64_tr_b16 v[82:83], v113 offset:20480
  ds_read_b64_tr_b16 v[84:85], v114 offset:16384
  ds_read_b64_tr_b16 v[86:87], v114 offset:20480
  ds_read_b64_tr_b16 v[88:89], v115 offset:16384
  ds_read_b64_tr_b16 v[90:91], v115 offset:20480
  ds_read_b64_tr_b16 v[92:93], v116 offset:16384
  ds_read_b64_tr_b16 v[94:95], v116 offset:20480
  ds_read_b64_tr_b16 v[96:97], v117 offset:16384
  ds_read_b64_tr_b16 v[98:99], v117 offset:20480
  ds_read_b64_tr_b16 v[100:101], v118 offset:16384
  ds_read_b64_tr_b16 v[102:103], v118 offset:20480
  s_waitcnt lgkmcnt(12)
  v_mfma_f32_16x16x32_bf16 v[20:23], v[76:79], v[68:71], v[20:23]
  ds_read_b64_tr_b16 v[104:105], v119 offset:16384
  ds_read_b64_tr_b16 v[106:107], v119 offset:20480
  s_waitcnt lgkmcnt(12)
  v_mfma_f32_16x16x32_bf16 v[24:27], v[80:83], v[68:71], v[24:27]
  ds_read_b64_tr_b16 v[76:77], v112 offset:24576
  ds_read_b64_tr_b16 v[78:79], v112 offset:28672
  s_waitcnt lgkmcnt(12)
  v_mfma_f32_16x16x32_bf16 v[28:31], v[84:87], v[68:71], v[28:31]
  ds_read_b64_tr_b16 v[80:81], v113 offset:24576
  ds_read_b64_tr_b16 v[82:83], v113 offset:28672
  s_waitcnt lgkmcnt(12)
  v_mfma_f32_16x16x32_bf16 v[32:35], v[88:91], v[68:71], v[32:35]
  ds_read_b64_tr_b16 v[84:85], v114 offset:24576
  ds_read_b64_tr_b16 v[86:87], v114 offset:28672
  s_waitcnt lgkmcnt(12)
  v_mfma_f32_16x16x32_bf16 v[36:39], v[92:95], v[68:71], v[36:39]
  ds_read_b64_tr_b16 v[88:89], v115 offset:24576
  ds_read_b64_tr_b16 v[90:91], v115 offset:28672
  s_waitcnt lgkmcnt(12)
  v_mfma_f32_16x16x32_bf16 v[40:43], v[96:99], v[68:71], v[40:43]
  ds_read_b64_tr_b16 v[92:93], v116 offset:24576
  ds_read_b64_tr_b16 v[94:95], v116 offset:28672
  s_waitcnt lgkmcnt(12)
  v_mfma_f32_16x16x32_bf16 v[44:47], v[100:103], v[68:71], v[44:47]
  ds_read_b64_tr_b16 v[96:97], v117 offset:24576
  ds_read_b64_tr_b16 v[98:99], v117 offset:28672
  s_waitcnt lgkmcnt(12)
  v_mfma_f32_16x16x32_bf16 v[48:51], v[104:107], v[68:71], v[48:51]
  ds_read_b64_tr_b16 v[100:101], v118 offset:24576
  ds_read_b64_tr_b16 v[102:103], v118 offset:28672
  s_waitcnt lgkmcnt(12)
  s_add_u32 s38, s38, 1
  v_mfma_f32_16x16x32_bf16 v[20:23], v[76:79], v[72:75], v[20:23]
  ds_read_b64_tr_b16 v[104:105], v119 offset:24576
  ds_read_b64_tr_b16 v[106:107], v119 offset:28672
  v_mfma_f32_16x16x32_bf16 v[128:131], v[124:127], v[72:75], v[128:131]
  s_waitcnt lgkmcnt(10)
  v_mfma_f32_16x16x32_bf16 v[24:27], v[80:83], v[72:75], v[24:27]
  v_mfma_f32_16x16x32_bf16 v[28:31], v[84:87], v[72:75], v[28:31]
  s_waitcnt lgkmcnt(6)
  v_mfma_f32_16x16x32_bf16 v[32:35], v[88:91], v[72:75], v[32:35]
  v_mfma_f32_16x16x32_bf16 v[36:39], v[92:95], v[72:75], v[36:39]
  s_waitcnt lgkmcnt(2)
  v_mfma_f32_16x16x32_bf16 v[40:43], v[96:99], v[72:75], v[40:43]
  v_mfma_f32_16x16x32_bf16 v[44:47], v[100:103], v[72:75], v[44:47]
  s_waitcnt lgkmcnt(0)
  v_add_u32 v3, 1, v3
  ds_write_b32 v137, v3
  v_mfma_f32_16x16x32_bf16 v[48:51], v[104:107], v[72:75], v[48:51]
L_step1:
  s_add_u32 s40, s40, 1
  s_cmp_ge_i32 s39, s40
  s_cbranch_scc1 L_go12
  s_mov_b32 s43, 1048576
L_poll12:
  ds_read_b128 v[132:135], v136 offset:0
  s_waitcnt lgkmcnt(0)
  v_min3_u32 v132, v132, v133, v134
  v_min_u32 v132, v132, v135
  s_sub_u32 s43, s43, 1
  v_readfirstlane_b32 s39, v132
  s_cbranch_scc1 L_end
  s_cmp_ge_i32 s39, s40
  s_cbranch_scc1 L_go12
  s_sleep 1
  s_branch L_poll12
L_go12:
  ds_read_b128 v[76:79], v108 offset:32768
  ds_read_b128 v[80:83], v109 offset:32768
  ds_read_b128 v[84:87], v110 offset:32768
  ds_read_b128 v[88:91], v111 offset:32768
  ds_read_b128 v[92:95], v108 offset:36864
  ds_read_b128 v[96:99], v109 offset:36864
  ds_read_b128 v[100:103], v110 offset:36864
  ds_read_b128 v[104:107], v111 offset:36864
  s_waitcnt lgkmcnt(4)
  v_mfma_f32_16x16x32_bf16 v[52:55], v[76:79], v[4:7], v[120:123]
  v_mfma_f32_16x16x32_bf16 v[52:55], v[80:83], v[8:11], v[52:55]
  v_mfma_f32_16x16x32_bf16 v[52:55], v[84:87], v[12:15], v[52:55]
  v_mfma_f32_16x16x32_bf16 v[52:55], v[88:91], v[16:19], v[52:55]
  s_waitcnt lgkmcnt(0)
  v_mfma_f32_16x16x32_bf16 v[56:59], v[92:95], v[4:7], v[120:123]
  ds_read_b128 v[76:79], v108 offset:40960
  ds_read_b128 v[92:95], v108 offset:45056
  v_mfma_f32_16x16x32_bf16 v[56:59], v[96:99], v[8:11], v[56:59]
  ds_read_b128 v[80:83], v109 offset:40960
  ds_read_b128 v[96:99], v109 offset:45056
  v_mfma_f32_16x16x32_bf16 v[56:59], v[100:103], v[12:15], v[56:59]
  ds_read_b128 v[84:87], v110 offset:40960
  ds_read_b128 v[100:103], v110 offset:45056
  v_mfma_f32_16x16x32_bf16 v[56:59], v[104:107], v[16:19], v[56:59]
  ds_read_b128 v[88:91], v111 offset:40960
  ds_read_b128 v[104:107], v111 offset:45056
  v_max3_f32 v132, v52, v53, v54
  v_max_f32 v132, v132, v55
  s_nop 3
  v_max3_f32 v132, v132, v56, v57
  v_max3_f32 v132, v132, v58, v59
  v_cmp_lt_f32 vcc, s82, v132
  s_cbranch_vccnz L_slow0
L_back0_1:
  s_waitcnt lgkmcnt(4)
  v_mfma_f32_16x16x32_bf16 v[60:63], v[76:79], v[4:7], v[120:123]
  v_exp_f32 v52, v52
  v_exp_f32 v53, v53
  v_mfma_f32_16x16x32_bf16 v[64:67], v[92:95], v[4:7], v[120:123]
  v_exp_f32 v54, v54
  v_mfma_f32_16x16x32_bf16 v[60:63], v[80:83], v[8:11], v[60:63]
  v_exp_f32 v55, v55
  v_cvt_pk_bf16_f32 v68, v52, v53
  v_mfma_f32_16x16x32_bf16 v[64:67], v[96:99], v[8:11], v[64:67]
  v_exp_f32 v56, v56
  s_waitcnt lgkmcnt(0)
  v_add_u32 v3, 1, v3
  ds_write_b32 v137, v3
  v_mfma_f32_16x16x32_bf16 v[60:63], v[84:87], v[12:15], v[60:63]
  v_exp_f32 v57, v57
  v_cvt_pk_bf16_f32 v69, v54, v55
  v_mfma_f32_16x16x32_bf16 v[64:67], v[100:103], v[12:15], v[64:67]
  v_exp_f32 v58, v58
  v_mfma_f32_16x16x32_bf16 v[60:63], v[88:91], v[16:19], v[60:63]
  v_exp_f32 v59, v59
  v_cvt_pk_bf16_f32 v70, v56, v57
  v_mfma_f32_16x16x32_bf16 v[64:67], v[104:107], v[16:19], v[64:67]
  v_cvt_pk_bf16_f32 v71, v58, v59
  s_nop 3
  v_max3_f32 v132, v60, v61, v62
  v_max_f32 v132, v132, v63
  s_nop 0
  v_max3_f32 v132, v132, v64, v65
  v_max3_f32 v132, v132, v66, v67
  v_cmp_lt_f32 vcc, s82, v132
  s_cbranch_vccnz L_slow1
L_back1_1:
  v_mfma_f32_16x16x32_bf16 v[128:131], v[124:127], v[68:71], v[128:131]
  v_exp_f32 v60, v60
  v_exp_f32 v61, v61
  v_exp_f32 v62, v62
  v_exp_f32 v63, v63
  v_cvt_pk_bf16_f32 v72, v60, v61
  v_exp_f32 v64, v64
  v_exp_f32 v65, v65
  v_cvt_pk_bf16_f32 v73, v62, v63
  v_exp_f32 v66, v66
  v_exp_f32 v67, v67
  v_cvt_pk_bf16_f32 v74, v64, v65
  v_cvt_pk_bf16_f32 v75, v66, v67
  s_cmp_eq_u32 s38, s80
  s_cbranch_scc1 L_jobs
L_jobs_done1:
  s_add_u32 s40, s40, 1
  s_cmp_ge_i32 s39, s40
  s_cbranch_scc1 L_go13
  s_mov_b32 s43, 1048576
L_poll13:
  ds_read_b128 v[132:135], v136 offset:0
  s_waitcnt lgkmcnt(0)
  v_min3_u32 v132, v132, v133, v134
  v_min_u32 v132, v132, v135
  s_sub_u32 s43, s43, 1
  v_readfirstlane_b32 s39, v132
  s_cbranch_scc1 L_end
  s_cmp_ge_i32 s39, s40
  s_cbranch_scc1 L_go13
  s_sleep 1
  s_branch L_poll13
L_go13:
  ds_read_b64_tr_b16 v[76:77], v112 offset:49152
  ds_read_b64_tr_b16 v[78:79], v112 offset:53248
  ds_read_b64_tr_b16 v[80:81], v113 offset:49152
  ds_read_b64_tr_b16 v[82:83], v113 offset:53248
  ds_read_b64_tr_b16 v[84:85], v114 offset:49152
  ds_read_b64_tr_b16 v[86:87], v114 offset:53248
  ds_read_b64_tr_b16 v[88:89], v115 offset:49152
  ds_read_b64_tr_b16 v[90:91], v115 offset:53248
  ds_read_b64_tr_b16 v[92:93], v116 offset:49152
  ds_read_b64_tr_b16 v[94:95], v116 offset:53248
  ds_read_b64_tr_b16 v[96:97], v117 offset:49152
  ds_read_b64_tr_b16 v[98:99], v117 offset:53248
  ds_read_b64_tr_b16 v[100:101], v118 offset:49152
  ds_read_b64_tr_b16 v[102:103], v118 offset:53248
  s_waitcnt lgkmcnt(12)
  v_mfma_f32_16x16x32_bf16 v[20:23], v[76:79], v[68:71], v[20:23]
  ds_read_b64_tr_b16 v[104:105], v119 offset:49152
  ds_read_b64_tr_b16 v[106:107], v119 offset:53248
  s_waitcnt lgkmcnt(12)
  v_mfma_f32_16x16x32_bf16 v[24:27], v[80:83], v[68:71], v[24:27]
  ds_read_b64_tr_b16 v[76:77], v112 offset:57344
  ds_read_b64_tr_b16 v[78:79], v112 offset:61440
  s_waitcnt lgkmcnt(12)
  v_mfma_f32_16x16x32_bf16 v[28:31], v[84:87], v[68:71], v[28:31]
  ds_read_b64_tr_b16 v[80:81], v113 offset:57344
  ds_read_b64_tr_b16 v[82:83], v113 offset:61440
  s_waitcnt lgkmcnt(12)
  v_mfma_f32_16x16x32_bf16 v[32:35], v[88:91], v[68:71], v[32:35]
  ds_read_b64_tr_b16 v[84:85], v114 offset:57344
  ds_read_b64_tr_b16 v[86:87], v114 offset:61440
  s_waitcnt lgkmcnt(12)
  v_mfma_f32_16x16x32_bf16 v[36:39], v[92:95], v[68:71], v[36:39]
  ds_read_b64_tr_b16 v[88:89], v115 offset:57344
  ds_read_b64_tr_b16 v[90:91], v115 offset:61440
  s_waitcnt lgkmcnt(12)
  v_mfma_f32_16x16x32_bf16 v[40:43], v[96:99], v[68:71], v[40:43]
  ds_read_b64_tr_b16 v[92:93], v116 offset:57344
  ds_read_b64_tr_b16 v[94:95], v116 offset:61440
  s_waitcnt lgkmcnt(12)
  v_mfma_f32_16x16x32_bf16 v[44:47], v[100:103], v[68:71], v[44:47]
  ds_read_b64_tr_b16 v[96:97], v117 offset:57344
  ds_read_b64_tr_b16 v[98:99], v117 offset:61440
  s_waitcnt lgkmcnt(12)
  v_mfma_f32_16x16x32_bf16 v[48:51], v[104:107], v[68:71], v[48:51]
  ds_read_b64_tr_b16 v[100:101], v118 offset:57344
  ds_read_b64_tr_b16 v[102:103], v118 offset:61440
  s_waitcnt lgkmcnt(12)
  s_add_u32 s38, s38, 1
  v_mfma_f32_16x16x32_bf16 v[20:23], v[76:79], v[72:75], v[20:23]
  ds_read_b64_tr_b16 v[104:105], v119 offset:57344
  ds_read_b64_tr_b16 v[106:107], v119 offset:61440
  v_mfma_f32_16x16x32_bf16 v[128:131], v[124:127], v[72:75], v[128:131]
  s_waitcnt lgkmcnt(10)
  v_mfma_f32_16x16x32_bf16 v[24:27], v[80:83], v[72:75], v[24:27]
  v_mfma_f32_16x16x32_bf16 v[28:31], v[84:87], v[72:75], v[28:31]
  s_waitcnt lgkmcnt(6)
  v_mfma_f32_16x16x32_bf16 v[32:35], v[88:91], v[72:75], v[32:35]
  v_mfma_f32_16x16x32_bf16 v[36:39], v[92:95], v[72:75], v[36:39]
  s_waitcnt lgkmcnt(2)
  v_mfma_f32_16x16x32_bf16 v[40:43], v[96:99], v[72:75], v[40:43]
  v_mfma_f32_16x16x32_bf16 v[44:47], v[100:103], v[72:75], v[44:47]
  s_waitcnt lgkmcnt(0)
  v_add_u32 v3, 1, v3
  ds_write_b32 v137, v3
  v_mfma_f32_16x16x32_bf16 v[48:51], v[104:107], v[72:75], v[48:51]
  s_cmp_gt_u32 s38, 16
  s_cbranch_scc1 L_notog
  v_xor_b32 v108, 0x10000, v108
  v_xor_b32 v109, 0x10000, v109
  v_xor_b32 v110, 0x10000, v110
  v_xor_b32 v111, 0x10000, v111
  v_xor_b32 v112, 0x10000, v112
  v_xor_b32 v113, 0x10000, v113
  v_xor_b32 v114, 0x10000, v114
  v_xor_b32 v115, 0x10000, v115
  v_xor_b32 v116, 0x10000, v116
  v_xor_b32 v117, 0x10000, v117
  v_xor_b32 v118, 0x10000, v118
  v_xor_b32 v119, 0x10000, v119
L_notog:
  s_cmp_lt_u32 s38, 32
  s_cbranch_scc1 L_step
  v_rcp_f32 v134, v128
  s_lshl_b32 s34, s3, 12
  v_add_u32 v108, s34, v1
  ds_read_b64_tr_b16 v[76:77], v140 offset:0
  ds_read_b64_tr_b16 v[78:79], v140 offset:2048
  ds_read_b64_tr_b16 v[80:81], v141 offset:0
  ds_read_b64_tr_b16 v[82:83], v141 offset:2048
  ds_read_b64_tr_b16 v[84:85], v142 offset:0
  ds_read_b64_tr_b16 v[86:87], v142 offset:2048
  ds_read_b64_tr_b16 v[88:89], v143 offset:0
  ds_read_b64_tr_b16 v[90:91], v143 offset:2048
  v_pk_mul_f32 v[20:21], v[20:21], v[134:135] op_sel_hi:[1,0]
  v_pk_mul_f32 v[22:23], v[22:23], v[134:135] op_sel_hi:[1,0]
  v_pk_mul_f32 v[24:25], v[24:25], v[134:135] op_sel_hi:[1,0]
  v_pk_mul_f32 v[26:27], v[26:27], v[134:135] op_sel_hi:[1,0]
  v_cvt_pk_bf16_f32 v52, v20, v21
  v_cvt_pk_bf16_f32 v53, v22, v23
  v_cvt_pk_bf16_f32 v54, v24, v25
  v_cvt_pk_bf16_f32 v55, v26, v27
  ds_write_b128 v108, v[52:55] offset:0
  v_pk_mul_f32 v[28:29], v[28:29], v[134:135] op_sel_hi:[1,0]
  v_pk_mul_f32 v[30:31], v[30:31], v[134:135] op_sel_hi:[1,0]
  v_pk_mul_f32 v[32:33], v[32:33], v[134:135] op_sel_hi:[1,0]
  v_pk_mul_f32 v[34:35], v[34:35], v[134:135] op_sel_hi:[1,0]
  v_cvt_pk_bf16_f32 v56, v28, v29
  v_cvt_pk_bf16_f32 v57, v30, v31
  v_cvt_pk_bf16_f32 v58, v32, v33
  v_cvt_pk_bf16_f32 v59, v34, v35
  ds_write_b128 v108, v[56:59] offset:1024
  v_pk_mul_f32 v[36:37], v[36:37], v[134:135] op_sel_hi:[1,0]
  v_pk_mul_f32 v[38:39], v[38:39], v[134:135] op_sel_hi:[1,0]
  v_pk_mul_f32 v[40:41], v[40:41], v[134:135] op_sel_hi:[1,0]
  v_pk_mul_f32 v[42:43], v[42:43], v[134:135] op_sel_hi:[1,0]
  v_cvt_pk_bf16_f32 v60, v36, v37
  v_cvt_pk_bf16_f32 v61, v38, v39
  v_cvt_pk_bf16_f32 v62, v40, v41
  v_cvt_pk_bf16_f32 v63, v42, v43
  ds_write_b128 v108, v[60:63] offset:2048
  v_pk_mul_f32 v[44:45], v[44:45], v[134:135] op_sel_hi:[1,0]
  v_pk_mul_f32 v[46:47], v[46:47], v[134:135] op_sel_hi:[1,0]
  v_pk_mul_f32 v[48:49], v[48:49], v[134:135] op_sel_hi:[1,0]
  v_pk_mul_f32 v[50:51], v[50:51], v[134:135] op_sel_hi:[1,0]
  v_cvt_pk_bf16_f32 v64, v44, v45
  v_cvt_pk_bf16_f32 v65, v46, v47
  v_cvt_pk_bf16_f32 v66, v48, v49
  v_cvt_pk_bf16_f32 v67, v50, v51
  ds_write_b128 v108, v[64:67] offset:3072
  s_nop 0
  v_mfma_f32_16x16x32_bf16 v[36:39], v[144:147], v[52:55], 0
  v_xor_b32 v113, 4096, v108
  v_xor_b32 v114, 8192, v108
  v_mfma_f32_16x16x32_bf16 v[40:43], v[148:151], v[52:55], 0
  v_xor_b32 v115, 12288, v108
  s_lshl_b32 s35, s3, 12
  v_mfma_f32_16x16x32_bf16 v[44:47], v[152:155], v[52:55], 0
  s_add_u32 s35, s35, 49152
  v_mfma_f32_16x16x32_bf16 v[48:51], v[156:159], v[52:55], 0
  v_mfma_f32_16x16x32_bf16 v[36:39], v[160:163], v[56:59], v[36:39]
  v_mfma_f32_16x16x32_bf16 v[40:43], v[164:167], v[56:59], v[40:43]
  v_mfma_f32_16x16x32_bf16 v[44:47], v[168:171], v[56:59], v[44:47]
  v_mfma_f32_16x16x32_bf16 v[48:51], v[172:175], v[56:59], v[48:51]
  v_mfma_f32_16x16x32_bf16 v[36:39], v[176:179], v[60:63], v[36:39]
  v_mfma_f32_16x16x32_bf16 v[40:43], v[180:183], v[60:63], v[40:43]
  v_mfma_f32_16x16x32_bf16 v[44:47], v[184:187], v[60:63], v[44:47]
  v_mfma_f32_16x16x32_bf16 v[48:51], v[188:191], v[60:63], v[48:51]
  v_mfma_f32_16x16x32_bf16 v[36:39], v[192:195], v[64:67], v[36:39]
  v_mfma_f32_16x16x32_bf16 v[40:43], v[196:199], v[64:67], v[40:43]
  v_mfma_f32_16x16x32_bf16 v[44:47], v[200:203], v[64:67], v[44:47]
  v_mfma_f32_16x16x32_bf16 v[48:51], v[204:207], v[64:67], v[48:51]
  s_waitcnt lgkmcnt(0)
  s_barrier
  ds_read_b128 v[72:75], v113 offset:0
  ds_read_b128 v[120:123], v113 offset:1024
  ds_read_b64_tr_b16 v[92:93], v140 offset:4096
  ds_read_b64_tr_b16 v[94:95], v140 offset:6144
  ds_read_b64_tr_b16 v[96:97], v141 offset:4096
  ds_read_b64_tr_b16 v[98:99], v141 offset:6144
  ds_read_b64_tr_b16 v[100:101], v142 offset:4096
  ds_read_b64_tr_b16 v[102:103], v142 offset:6144
  ds_read_b64_tr_b16 v[104:105], v143 offset:4096
  ds_read_b64_tr_b16 v[106:107], v143 offset:6144
  ds_read_b64_tr_b16 v[20:21], v140 offset:12288
  ds_read_b64_tr_b16 v[22:23], v140 offset:14336
  ds_read_b64_tr_b16 v[24:25], v141 offset:12288
  ds_read_b64_tr_b16 v[26:27], v141 offset:14336
  ds_read_b64_tr_b16 v[28:29], v142 offset:12288
  ds_read_b64_tr_b16 v[30:31], v142 offset:14336
  ds_read_b64_tr_b16 v[32:33], v143 offset:12288
  ds_read_b64_tr_b16 v[34:35], v143 offset:14336
  s_xor_b32 s61, s50, 393216
  s_add_u32 m0, s52, 0
  s_add_u32 s37, s61, 14336
  buffer_load_dwordx4 v138, s[28:31], s61 offen offset:0 lds
  buffer_load_dwordx4 v139, s[28:31], s61 offen offset:1024 lds
  buffer_load_dwordx4 v138, s[28:31], s37 offen offset:2048 lds
  buffer_load_dwordx4 v139, s[28:31], s37 offen offset:3072 lds
  s_xor_b32 s61, s50, 425984
  s_add_u32 m0, s35, 0
  s_add_u32 s37, s61, 14336
  buffer_load_dwordx4 v138, s[28:31], s61 offen offset:0 lds
  buffer_load_dwordx4 v139, s[28:31], s61 offen offset:1024 lds
  buffer_load_dwordx4 v138, s[28:31], s37 offen offset:2048 lds
  buffer_load_dwordx4 v139, s[28:31], s37 offen offset:3072 lds
  s_waitcnt lgkmcnt(0)
  s_xor_b32 s61, s50, 458752
  s_add_u32 m0, s52, 4096
  s_add_u32 s37, s61, 14336
  buffer_load_dwordx4 v138, s[28:31], s61 offen offset:0 lds
  buffer_load_dwordx4 v139, s[28:31], s61 offen offset:1024 lds
  buffer_load_dwordx4 v138, s[28:31], s37 offen offset:2048 lds
  buffer_load_dwordx4 v139, s[28:31], s37 offen offset:3072 lds
  s_xor_b32 s61, s50, 491520
  s_add_u32 m0, s52, 12288
  s_add_u32 s37, s61, 14336
  buffer_load_dwordx4 v138, s[28:31], s61 offen offset:0 lds
  buffer_load_dwordx4 v139, s[28:31], s61 offen offset:1024 lds
  buffer_load_dwordx4 v138, s[28:31], s37 offen offset:2048 lds
  buffer_load_dwordx4 v139, s[28:31], s37 offen offset:3072 lds
  ds_read_b128 v[68:71], v113 offset:2048
  v_mfma_f32_16x16x32_bf16 v[36:39], v[208:211], v[72:75], v[36:39]
  s_mul_i32 s34, s3, 16384
  s_mul_i32 s36, s33, 2048
  v_mfma_f32_16x16x32_bf16 v[40:43], v[212:215], v[72:75], v[40:43]
  s_add_u32 s34, s34, s36
  v_lshl_add_u32 v112, v0, 4, s34
  v_mfma_f32_16x16x32_bf16 v[44:47], v[216:219], v[72:75], v[44:47]
  s_mul_i32 s34, s3, 256
  s_lshl_b32 s36, s33, 3
  v_mfma_f32_16x16x32_bf16 v[48:51], v[220:223], v[72:75], v[48:51]
  s_add_u32 s34, s34, s36
  v_mov_b32 v108, s34
  v_mov_b32 v110, s94
  v_mov_b32 v111, s95
  ds_read_b128 v[72:75], v113 offset:3072
  v_mfma_f32_16x16x32_bf16 v[36:39], v[224:227], v[120:123], v[36:39]
  s_mul_i32 s34, s33, 256
  v_and_b32 v109, 7, v0
  v_mfma_f32_16x16x32_bf16 v[40:43], v[228:231], v[120:123], v[40:43]
  v_lshl_add_u32 v109, v109, 3, s34
  s_sub_u32 s35, s35, s52
  v_mfma_f32_16x16x32_bf16 v[44:47], v[232:235], v[120:123], v[44:47]
  v_add_u32 v116, s35, v140
  v_add_u32 v117, s35, v141
  v_mfma_f32_16x16x32_bf16 v[48:51], v[236:239], v[120:123], v[48:51]
  v_add_u32 v118, s35, v142
  v_add_u32 v119, s35, v143
  ds_read_b128 v[120:123], v114 offset:0
  s_waitcnt lgkmcnt(2)
  v_mfma_f32_16x16x32_bf16 v[36:39], v[240:243], v[68:71], v[36:39]
  s_lshl_b32 s34, s32, 14
  s_lshl_b32 s36, s33, 7
  v_mfma_f32_16x16x32_bf16 v[40:43], v[244:247], v[68:71], v[40:43]
  s_add_u32 s34, s34, s36
  s_lshl_b32 s36, s3, 5
  v_mfma_f32_16x16x32_bf16 v[44:47], v[248:251], v[68:71], v[44:47]
  s_add_u32 s34, s34, s36
  v_lshrrev_b32 v132, 4, v0
  v_mfma_f32_16x16x32_bf16 v[48:51], v[252:255], v[68:71], v[48:51]
  v_and_b32 v133, 15, v0
  v_lshlrev_b32 v132, 3, v132
  v_lshl_add_u32 v132, v133, 10, v132
  v_add_u32 v132, s34, v132
  ds_read_b128 v[68:71], v114 offset:1024
  s_waitcnt lgkmcnt(2)
  v_mfma_f32_16x16x32_bf16 v[36:39], v[76:79], v[72:75], v[36:39]
  s_mul_i32 s34, s33, 16384
  s_lshr_b32 s36, s3, 1
  v_mfma_f32_16x16x32_bf16 v[40:43], v[80:83], v[72:75], v[40:43]
  s_lshl_b32 s36, s36, 10
  s_add_u32 s34, s34, s36
  v_mfma_f32_16x16x32_bf16 v[44:47], v[84:87], v[72:75], v[44:47]
  s_and_b32 s36, s3, 1
  s_lshl_b32 s36, s36, 3
  v_mfma_f32_16x16x32_bf16 v[48:51], v[88:91], v[72:75], v[48:51]
  s_add_u32 s34, s34, s36
  v_lshl_add_u32 v124, v0, 4, s34
  v_add_u32 v125, 2048, v124
  v_add_u32 v126, 4096, v124
  v_add_u32 v127, 6144, v124
  v_add_u32 v128, 8192, v124
  v_add_u32 v129, 10240, v124
  v_add_u32 v130, 12288, v124
  v_add_u32 v131, 14336, v124
  ds_read_b128 v[72:75], v114 offset:2048
  s_waitcnt lgkmcnt(2)
  v_mfma_f32_16x16x32_bf16 v[36:39], v[92:95], v[120:123], v[36:39]
  v_mfma_f32_16x16x32_bf16 v[40:43], v[96:99], v[120:123], v[40:43]
  v_mfma_f32_16x16x32_bf16 v[44:47], v[100:103], v[120:123], v[44:47]
  v_mfma_f32_16x16x32_bf16 v[48:51], v[104:107], v[120:123], v[48:51]
  ds_read_b128 v[120:123], v114 offset:3072
  s_waitcnt lgkmcnt(2)
  v_mfma_f32_16x16x32_bf16 v[36:39], v[4:7], v[68:71], v[36:39]
  v_mfma_f32_16x16x32_bf16 v[40:43], v[8:11], v[68:71], v[40:43]
  v_mfma_f32_16x16x32_bf16 v[44:47], v[12:15], v[68:71], v[44:47]
  v_mfma_f32_16x16x32_bf16 v[48:51], v[16:19], v[68:71], v[48:51]
  s_waitcnt vmcnt(16)
  ds_read_b64_tr_b16 v[144:145], v140 offset:8192
  ds_read_b64_tr_b16 v[146:147], v140 offset:10240
  ds_read_b64_tr_b16 v[148:149], v141 offset:8192
  ds_read_b64_tr_b16 v[150:151], v141 offset:10240
  ds_read_b64_tr_b16 v[152:153], v142 offset:8192
  ds_read_b64_tr_b16 v[154:155], v142 offset:10240
  ds_read_b64_tr_b16 v[156:157], v143 offset:8192
  ds_read_b64_tr_b16 v[158:159], v143 offset:10240
  ds_read_b128 v[68:71], v115 offset:0
  s_waitcnt lgkmcnt(10)
  v_mfma_f32_16x16x32_bf16 v[36:39], v[20:23], v[72:75], v[36:39]
  v_mfma_f32_16x16x32_bf16 v[40:43], v[24:27], v[72:75], v[40:43]
  v_mfma_f32_16x16x32_bf16 v[44:47], v[28:31], v[72:75], v[44:47]
  v_mfma_f32_16x16x32_bf16 v[48:51], v[32:35], v[72:75], v[48:51]
  s_waitcnt vmcnt(12)
  ds_read_b64_tr_b16 v[160:161], v140 offset:0
  ds_read_b64_tr_b16 v[162:163], v140 offset:2048
  ds_read_b64_tr_b16 v[164:165], v141 offset:0
  ds_read_b64_tr_b16 v[166:167], v141 offset:2048
  ds_read_b64_tr_b16 v[168:169], v142 offset:0
  ds_read_b64_tr_b16 v[170:171], v142 offset:2048
  ds_read_b64_tr_b16 v[172:173], v143 offset:0
  ds_read_b64_tr_b16 v[174:175], v143 offset:2048
  ds_read_b128 v[72:75], v115 offset:1024
  s_waitcnt lgkmcnt(10)
  v_mfma_f32_16x16x32_bf16 v[36:39], v[144:147], v[120:123], v[36:39]
  v_mfma_f32_16x16x32_bf16 v[40:43], v[148:151], v[120:123], v[40:43]
  v_mfma_f32_16x16x32_bf16 v[44:47], v[152:155], v[120:123], v[44:47]
  v_mfma_f32_16x16x32_bf16 v[48:51], v[156:159], v[120:123], v[48:51]
  s_waitcnt vmcnt(8)
  ds_read_b64_tr_b16 v[176:177], v116 offset:0
  ds_read_b64_tr_b16 v[178:179], v116 offset:2048
  ds_read_b64_tr_b16 v[180:181], v117 offset:0
  ds_read_b64_tr_b16 v[182:183], v117 offset:2048
  ds_read_b64_tr_b16 v[184:185], v118 offset:0
  ds_read_b64_tr_b16 v[186:187], v118 offset:2048
  ds_read_b64_tr_b16 v[188:189], v119 offset:0
  ds_read_b64_tr_b16 v[190:191], v119 offset:2048
  ds_read_b128 v[120:123], v115 offset:2048
  s_waitcnt lgkmcnt(10)
  v_mfma_f32_16x16x32_bf16 v[36:39], v[160:163], v[68:71], v[36:39]
  v_mfma_f32_16x16x32_bf16 v[40:43], v[164:167], v[68:71], v[40:43]
  v_mfma_f32_16x16x32_bf16 v[44:47], v[168:171], v[68:71], v[44:47]
  v_mfma_f32_16x16x32_bf16 v[48:51], v[172:175], v[68:71], v[48:51]
  s_waitcnt vmcnt(4)
  ds_read_b64_tr_b16 v[192:193], v140 offset:4096
  ds_read_b64_tr_b16 v[194:195], v140 offset:6144
  ds_read_b64_tr_b16 v[196:197], v141 offset:4096
  ds_read_b64_tr_b16 v[198:199], v141 offset:6144
  ds_read_b64_tr_b16 v[200:201], v142 offset:4096
  ds_read_b64_tr_b16 v[202:203], v142 offset:6144
  ds_read_b64_tr_b16 v[204:205], v143 offset:4096
  ds_read_b64_tr_b16 v[206:207], v143 offset:6144
  ds_read_b128 v[68:71], v115 offset:3072
  s_waitcnt lgkmcnt(10)
  v_mfma_f32_16x16x32_bf16 v[36:39], v[176:179], v[72:75], v[36:39]
  v_mfma_f32_16x16x32_bf16 v[40:43], v[180:183], v[72:75], v[40:43]
  v_mfma_f32_16x16x32_bf16 v[44:47], v[184:187], v[72:75], v[44:47]
  v_mfma_f32_16x16x32_bf16 v[48:51], v[188:191], v[72:75], v[48:51]
  s_waitcnt vmcnt(0)
  ds_read_b64_tr_b16 v[208:209], v140 offset:12288
  ds_read_b64_tr_b16 v[210:211], v140 offset:14336
  ds_read_b64_tr_b16 v[212:213], v141 offset:12288
  ds_read_b64_tr_b16 v[214:215], v141 offset:14336
  ds_read_b64_tr_b16 v[216:217], v142 offset:12288
  ds_read_b64_tr_b16 v[218:219], v142 offset:14336
  ds_read_b64_tr_b16 v[220:221], v143 offset:12288
  ds_read_b64_tr_b16 v[222:223], v143 offset:14336
  s_waitcnt lgkmcnt(9)
  v_mfma_f32_16x16x32_bf16 v[36:39], v[192:195], v[120:123], v[36:39]
  v_mfma_f32_16x16x32_bf16 v[40:43], v[196:199], v[120:123], v[40:43]
  v_mfma_f32_16x16x32_bf16 v[44:47], v[200:203], v[120:123], v[44:47]
  v_mfma_f32_16x16x32_bf16 v[48:51], v[204:207], v[120:123], v[48:51]
  s_waitcnt lgkmcnt(0)
  v_mfma_f32_16x16x32_bf16 v[36:39], v[208:211], v[68:71], v[36:39]
  v_mfma_f32_16x16x32_bf16 v[40:43], v[212:215], v[68:71], v[40:43]
  v_mfma_f32_16x16x32_bf16 v[44:47], v[216:219], v[68:71], v[44:47]
  v_mfma_f32_16x16x32_bf16 v[48:51], v[220:223], v[68:71], v[48:51]
  s_nop 4
  v_cvt_pk_bf16_f32 v76, v36, v37
  v_cvt_pk_bf16_f32 v77, v38, v39
  v_cvt_pk_bf16_f32 v78, v40, v41
  v_cvt_pk_bf16_f32 v79, v42, v43
  global_store_dwordx4 v112, v[76:79], s[54:55] offset:0 sc1
  v_cvt_pk_bf16_f32 v80, v44, v45
  v_cvt_pk_bf16_f32 v81, v46, v47
  v_cvt_pk_bf16_f32 v82, v48, v49
  v_cvt_pk_bf16_f32 v83, v50, v51
  global_store_dwordx4 v112, v[80:83], s[54:55] offset:1024 sc1
  s_mov_b64 exec, 1
  s_waitcnt vmcnt(0)
  global_store_dwordx2 v108, v[110:111], s[56:57] sc1
  s_mov_b64 exec, -1
  s_mov_b32 s43, 1048576
  s_cmp_lg_u32 s3, 0
  s_cbranch_scc1 L_fok
  global_load_dwordx2 v[8:9], v109, s[56:57] sc1
  s_sleep 4
L_fp:
  global_load_dwordx2 v[4:5], v109, s[56:57] sc1
  s_sub_u32 s43, s43, 1
  s_cbranch_scc1 L_end
  s_waitcnt vmcnt(1)
  v_subrev_co_u32 v8, vcc, s92, v8
  v_mov_b32 v10, s93
  s_nop 0
  v_subb_co_u32 v9, vcc, v9, v10, vcc
  v_lshrrev_b32 v8, 24, v8
  v_or_b32 v8, v8, v9
  v_cmp_ne_u32 vcc, 0, v8
  s_cbranch_vccz L_fok
  global_load_dwordx2 v[8:9], v109, s[56:57] sc1
  s_waitcnt vmcnt(1)
  v_subrev_co_u32 v4, vcc, s92, v4
  v_mov_b32 v6, s93
  s_nop 0
  v_subb_co_u32 v5, vcc, v5, v6, vcc
  v_lshrrev_b32 v4, 24, v4
  v_or_b32 v4, v4, v5
  v_cmp_ne_u32 vcc, 0, v4
  s_cbranch_vccnz L_fp
L_fok:
  s_barrier
  global_load_dwordx2 v[76:77], v124, s[54:55] sc1
  global_load_dwordx2 v[78:79], v125, s[54:55] sc1
  global_load_dwordx2 v[80:81], v126, s[54:55] sc1
  global_load_dwordx2 v[82:83], v127, s[54:55] sc1
  global_load_dwordx2 v[84:85], v128, s[54:55] sc1
  global_load_dwordx2 v[86:87], v129, s[54:55] sc1
  global_load_dwordx2 v[88:89], v130, s[54:55] sc1
  global_load_dwordx2 v[90:91], v131, s[54:55] sc1
  s_waitcnt vmcnt(7)
  v_lshlrev_b32 v52, 16, v76
  v_and_b32 v53, 0xffff0000, v76
  v_lshlrev_b32 v54, 16, v77
  v_and_b32 v55, 0xffff0000, v77
  s_waitcnt vmcnt(6)
  v_lshlrev_b32 v56, 16, v78
  v_and_b32 v57, 0xffff0000, v78
  v_lshlrev_b32 v58, 16, v79
  v_and_b32 v59, 0xffff0000, v79
  v_pk_add_f32 v[52:53], v[52:53], v[56:57]
  v_pk_add_f32 v[54:55], v[54:55], v[58:59]
  s_waitcnt vmcnt(5)
  v_lshlrev_b32 v56, 16, v80
  v_and_b32 v57, 0xffff0000, v80
  v_lshlrev_b32 v58, 16, v81
  v_and_b32 v59, 0xffff0000, v81
  v_pk_add_f32 v[52:53], v[52:53], v[56:57]
  v_pk_add_f32 v[54:55], v[54:55], v[58:59]
  s_waitcnt vmcnt(4)
  v_lshlrev_b32 v56, 16, v82
  v_and_b32 v57, 0xffff0000, v82
  v_lshlrev_b32 v58, 16, v83
  v_and_b32 v59, 0xffff0000, v83
  v_pk_add_f32 v[52:53], v[52:53], v[56:57]
  v_pk_add_f32 v[54:55], v[54:55], v[58:59]
  s_waitcnt vmcnt(3)
  v_lshlrev_b32 v56, 16, v84
  v_and_b32 v57, 0xffff0000, v84
  v_lshlrev_b32 v58, 16, v85
  v_and_b32 v59, 0xffff0000, v85
  v_pk_add_f32 v[52:53], v[52:53], v[56:57]
  v_pk_add_f32 v[54:55], v[54:55], v[58:59]
  s_waitcnt vmcnt(2)
  v_lshlrev_b32 v56, 16, v86
  v_and_b32 v57, 0xffff0000, v86
  v_lshlrev_b32 v58, 16, v87
  v_and_b32 v59, 0xffff0000, v87
  v_pk_add_f32 v[52:53], v[52:53], v[56:57]
  v_pk_add_f32 v[54:55], v[54:55], v[58:59]
  s_waitcnt vmcnt(1)
  v_lshlrev_b32 v56, 16, v88
  v_and_b32 v57, 0xffff0000, v88
  v_lshlrev_b32 v58, 16, v89
  v_and_b32 v59, 0xffff0000, v89
  v_pk_add_f32 v[52:53], v[52:53], v[56:57]
  v_pk_add_f32 v[54:55], v[54:55], v[58:59]
  s_waitcnt vmcnt(0)
  v_lshlrev_b32 v56, 16, v90
  v_and_b32 v57, 0xffff0000, v90
  v_lshlrev_b32 v58, 16, v91
  v_and_b32 v59, 0xffff0000, v91
  v_pk_add_f32 v[52:53], v[52:53], v[56:57]
  v_pk_add_f32 v[54:55], v[54:55], v[58:59]
  v_cvt_pk_bf16_f32 v80, v52, v53
  v_cvt_pk_bf16_f32 v81, v54, v55
  global_store_dwordx2 v132, v[80:81], s[14:15]
  s_endpgm
.p2align 3
L_jobs:
  s_cmp_ge_u32 s38, 24
  s_cbranch_scc1 L_jt24
  s_cmp_ge_u32 s38, 22
  s_cbranch_scc1 L_jt22
  s_cmp_ge_u32 s38, 21
  s_cbranch_scc1 L_jt21
  s_mov_b32 s80, 21
  ds_read_b64_tr_b16 v[144:145], v140 offset:4096
  ds_read_b64_tr_b16 v[146:147], v140 offset:6144
  ds_read_b64_tr_b16 v[148:149], v141 offset:4096
  ds_read_b64_tr_b16 v[150:151], v141 offset:6144
  ds_read_b64_tr_b16 v[152:153], v142 offset:4096
  ds_read_b64_tr_b16 v[154:155], v142 offset:6144
  ds_read_b64_tr_b16 v[156:157], v143 offset:4096
  ds_read_b64_tr_b16 v[158:159], v143 offset:6144
  s_branch L_jobs_done0
L_jt21:
  s_mov_b32 s80, 22
  ds_read_b64_tr_b16 v[160:161], v140 offset:8192
  ds_read_b64_tr_b16 v[162:163], v140 offset:10240
  ds_read_b64_tr_b16 v[164:165], v141 offset:8192
  ds_read_b64_tr_b16 v[166:167], v141 offset:10240
  ds_read_b64_tr_b16 v[168:169], v142 offset:8192
  ds_read_b64_tr_b16 v[170:171], v142 offset:10240
  ds_read_b64_tr_b16 v[172:173], v143 offset:8192
  ds_read_b64_tr_b16 v[174:175], v143 offset:10240
  s_branch L_jobs_done1
L_jt22:
  s_cmp_ge_u32 s38, 23
  s_cbranch_scc1 L_jt23
  s_mov_b32 s80, 23
  ds_read_b64_tr_b16 v[176:177], v140 offset:12288
  ds_read_b64_tr_b16 v[178:179], v140 offset:14336
  ds_read_b64_tr_b16 v[180:181], v141 offset:12288
  ds_read_b64_tr_b16 v[182:183], v141 offset:14336
  ds_read_b64_tr_b16 v[184:185], v142 offset:12288
  ds_read_b64_tr_b16 v[186:187], v142 offset:14336
  ds_read_b64_tr_b16 v[188:189], v143 offset:12288
  ds_read_b64_tr_b16 v[190:191], v143 offset:14336
  s_branch L_jobs_done0
L_jt23:
  s_mov_b32 s80, 24
  ds_read_b64_tr_b16 v[192:193], v140 offset:0
  ds_read_b64_tr_b16 v[194:195], v140 offset:2048
  ds_read_b64_tr_b16 v[196:197], v141 offset:0
  ds_read_b64_tr_b16 v[198:199], v141 offset:2048
  ds_read_b64_tr_b16 v[200:201], v142 offset:0
  ds_read_b64_tr_b16 v[202:203], v142 offset:2048
  ds_read_b64_tr_b16 v[204:205], v143 offset:0
  ds_read_b64_tr_b16 v[206:207], v143 offset:2048
  s_branch L_jobs_done1
L_jt24:
  s_cmp_ge_u32 s38, 26
  s_cbranch_scc1 L_jt26
  s_cmp_ge_u32 s38, 25
  s_cbranch_scc1 L_jt25
  s_mov_b32 s80, 25
  ds_read_b64_tr_b16 v[208:209], v140 offset:4096
  ds_read_b64_tr_b16 v[210:211], v140 offset:6144
  ds_read_b64_tr_b16 v[212:213], v141 offset:4096
  ds_read_b64_tr_b16 v[214:215], v141 offset:6144
  ds_read_b64_tr_b16 v[216:217], v142 offset:4096
  ds_read_b64_tr_b16 v[218:219], v142 offset:6144
  ds_read_b64_tr_b16 v[220:221], v143 offset:4096
  ds_read_b64_tr_b16 v[222:223], v143 offset:6144
  s_branch L_jobs_done0
L_jt25:
  s_mov_b32 s80, 26
  ds_read_b64_tr_b16 v[224:225], v140 offset:8192
  ds_read_b64_tr_b16 v[226:227], v140 offset:10240
  ds_read_b64_tr_b16 v[228:229], v141 offset:8192
  ds_read_b64_tr_b16 v[230:231], v141 offset:10240
  ds_read_b64_tr_b16 v[232:233], v142 offset:8192
  ds_read_b64_tr_b16 v[234:235], v142 offset:10240
  ds_read_b64_tr_b16 v[236:237], v143 offset:8192
  ds_read_b64_tr_b16 v[238:239], v143 offset:10240
  s_branch L_jobs_done1
L_jt26:
  s_cmp_ge_u32 s38, 31
  s_cbranch_scc1 L_jt31
  s_mov_b32 s80, 31
  ds_read_b64_tr_b16 v[240:241], v140 offset:12288
  ds_read_b64_tr_b16 v[242:243], v140 offset:14336
  ds_read_b64_tr_b16 v[244:245], v141 offset:12288
  ds_read_b64_tr_b16 v[246:247], v141 offset:14336
  ds_read_b64_tr_b16 v[248:249], v142 offset:12288
  ds_read_b64_tr_b16 v[250:251], v142 offset:14336
  ds_read_b64_tr_b16 v[252:253], v143 offset:12288
  ds_read_b64_tr_b16 v[254:255], v143 offset:14336
  s_branch L_jobs_done0
L_jt31:
  s_mov_b32 s80, 99
  s_memrealtime s[94:95]
  ds_read_b64_tr_b16 v[4:5], v140 offset:8192
  ds_read_b64_tr_b16 v[6:7], v140 offset:10240
  ds_read_b64_tr_b16 v[8:9], v141 offset:8192
  ds_read_b64_tr_b16 v[10:11], v141 offset:10240
  ds_read_b64_tr_b16 v[12:13], v142 offset:8192
  ds_read_b64_tr_b16 v[14:15], v142 offset:10240
  ds_read_b64_tr_b16 v[16:17], v143 offset:8192
  ds_read_b64_tr_b16 v[18:19], v143 offset:10240
  s_mov_b32 s36, 0
  s_mov_b32 s37, 66
  s_cmp_ge_i32 s36, s37
  s_cbranch_scc1 L_go14
  s_mov_b32 s43, 1048576
L_poll14:
  ds_read_b128 v[132:135], v136 offset:16
  s_waitcnt lgkmcnt(0)
  v_min3_u32 v132, v132, v133, v134
  v_min_u32 v132, v132, v135
  s_sub_u32 s43, s43, 1
  v_readfirstlane_b32 s36, v132
  s_cbranch_scc1 L_end
  s_cmp_ge_i32 s36, s37
  s_cbranch_scc1 L_go14
  s_sleep 1
  s_branch L_poll14
L_go14:
  s_lshl_b32 s50, s3, 17
  s_xor_b32 s61, s50, 360448
  s_add_u32 m0, s52, 8192
  s_add_u32 s37, s61, 14336
  buffer_load_dwordx4 v138, s[28:31], s61 offen offset:0 lds
  buffer_load_dwordx4 v139, s[28:31], s61 offen offset:1024 lds
  buffer_load_dwordx4 v138, s[28:31], s37 offen offset:2048 lds
  buffer_load_dwordx4 v139, s[28:31], s37 offen offset:3072 lds
  s_branch L_jobs_done1
L_slow0:
  v_mov_b32 v133, v132
  s_nop 1
  v_permlane32_swap_b32 v132, v133
  v_max_f32 v132, v132, v133
  v_mov_b32 v133, v132
  s_nop 1
  v_permlane16_swap_b32 v132, v133
  v_max3_f32 v132, v132, v133, s83
  v_max_f32 v133, 0, v132
  v_exp_f32 v134, -v133
  v_sub_f32 v120, v120, v132
  v_sub_f32 v121, v121, v132
  v_sub_f32 v122, v122, v132
  v_sub_f32 v123, v123, v132
  v_sub_f32 v52, v52, v132
  v_sub_f32 v53, v53, v132
  v_sub_f32 v54, v54, v132
  v_sub_f32 v55, v55, v132
  v_sub_f32 v56, v56, v132
  v_sub_f32 v57, v57, v132
  v_sub_f32 v58, v58, v132
  v_sub_f32 v59, v59, v132
  v_mul_f32 v128, v128, v134
  v_mul_f32 v20, v20, v134
  v_mul_f32 v21, v21, v134
  v_mul_f32 v22, v22, v134
  v_mul_f32 v23, v23, v134
  v_mul_f32 v24, v24, v134
  v_mul_f32 v25, v25, v134
  v_mul_f32 v26, v26, v134
  v_mul_f32 v27, v27, v134
  v_mul_f32 v28, v28, v134
  v_mul_f32 v29, v29, v134
  v_mul_f32 v30, v30, v134
  v_mul_f32 v31, v31, v134
  v_mul_f32 v32, v32, v134
  v_mul_f32 v33, v33, v134
  v_mul_f32 v34, v34, v134
  v_mul_f32 v35, v35, v134
  v_mul_f32 v36, v36, v134
  v_mul_f32 v37, v37, v134
  v_mul_f32 v38, v38, v134
  v_mul_f32 v39, v39, v134
  v_mul_f32 v40, v40, v134
  v_mul_f32 v41, v41, v134
  v_mul_f32 v42, v42, v134
  v_mul_f32 v43, v43, v134
  v_mul_f32 v44, v44, v134
  v_mul_f32 v45, v45, v134
  v_mul_f32 v46, v46, v134
  v_mul_f32 v47, v47, v134
  v_mul_f32 v48, v48, v134
  v_mul_f32 v49, v49, v134
  v_mul_f32 v50, v50, v134
  v_mul_f32 v51, v51, v134
  s_mov_b32 s82, 0x41000000
  s_mov_b32 s83, 0
  s_and_b32 s34, s38, 1
  s_add_u32 s34, s34, s87
  s_cmp_eq_u32 s34, 1
  s_cbranch_scc1 L_back0_1
  s_cmp_eq_u32 s34, 2
  s_cbranch_scc1 L_back0_2
  s_cmp_eq_u32 s34, 3
  s_cbranch_scc1 L_back0_3
  s_cmp_eq_u32 s34, 4
  s_cbranch_scc1 L_back0_4
  s_branch L_back0_0
L_slow1:
  v_mov_b32 v133, v132
  s_nop 1
  v_permlane32_swap_b32 v132, v133
  v_max_f32 v132, v132, v133
  v_mov_b32 v133, v132
  s_nop 1
  v_permlane16_swap_b32 v132, v133
  v_max3_f32 v132, v132, v133, s83
  v_max_f32 v133, 0, v132
  v_exp_f32 v134, -v133
  v_sub_f32 v120, v120, v132
  v_sub_f32 v121, v121, v132
  v_sub_f32 v122, v122, v132
  v_sub_f32 v123, v123, v132
  v_sub_f32 v60, v60, v132
  v_sub_f32 v61, v61, v132
  v_sub_f32 v62, v62, v132
  v_sub_f32 v63, v63, v132
  v_sub_f32 v64, v64, v132
  v_sub_f32 v65, v65, v132
  v_sub_f32 v66, v66, v132
  v_sub_f32 v67, v67, v132
  v_mul_f32 v128, v128, v134
  v_mul_f32 v20, v20, v134
  v_mul_f32 v21, v21, v134
  v_mul_f32 v22, v22, v134
  v_mul_f32 v23, v23, v134
  v_mul_f32 v24, v24, v134
  v_mul_f32 v25, v25, v134
  v_mul_f32 v26, v26, v134
  v_mul_f32 v27, v27, v134
  v_mul_f32 v28, v28, v134
  v_mul_f32 v29, v29, v134
  v_mul_f32 v30, v30, v134
  v_mul_f32 v31, v31, v134
  v_mul_f32 v32, v32, v134
  v_mul_f32 v33, v33, v134
  v_mul_f32 v34, v34, v134
  v_mul_f32 v35, v35, v134
  v_mul_f32 v36, v36, v134
  v_mul_f32 v37, v37, v134
  v_mul_f32 v38, v38, v134
  v_mul_f32 v39, v39, v134
  v_mul_f32 v40, v40, v134
  v_mul_f32 v41, v41, v134
  v_mul_f32 v42, v42, v134
  v_mul_f32 v43, v43, v134
  v_mul_f32 v44, v44, v134
  v_mul_f32 v45, v45, v134
  v_mul_f32 v46, v46, v134
  v_mul_f32 v47, v47, v134
  v_mul_f32 v48, v48, v134
  v_mul_f32 v49, v49, v134
  v_mul_f32 v50, v50, v134
  v_mul_f32 v51, v51, v134
  v_mul_f32 v52, v52, v134
  v_mul_f32 v53, v53, v134
  v_mul_f32 v54, v54, v134
  v_mul_f32 v55, v55, v134
  v_mul_f32 v56, v56, v134
  v_mul_f32 v57, v57, v134
  v_mul_f32 v58, v58, v134
  v_mul_f32 v59, v59, v134
  v_cvt_pk_bf16_f32 v68, v52, v53
  v_cvt_pk_bf16_f32 v69, v54, v55
  v_cvt_pk_bf16_f32 v70, v56, v57
  v_cvt_pk_bf16_f32 v71, v58, v59
  s_mov_b32 s82, 0x41000000
  s_mov_b32 s83, 0
  s_and_b32 s34, s38, 1
  s_add_u32 s34, s34, s87
  s_cmp_eq_u32 s34, 1
  s_cbranch_scc1 L_back1_1
  s_cmp_eq_u32 s34, 2
  s_cbranch_scc1 L_back1_2
  s_cmp_eq_u32 s34, 3
  s_cbranch_scc1 L_back1_3
  s_cmp_eq_u32 s34, 4
  s_cbranch_scc1 L_back1_4
  s_branch L_back1_0
.p2align 3
L_loader:
  v_xor_b32 v3, v2, v1
  v_lshlrev_b32 v8, 8, v1
  v_lshl_add_u32 v4, v3, 4, v8
  v_xor_b32 v5, 0xc0, v4
  v_lshlrev_b32 v3, 1, v1
  v_xor_b32 v3, v2, v3
  v_lshl_add_u32 v6, v3, 4, v8
  v_xor_b32 v7, 0x80, v6
  s_sub_u32 s35, s3, 4
  s_lshl_b32 s42, s35, 12
  s_mov_b32 s41, s42
  s_mul_i32 s52, s35, 6144
  s_add_u32 s52, s52, 131072
  s_lshl_b32 s51, s35, 14
  s_add_u32 s51, s51, 65536
  s_lshl_b32 s34, s2, 19
  s_lshl_b32 s35, s35, 2
  s_add_u32 s35, s35, 163808
  v_mov_b32 v13, s35
  v_mov_b32 v14, 163824
  v_mov_b32 v12, 0
  ds_write_b32 v13, v12
  v_subrev_u32 v15, 32, v13
  ds_write_b32 v15, v12
  s_bitcmp1_b32 s32, 0
  s_cselect_b32 s40, 0, 2
  s_mov_b32 s39, 0
  s_mov_b32 s49, 0
  s_mov_b32 s60, 4
  s_mov_b32 s53, 131072
  s_bitcmp1_b32 s32, 0
  s_cbranch_scc0 L_even
  s_waitcnt lgkmcnt(0)
  s_add_u32 s20, s6, s34
  s_addc_u32 s21, s7, 0
  s_mov_b32 s22, 0x80000
  s_mov_b32 s23, 0x20000
  s_add_u32 s24, s8, s34
  s_addc_u32 s25, s9, 0
  s_mov_b32 s26, 0x80000
  s_mov_b32 s27, 0x20000
  s_mov_b32 m0, s41
  s_nop 0
  buffer_load_dwordx4 v4, s[20:23], s42 offen offset:0 nt lds
  buffer_load_dwordx4 v4, s[20:23], s42 offen offset:1024 nt lds
  buffer_load_dwordx4 v5, s[20:23], s42 offen offset:2048 nt lds
  buffer_load_dwordx4 v5, s[20:23], s42 offen offset:3072 nt lds
  s_add_u32 s49, s49, 1
  s_add_u32 s41, s41, 16384
  s_cmp_ge_u32 s41, s53
  s_cselect_b32 s34, s53, 0
  s_sub_u32 s41, s41, s34
  s_mov_b32 m0, s41
  s_nop 0
  buffer_load_dwordx4 v6, s[24:27], s42 offen offset:0 nt lds
  buffer_load_dwordx4 v7, s[24:27], s42 offen offset:1024 nt lds
  buffer_load_dwordx4 v6, s[24:27], s42 offen offset:2048 nt lds
  buffer_load_dwordx4 v7, s[24:27], s42 offen offset:3072 nt lds
  s_barrier
  s_mul_i32 s34, s32, 131072
  s_add_u32 s54, s18, s34
  s_addc_u32 s55, s19, 0
  s_mul_i32 s34, s32, 2048
  s_add_u32 s34, s34, 12582912
  s_add_u32 s56, s18, s34
  s_addc_u32 s57, s19, 0
  s_lshl_b32 s34, s33, 19
  s_lshl_b32 s35, s3, 7
  s_add_u32 s34, s34, s35
  s_add_u32 s28, s12, s34
  s_addc_u32 s29, s13, 0
  s_sub_u32 s30, 0x80000, s35
  s_mov_b32 s31, 0x20000
  s_mov_b32 s61, 0
  v_lshlrev_b32 v8, 1, v1
  v_and_b32 v9, 7, v0
  v_xor_b32 v8, v8, v9
  v_lshlrev_b32 v8, 4, v8
  v_lshrrev_b32 v9, 3, v0
  v_lshl_add_u32 v16, v9, 10, v8
  v_add_u32 v17, 7168, v16
  v_lshrrev_b32 v8, 2, v0
  v_bfe_u32 v9, v0, 3, 2
  v_lshlrev_b32 v9, 5, v9
  v_lshl_add_u32 v8, v8, 7, v9
  v_and_b32 v9, 3, v0
  v_lshl_add_u32 v8, v9, 3, v8
  v_add_u32 v20, s52, v8
  v_xor_b32 v21, 32, v20
  v_xor_b32 v22, 64, v20
  v_xor_b32 v23, 96, v20
  v_lshlrev_b32 v8, 4, v0
  v_add_u32 v15, 32768, v8
  s_sub_u32 s44, s28, 512
  s_subb_u32 s45, s29, 0
  s_add_u32 s46, s30, 512
  s_mov_b32 s47, 0x20000
  s_sub_u32 s48, s3, 4
  s_lshl_b32 s48, s48, 17
  s_add_u32 s42, s42, 16384
  s_add_u32 s49, s49, 1
  s_add_u32 s41, s41, 16384
  s_cmp_ge_u32 s41, s53
  s_cselect_b32 s34, s53, 0
  s_sub_u32 s41, s41, s34
  s_mov_b32 m0, s41
  s_waitcnt vmcnt(7)
  buffer_load_dwordx4 v4, s[20:23], s42 offen offset:0 nt lds
  s_waitcnt vmcnt(7)
  buffer_load_dwordx4 v4, s[20:23], s42 offen offset:1024 nt lds
  s_waitcnt vmcnt(7)
  buffer_load_dwordx4 v5, s[20:23], s42 offen offset:2048 nt lds
  s_waitcnt vmcnt(7)
  v_add_u32 v12, 1, v12
  ds_write_b32 v13, v12
  buffer_load_dwordx4 v5, s[20:23], s42 offen offset:3072 nt lds
  s_add_u32 s49, s49, 1
  s_add_u32 s41, s41, 16384
  s_cmp_ge_u32 s41, s53
  s_cselect_b32 s34, s53, 0
  s_sub_u32 s41, s41, s34
  s_mov_b32 m0, s41
  s_waitcnt vmcnt(7)
  buffer_load_dwordx4 v6, s[24:27], s42 offen offset:0 nt lds
  s_waitcnt vmcnt(7)
  buffer_load_dwordx4 v7, s[24:27], s42 offen offset:1024 nt lds
  s_waitcnt vmcnt(7)
  buffer_load_dwordx4 v6, s[24:27], s42 offen offset:2048 nt lds
  s_waitcnt vmcnt(7)
  v_add_u32 v12, 1, v12
  ds_write_b32 v13, v12
  buffer_load_dwordx4 v7, s[24:27], s42 offen offset:3072 nt lds
  s_add_u32 s42, s42, 16384
  s_add_u32 s49, s49, 1
  s_add_u32 s41, s41, 16384
  s_cmp_ge_u32 s41, s53
  s_cselect_b32 s34, s53, 0
  s_sub_u32 s41, s41, s34
  s_mov_b32 m0, s41
  s_waitcnt vmcnt(7)
  buffer_load_dwordx4 v4, s[20:23], s42 offen offset:0 nt lds
  s_waitcnt vmcnt(7)
  buffer_load_dwordx4 v4, s[20:23], s42 offen offset:1024 nt lds
  s_waitcnt vmcnt(7)
  buffer_load_dwordx4 v5, s[20:23], s42 offen offset:2048 nt lds
  s_waitcnt vmcnt(7)
  v_add_u32 v12, 1, v12
  ds_write_b32 v13, v12
  buffer_load_dwordx4 v5, s[20:23], s42 offen offset:3072 nt lds
  s_add_u32 s49, s49, 1
  s_add_u32 s41, s41, 16384
  s_cmp_ge_u32 s41, s53
  s_cselect_b32 s34, s53, 0
  s_sub_u32 s41, s41, s34
  s_mov_b32 m0, s41
  s_waitcnt vmcnt(7)
  buffer_load_dwordx4 v6, s[24:27], s42 offen offset:0 nt lds
  s_waitcnt vmcnt(7)
  buffer_load_dwordx4 v7, s[24:27], s42 offen offset:1024 nt lds
  s_waitcnt vmcnt(7)
  buffer_load_dwordx4 v6, s[24:27], s42 offen offset:2048 nt lds
  s_waitcnt vmcnt(7)
  v_add_u32 v12, 1, v12
  ds_write_b32 v13, v12
  buffer_load_dwordx4 v7, s[24:27], s42 offen offset:3072 nt lds
  s_lshr_b32 s34, s32, 1
  s_lshl_b32 s34, s34, 15
  s_sub_u32 s35, s3, 4
  s_mul_i32 s35, s35, 8064
  s_add_u32 s34, s34, s35
  s_add_u32 s34, s34, 512
  v_lshrrev_b32 v24, 2, v0
  v_and_b32 v25, 3, v0
  v_lshlrev_b32 v25, 7, v25
  v_lshl_add_u32 v24, v24, 10, v25
  s_mov_b64 exec, 0xffffffff
  buffer_load_dword v25, v24, s[44:47], s34 offen
  s_mov_b64 exec, -1
  s_add_u32 s42, s42, 16384
  s_add_u32 s49, s49, 1
  s_add_u32 s41, s41, 16384
  s_cmp_ge_u32 s41, s53
  s_cselect_b32 s34, s53, 0
  s_sub_u32 s41, s41, s34
  s_mov_b32 m0, s41
  s_waitcnt vmcnt(8)
  buffer_load_dwordx4 v4, s[20:23], s42 offen offset:0 nt lds
  s_waitcnt vmcnt(8)
  buffer_load_dwordx4 v4, s[20:23], s42 offen offset:1024 nt lds
  s_waitcnt vmcnt(8)
  buffer_load_dwordx4 v5, s[20:23], s42 offen offset:2048 nt lds
  s_waitcnt vmcnt(8)
  v_add_u32 v12, 1, v12
  ds_write_b32 v13, v12
  buffer_load_dwordx4 v5, s[20:23], s42 offen offset:3072 nt lds
  s_add_u32 s49, s49, 1
  s_add_u32 s41, s41, 16384
  s_cmp_ge_u32 s41, s53
  s_cselect_b32 s34, s53, 0
  s_sub_u32 s41, s41, s34
  s_mov_b32 m0, s41
  s_waitcnt vmcnt(8)
  buffer_load_dwordx4 v6, s[24:27], s42 offen offset:0 nt lds
  s_waitcnt vmcnt(8)
  buffer_load_dwordx4 v7, s[24:27], s42 offen offset:1024 nt lds
  s_waitcnt vmcnt(8)
  buffer_load_dwordx4 v6, s[24:27], s42 offen offset:2048 nt lds
  s_waitcnt vmcnt(7)
  v_add_u32 v12, 1, v12
  ds_write_b32 v13, v12
  buffer_load_dwordx4 v7, s[24:27], s42 offen offset:3072 nt lds
  s_add_u32 s42, s42, 16384
  s_add_u32 s49, s49, 1
  s_add_u32 s41, s41, 16384
  s_cmp_ge_u32 s41, s53
  s_cselect_b32 s34, s53, 0
  s_sub_u32 s41, s41, s34
  s_waitcnt vmcnt(7)
  buffer_load_dwordx4 v[48:51], v4, s[20:23], s42 offen offset:0 nt
  s_waitcnt vmcnt(7)
  buffer_load_dwordx4 v[52:55], v4, s[20:23], s42 offen offset:1024 nt
  s_waitcnt vmcnt(7)
  buffer_load_dwordx4 v[56:59], v5, s[20:23], s42 offen offset:2048 nt
  s_waitcnt vmcnt(7)
  v_add_u32 v12, 1, v12
  ds_write_b32 v13, v12
  buffer_load_dwordx4 v[60:63], v5, s[20:23], s42 offen offset:3072 nt
  s_waitcnt vmcnt(7)
  buffer_load_dwordx4 v[64:67], v6, s[24:27], s42 offen offset:0 nt
  s_waitcnt vmcnt(7)
  buffer_load_dwordx4 v[68:71], v7, s[24:27], s42 offen offset:1024 nt
  s_waitcnt vmcnt(7)
  buffer_load_dwordx4 v[72:75], v6, s[24:27], s42 offen offset:2048 nt
  s_waitcnt vmcnt(7)
  v_add_u32 v12, 1, v12
  ds_write_b32 v13, v12
  buffer_load_dwordx4 v[76:79], v7, s[24:27], s42 offen offset:3072 nt
  s_add_u32 s42, s42, 16384
  s_waitcnt vmcnt(7)
  buffer_load_dwordx4 v[80:83], v4, s[20:23], s42 offen offset:0 nt
  s_waitcnt vmcnt(7)
  buffer_load_dwordx4 v[84:87], v4, s[20:23], s42 offen offset:1024 nt
  s_waitcnt vmcnt(7)
  buffer_load_dwordx4 v[88:91], v5, s[20:23], s42 offen offset:2048 nt
  s_waitcnt vmcnt(7)
  buffer_load_dwordx4 v[92:95], v5, s[20:23], s42 offen offset:3072 nt
  s_waitcnt vmcnt(7)
  buffer_load_dwordx4 v[96:99], v6, s[24:27], s42 offen offset:0 nt
  s_waitcnt vmcnt(7)
  buffer_load_dwordx4 v[100:103], v7, s[24:27], s42 offen offset:1024 nt
  s_waitcnt vmcnt(7)
  buffer_load_dwordx4 v[104:107], v6, s[24:27], s42 offen offset:2048 nt
  s_waitcnt vmcnt(7)
  buffer_load_dwordx4 v[108:111], v7, s[24:27], s42 offen offset:3072 nt
  s_add_u32 s42, s42, 16384
  s_waitcnt vmcnt(7)
  buffer_load_dwordx4 v[112:115], v4, s[20:23], s42 offen offset:0 nt
  s_waitcnt vmcnt(7)
  buffer_load_dwordx4 v[116:119], v4, s[20:23], s42 offen offset:1024 nt
  s_waitcnt vmcnt(7)
  buffer_load_dwordx4 v[120:123], v5, s[20:23], s42 offen offset:2048 nt
  s_waitcnt vmcnt(7)
  buffer_load_dwordx4 v[124:127], v5, s[20:23], s42 offen offset:3072 nt
  s_waitcnt vmcnt(7)
  buffer_load_dwordx4 v[128:131], v6, s[24:27], s42 offen offset:0 nt
  s_waitcnt vmcnt(7)
  buffer_load_dwordx4 v[132:135], v7, s[24:27], s42 offen offset:1024 nt
  s_waitcnt vmcnt(7)
  buffer_load_dwordx4 v[136:139], v6, s[24:27], s42 offen offset:2048 nt
  s_waitcnt vmcnt(7)
  buffer_load_dwordx4 v[140:143], v7, s[24:27], s42 offen offset:3072 nt
  s_add_u32 s42, s42, 16384
  s_waitcnt vmcnt(7)
  buffer_load_dwordx4 v[144:147], v4, s[20:23], s42 offen offset:0 nt
  s_waitcnt vmcnt(7)
  buffer_load_dwordx4 v[148:151], v4, s[20:23], s42 offen offset:1024 nt
  s_waitcnt vmcnt(7)
  buffer_load_dwordx4 v[152:155], v5, s[20:23], s42 offen offset:2048 nt
  s_waitcnt vmcnt(7)
  buffer_load_dwordx4 v[156:159], v5, s[20:23], s42 offen offset:3072 nt
  s_waitcnt vmcnt(7)
  buffer_load_dwordx4 v[160:163], v6, s[24:27], s42 offen offset:0 nt
  s_waitcnt vmcnt(7)
  buffer_load_dwordx4 v[164:167], v7, s[24:27], s42 offen offset:1024 nt
  s_waitcnt vmcnt(7)
  buffer_load_dwordx4 v[168:171], v6, s[24:27], s42 offen offset:2048 nt
  s_waitcnt vmcnt(7)
  buffer_load_dwordx4 v[172:175], v7, s[24:27], s42 offen offset:3072 nt
  s_add_u32 s42, s42, 16384
  s_waitcnt vmcnt(7)
  buffer_load_dwordx4 v[176:179], v4, s[20:23], s42 offen offset:0 nt
  s_waitcnt vmcnt(7)
  buffer_load_dwordx4 v[180:183], v4, s[20:23], s42 offen offset:1024 nt
  s_waitcnt vmcnt(7)
  buffer_load_dwordx4 v[184:187], v5, s[20:23], s42 offen offset:2048 nt
  s_waitcnt vmcnt(7)
  buffer_load_dwordx4 v[188:191], v5, s[20:23], s42 offen offset:3072 nt
  s_waitcnt vmcnt(7)
  buffer_load_dwordx4 v[192:195], v6, s[24:27], s42 offen offset:0 nt
  s_waitcnt vmcnt(7)
  buffer_load_dwordx4 v[196:199], v7, s[24:27], s42 offen offset:1024 nt
  s_waitcnt vmcnt(7)
  buffer_load_dwordx4 v[200:203], v6, s[24:27], s42 offen offset:2048 nt
  s_waitcnt vmcnt(7)
  buffer_load_dwordx4 v[204:207], v7, s[24:27], s42 offen offset:3072 nt
  s_add_u32 s42, s42, 16384
  s_waitcnt vmcnt(7)
  buffer_load_dwordx4 v[208:211], v4, s[20:23], s42 offen offset:0 nt
  s_waitcnt vmcnt(7)
  buffer_load_dwordx4 v[212:215], v4, s[20:23], s42 offen offset:1024 nt
  s_waitcnt vmcnt(7)
  buffer_load_dwordx4 v[216:219], v5, s[20:23], s42 offen offset:2048 nt
  s_waitcnt vmcnt(7)
  buffer_load_dwordx4 v[220:223], v5, s[20:23], s42 offen offset:3072 nt
  s_waitcnt vmcnt(7)
  buffer_load_dwordx4 v[224:227], v6, s[24:27], s42 offen offset:0 nt
  s_waitcnt vmcnt(7)
  buffer_load_dwordx4 v[228:231], v7, s[24:27], s42 offen offset:1024 nt
  s_waitcnt vmcnt(7)
  buffer_load_dwordx4 v[232:235], v6, s[24:27], s42 offen offset:2048 nt
  s_waitcnt vmcnt(7)
  buffer_load_dwordx4 v[236:239], v7, s[24:27], s42 offen offset:3072 nt
  s_add_u32 s42, s42, 16384
  v_subrev_u32 v8, 32, v13
  v_mov_b32 v9, 1
  ds_write_b32 v8, v9
  s_waitcnt vmcnt(7)
  buffer_load_dwordx4 v[240:243], v4, s[20:23], s42 offen offset:0 nt
  s_waitcnt vmcnt(7)
  buffer_load_dwordx4 v[244:247], v4, s[20:23], s42 offen offset:1024 nt
  s_waitcnt vmcnt(7)
  buffer_load_dwordx4 v[248:251], v5, s[20:23], s42 offen offset:2048 nt
  s_waitcnt vmcnt(7)
  buffer_load_dwordx4 v[252:255], v5, s[20:23], s42 offen offset:3072 nt
  v_lshlrev_b32 v24, 4, v0
  s_sub_u32 s40, s49, s60
  s_cmp_ge_i32 s39, s40
  s_cbranch_scc1 L_go15
  s_mov_b32 s43, 1048576
L_poll15:
  ds_read_b128 v[8:11], v14 offset:0
  s_waitcnt lgkmcnt(0)
  v_min3_u32 v8, v8, v9, v10
  v_min_u32 v8, v8, v11
  s_sub_u32 s43, s43, 1
  v_readfirstlane_b32 s39, v8
  s_cbranch_scc1 L_end
  s_cmp_ge_i32 s39, s40
  s_cbranch_scc1 L_go15
  s_sleep 1
  s_branch L_poll15
L_go15:
  v_add_u32 v25, s41, v24
  s_waitcnt vmcnt(48)
  ds_write_b128 v25, v[48:51] offset:0
  ds_write_b128 v25, v[52:55] offset:1024
  ds_write_b128 v25, v[56:59] offset:2048
  ds_write_b128 v25, v[60:63] offset:3072
  s_add_u32 s49, s49, 1
  s_add_u32 s41, s41, 16384
  s_cmp_ge_u32 s41, s53
  s_cselect_b32 s34, s53, 0
  s_sub_u32 s41, s41, s34
  v_add_u32 v12, 1, v12
  s_waitcnt lgkmcnt(0)
  ds_write_b32 v13, v12
  s_waitcnt lgkmcnt(0)
  s_mov_b32 s61, 0
  s_add_u32 m0, s52, 2048
  s_nop 0
  buffer_load_dwordx4 v16, s[28:31], s61 offen offset:0 lds
  s_add_u32 m0, s52, 2048
  s_nop 0
  buffer_load_dwordx4 v17, s[28:31], s61 offen offset:1024 lds
  s_sub_u32 s40, s49, s60
  s_cmp_ge_i32 s39, s40
  s_cbranch_scc1 L_go16
  s_mov_b32 s43, 1048576
L_poll16:
  ds_read_b128 v[8:11], v14 offset:0
  s_waitcnt lgkmcnt(0)
  v_min3_u32 v8, v8, v9, v10
  v_min_u32 v8, v8, v11
  s_sub_u32 s43, s43, 1
  v_readfirstlane_b32 s39, v8
  s_cbranch_scc1 L_end
  s_cmp_ge_i32 s39, s40
  s_cbranch_scc1 L_go16
  s_sleep 1
  s_branch L_poll16
L_go16:
  v_add_u32 v25, s41, v24
  s_waitcnt vmcnt(46)
  ds_write_b128 v25, v[64:67] offset:0
  ds_write_b128 v25, v[68:71] offset:1024
  ds_write_b128 v25, v[72:75] offset:2048
  ds_write_b128 v25, v[76:79] offset:3072
  s_add_u32 s49, s49, 1
  s_add_u32 s41, s41, 16384
  s_cmp_ge_u32 s41, s53
  s_cselect_b32 s34, s53, 0
  s_sub_u32 s41, s41, s34
  v_add_u32 v12, 1, v12
  s_waitcnt lgkmcnt(0)
  ds_write_b32 v13, v12
  s_waitcnt lgkmcnt(0)
  s_mov_b32 s61, 16384
  s_add_u32 m0, s52, 4096
  s_nop 0
  buffer_load_dwordx4 v16, s[28:31], s61 offen offset:0 lds
  s_add_u32 m0, s52, 4096
  s_nop 0
  buffer_load_dwordx4 v17, s[28:31], s61 offen offset:1024 lds
  s_sub_u32 s40, s49, s60
  s_cmp_ge_i32 s39, s40
  s_cbranch_scc1 L_go17
  s_mov_b32 s43, 1048576
L_poll17:
  ds_read_b128 v[8:11], v14 offset:0
  s_waitcnt lgkmcnt(0)
  v_min3_u32 v8, v8, v9, v10
  v_min_u32 v8, v8, v11
  s_sub_u32 s43, s43, 1
  v_readfirstlane_b32 s39, v8
  s_cbranch_scc1 L_end
  s_cmp_ge_i32 s39, s40
  s_cbranch_scc1 L_go17
  s_sleep 1
  s_branch L_poll17
L_go17:
  v_add_u32 v25, s41, v24
  s_waitcnt vmcnt(44)
  ds_write_b128 v25, v[80:83] offset:0
  ds_write_b128 v25, v[84:87] offset:1024
  ds_write_b128 v25, v[88:91] offset:2048
  ds_write_b128 v25, v[92:95] offset:3072
  s_add_u32 s49, s49, 1
  s_add_u32 s41, s41, 16384
  s_cmp_ge_u32 s41, s53
  s_cselect_b32 s34, s53, 0
  s_sub_u32 s41, s41, s34
  v_add_u32 v12, 1, v12
  s_waitcnt lgkmcnt(0)
  ds_write_b32 v13, v12
  s_mov_b32 s81, 0
  s_waitcnt lgkmcnt(0)
  s_mov_b32 s61, 32768
  s_add_u32 m0, s52, 0
  s_nop 0
  buffer_load_dwordx4 v16, s[28:31], s61 offen offset:0 lds
  s_bitcmp1_b32 s81, 0
  s_waitcnt vmcnt(12)
  s_cbranch_scc0 L_w18
  s_waitcnt vmcnt(10)
L_w18:
  buffer_load_dwordx4 v[80:83], v6, s[24:27], s42 offen offset:0 nt
  s_bitcmp1_b32 s81, 1
  s_waitcnt vmcnt(12)
  s_cbranch_scc0 L_w19
  s_waitcnt vmcnt(10)
L_w19:
  buffer_load_dwordx4 v[84:87], v7, s[24:27], s42 offen offset:1024 nt
  s_add_u32 m0, s52, 0
  s_nop 0
  buffer_load_dwordx4 v17, s[28:31], s61 offen offset:1024 lds
  s_bitcmp1_b32 s81, 2
  s_waitcnt vmcnt(6)
  s_cbranch_scc0 L_w20
  s_waitcnt vmcnt(6)
L_w20:
  buffer_load_dwordx4 v[88:91], v6, s[24:27], s42 offen offset:2048 nt
  ds_read_b64_tr_b16 v[48:49], v20 offset:2048
  ds_read_b64_tr_b16 v[52:53], v21 offset:2048
  ds_read_b64_tr_b16 v[56:57], v22 offset:2048
  ds_read_b64_tr_b16 v[60:61], v23 offset:2048
  s_bitcmp1_b32 s81, 3
  s_waitcnt vmcnt(13)
  s_cbranch_scc0 L_w21
  s_waitcnt vmcnt(11)
L_w21:
  buffer_load_dwordx4 v[92:95], v7, s[24:27], s42 offen offset:3072 nt
  s_add_u32 s42, s42, 16384
  s_sub_u32 s40, s49, s60
  s_cmp_ge_i32 s39, s40
  s_cbranch_scc1 L_go22
  s_mov_b32 s43, 1048576
L_poll22:
  ds_read_b128 v[8:11], v14 offset:0
  s_waitcnt lgkmcnt(0)
  v_min3_u32 v8, v8, v9, v10
  v_min_u32 v8, v8, v11
  s_sub_u32 s43, s43, 1
  v_readfirstlane_b32 s39, v8
  s_cbranch_scc1 L_end
  s_cmp_ge_i32 s39, s40
  s_cbranch_scc1 L_go22
  s_sleep 1
  s_branch L_poll22
L_go22:
  v_add_u32 v25, s41, v24
  s_waitcnt vmcnt(46)
  ds_write_b128 v25, v[96:99] offset:0
  ds_write_b128 v25, v[100:103] offset:1024
  ds_write_b128 v25, v[104:107] offset:2048
  ds_write_b128 v25, v[108:111] offset:3072
  s_add_u32 s49, s49, 1
  s_add_u32 s41, s41, 16384
  s_cmp_ge_u32 s41, s53
  s_cselect_b32 s34, s53, 0
  s_sub_u32 s41, s41, s34
  v_add_u32 v12, 1, v12
  s_waitcnt lgkmcnt(0)
  ds_write_b32 v13, v12
  s_waitcnt vmcnt(6)
  ds_read_b64_tr_b16 v[50:51], v20 offset:4096
  ds_read_b64_tr_b16 v[54:55], v21 offset:4096
  ds_read_b64_tr_b16 v[58:59], v22 offset:4096
  ds_read_b64_tr_b16 v[62:63], v23 offset:4096
  s_waitcnt lgkmcnt(0)
  s_mov_b32 s61, 49152
  s_add_u32 m0, s52, 2048
  s_nop 0
  buffer_load_dwordx4 v16, s[28:31], s61 offen offset:0 lds
  s_add_u32 m0, s52, 2048
  s_nop 0
  buffer_load_dwordx4 v17, s[28:31], s61 offen offset:1024 lds
  s_sub_u32 s40, s49, s60
  s_cmp_ge_i32 s39, s40
  s_cbranch_scc1 L_go23
  s_mov_b32 s43, 1048576
L_poll23:
  ds_read_b128 v[8:11], v14 offset:0
  s_waitcnt lgkmcnt(0)
  v_min3_u32 v8, v8, v9, v10
  v_min_u32 v8, v8, v11
  s_sub_u32 s43, s43, 1
  v_readfirstlane_b32 s39, v8
  s_cbranch_scc1 L_end
  s_cmp_ge_i32 s39, s40
  s_cbranch_scc1 L_go23
  s_sleep 1
  s_branch L_poll23
L_go23:
  v_add_u32 v25, s41, v24
  s_waitcnt vmcnt(44)
  ds_write_b128 v25, v[112:115] offset:0
  ds_write_b128 v25, v[116:119] offset:1024
  ds_write_b128 v25, v[120:123] offset:2048
  ds_write_b128 v25, v[124:127] offset:3072
  s_add_u32 s49, s49, 1
  s_add_u32 s41, s41, 16384
  s_cmp_ge_u32 s41, s53
  s_cselect_b32 s34, s53, 0
  s_sub_u32 s41, s41, s34
  v_add_u32 v12, 1, v12
  s_waitcnt lgkmcnt(0)
  ds_write_b32 v13, v12
  s_waitcnt vmcnt(4)
  ds_read_b64_tr_b16 v[64:65], v20 offset:0
  ds_read_b64_tr_b16 v[68:69], v21 offset:0
  ds_read_b64_tr_b16 v[72:73], v22 offset:0
  ds_read_b64_tr_b16 v[76:77], v23 offset:0
  s_waitcnt lgkmcnt(0)
  s_mov_b32 s61, 98304
  s_add_u32 m0, s52, 4096
  s_nop 0
  buffer_load_dwordx4 v16, s[28:31], s61 offen offset:0 lds
  s_add_u32 m0, s52, 4096
  s_nop 0
  buffer_load_dwordx4 v17, s[28:31], s61 offen offset:1024 lds
  s_sub_u32 s40, s49, s60
  s_cmp_ge_i32 s39, s40
  s_cbranch_scc1 L_go24
  s_mov_b32 s43, 1048576
L_poll24:
  ds_read_b128 v[8:11], v14 offset:0
  s_waitcnt lgkmcnt(0)
  v_min3_u32 v8, v8, v9, v10
  v_min_u32 v8, v8, v11
  s_sub_u32 s43, s43, 1
  v_readfirstlane_b32 s39, v8
  s_cbranch_scc1 L_end
  s_cmp_ge_i32 s39, s40
  s_cbranch_scc1 L_go24
  s_sleep 1
  s_branch L_poll24
L_go24:
  v_add_u32 v25, s41, v24
  s_waitcnt vmcnt(42)
  ds_write_b128 v25, v[128:131] offset:0
  ds_write_b128 v25, v[132:135] offset:1024
  ds_write_b128 v25, v[136:139] offset:2048
  ds_write_b128 v25, v[140:143] offset:3072
  s_add_u32 s49, s49, 1
  s_add_u32 s41, s41, 16384
  s_cmp_ge_u32 s41, s53
  s_cselect_b32 s34, s53, 0
  s_sub_u32 s41, s41, s34
  v_add_u32 v12, 1, v12
  s_waitcnt lgkmcnt(0)
  ds_write_b32 v13, v12
  s_waitcnt lgkmcnt(0)
  s_mov_b32 s61, 114688
  s_add_u32 m0, s52, 0
  s_nop 0
  buffer_load_dwordx4 v16, s[28:31], s61 offen offset:0 lds
  s_bitcmp1_b32 s81, 0
  s_waitcnt vmcnt(18)
  s_cbranch_scc0 L_w25
  s_waitcnt vmcnt(16)
L_w25:
  buffer_load_dwordx4 v[128:131], v4, s[20:23], s42 offen offset:0 nt
  s_bitcmp1_b32 s81, 1
  s_waitcnt vmcnt(18)
  s_cbranch_scc0 L_w26
  s_waitcnt vmcnt(12)
L_w26:
  buffer_load_dwordx4 v[132:135], v4, s[20:23], s42 offen offset:1024 nt
  s_add_u32 m0, s52, 0
  s_nop 0
  buffer_load_dwordx4 v17, s[28:31], s61 offen offset:1024 lds
  s_bitcmp1_b32 s81, 2
  s_waitcnt vmcnt(6)
  s_cbranch_scc0 L_w27
  s_waitcnt vmcnt(6)
L_w27:
  buffer_load_dwordx4 v[136:139], v5, s[20:23], s42 offen offset:2048 nt
  ds_read_b64_tr_b16 v[66:67], v20 offset:2048
  ds_read_b64_tr_b16 v[70:71], v21 offset:2048
  ds_read_b64_tr_b16 v[74:75], v22 offset:2048
  ds_read_b64_tr_b16 v[78:79], v23 offset:2048
  s_bitcmp1_b32 s81, 3
  s_waitcnt vmcnt(15)
  s_cbranch_scc0 L_w28
  s_waitcnt vmcnt(12)
L_w28:
  buffer_load_dwordx4 v[140:143], v5, s[20:23], s42 offen offset:3072 nt
  s_sub_u32 s40, s49, s60
  s_cmp_ge_i32 s39, s40
  s_cbranch_scc1 L_go29
  s_mov_b32 s43, 1048576
L_poll29:
  ds_read_b128 v[8:11], v14 offset:0
  s_waitcnt lgkmcnt(0)
  v_min3_u32 v8, v8, v9, v10
  v_min_u32 v8, v8, v11
  s_sub_u32 s43, s43, 1
  v_readfirstlane_b32 s39, v8
  s_cbranch_scc1 L_end
  s_cmp_ge_i32 s39, s40
  s_cbranch_scc1 L_go29
  s_sleep 1
  s_branch L_poll29
L_go29:
  v_add_u32 v25, s41, v24
  s_waitcnt vmcnt(44)
  ds_write_b128 v25, v[144:147] offset:0
  ds_write_b128 v25, v[148:151] offset:1024
  ds_write_b128 v25, v[152:155] offset:2048
  ds_write_b128 v25, v[156:159] offset:3072
  s_add_u32 s49, s49, 1
  s_add_u32 s41, s41, 16384
  s_cmp_ge_u32 s41, s53
  s_cselect_b32 s34, s53, 0
  s_sub_u32 s41, s41, s34
  v_add_u32 v12, 1, v12
  s_waitcnt lgkmcnt(0)
  ds_write_b32 v13, v12
  s_waitcnt vmcnt(6)
  ds_read_b64_tr_b16 v[96:97], v20 offset:4096
  ds_read_b64_tr_b16 v[100:101], v21 offset:4096
  ds_read_b64_tr_b16 v[104:105], v22 offset:4096
  ds_read_b64_tr_b16 v[108:109], v23 offset:4096
  s_waitcnt lgkmcnt(0)
  s_mov_b32 s61, 131072
  s_add_u32 m0, s52, 2048
  s_nop 0
  buffer_load_dwordx4 v16, s[28:31], s61 offen offset:0 lds
  s_add_u32 m0, s52, 2048
  s_nop 0
  buffer_load_dwordx4 v17, s[28:31], s61 offen offset:1024 lds
  s_sub_u32 s40, s49, s60
  s_cmp_ge_i32 s39, s40
  s_cbranch_scc1 L_go30
  s_mov_b32 s43, 1048576
L_poll30:
  ds_read_b128 v[8:11], v14 offset:0
  s_waitcnt lgkmcnt(0)
  v_min3_u32 v8, v8, v9, v10
  v_min_u32 v8, v8, v11
  s_sub_u32 s43, s43, 1
  v_readfirstlane_b32 s39, v8
  s_cbranch_scc1 L_end
  s_cmp_ge_i32 s39, s40
  s_cbranch_scc1 L_go30
  s_sleep 1
  s_branch L_poll30
L_go30:
  v_add_u32 v25, s41, v24
  s_waitcnt vmcnt(42)
  ds_write_b128 v25, v[160:163] offset:0
  ds_write_b128 v25, v[164:167] offset:1024
  ds_write_b128 v25, v[168:171] offset:2048
  ds_write_b128 v25, v[172:175] offset:3072
  s_add_u32 s49, s49, 1
  s_add_u32 s41, s41, 16384
  s_cmp_ge_u32 s41, s53
  s_cselect_b32 s34, s53, 0
  s_sub_u32 s41, s41, s34
  v_add_u32 v12, 1, v12
  s_waitcnt lgkmcnt(0)
  ds_write_b32 v13, v12
  s_waitcnt vmcnt(4)
  ds_read_b64_tr_b16 v[98:99], v20 offset:0
  ds_read_b64_tr_b16 v[102:103], v21 offset:0
  ds_read_b64_tr_b16 v[106:107], v22 offset:0
  ds_read_b64_tr_b16 v[110:111], v23 offset:0
  s_waitcnt lgkmcnt(0)
  s_mov_b32 s61, 147456
  s_add_u32 m0, s52, 4096
  s_nop 0
  buffer_load_dwordx4 v16, s[28:31], s61 offen offset:0 lds
  s_add_u32 m0, s52, 4096
  s_nop 0
  buffer_load_dwordx4 v17, s[28:31], s61 offen offset:1024 lds
  s_sub_u32 s40, s49, s60
  s_cmp_ge_i32 s39, s40
  s_cbranch_scc1 L_go31
  s_mov_b32 s43, 1048576
L_poll31:
  ds_read_b128 v[8:11], v14 offset:0
  s_waitcnt lgkmcnt(0)
  v_min3_u32 v8, v8, v9, v10
  v_min_u32 v8, v8, v11
  s_sub_u32 s43, s43, 1
  v_readfirstlane_b32 s39, v8
  s_cbranch_scc1 L_end
  s_cmp_ge_i32 s39, s40
  s_cbranch_scc1 L_go31
  s_sleep 1
  s_branch L_poll31
L_go31:
  v_add_u32 v25, s41, v24
  s_waitcnt vmcnt(40)
  ds_write_b128 v25, v[176:179] offset:0
  ds_write_b128 v25, v[180:183] offset:1024
  ds_write_b128 v25, v[184:187] offset:2048
  ds_write_b128 v25, v[188:191] offset:3072
  s_add_u32 s49, s49, 1
  s_add_u32 s41, s41, 16384
  s_cmp_ge_u32 s41, s53
  s_cselect_b32 s34, s53, 0
  s_sub_u32 s41, s41, s34
  v_add_u32 v12, 1, v12
  s_waitcnt lgkmcnt(0)
  ds_write_b32 v13, v12
  s_waitcnt lgkmcnt(0)
  s_mov_b32 s61, 196608
  s_add_u32 m0, s52, 0
  s_nop 0
  buffer_load_dwordx4 v16, s[28:31], s61 offen offset:0 lds
  s_bitcmp1_b32 s81, 0
  s_waitcnt vmcnt(19)
  s_cbranch_scc0 L_w32
  s_waitcnt vmcnt(16)
L_w32:
  buffer_load_dwordx4 v[176:179], v6, s[24:27], s42 offen offset:0 nt
  s_bitcmp1_b32 s81, 1
  s_waitcnt vmcnt(19)
  s_cbranch_scc0 L_w33
  s_waitcnt vmcnt(12)
L_w33:
  buffer_load_dwordx4 v[180:183], v7, s[24:27], s42 offen offset:1024 nt
  s_add_u32 m0, s52, 0
  s_nop 0
  buffer_load_dwordx4 v17, s[28:31], s61 offen offset:1024 lds
  s_bitcmp1_b32 s81, 2
  s_waitcnt vmcnt(6)
  s_cbranch_scc0 L_w34
  s_waitcnt vmcnt(6)
L_w34:
  buffer_load_dwordx4 v[184:187], v6, s[24:27], s42 offen offset:2048 nt
  ds_read_b64_tr_b16 v[112:113], v20 offset:2048
  ds_read_b64_tr_b16 v[116:117], v21 offset:2048
  ds_read_b64_tr_b16 v[120:121], v22 offset:2048
  ds_read_b64_tr_b16 v[124:125], v23 offset:2048
  s_bitcmp1_b32 s81, 3
  s_waitcnt vmcnt(15)
  s_cbranch_scc0 L_w35
  s_waitcnt vmcnt(12)
L_w35:
  buffer_load_dwordx4 v[188:191], v7, s[24:27], s42 offen offset:3072 nt
  s_add_u32 s42, s42, 16384
  s_sub_u32 s40, s49, s60
  s_cmp_ge_i32 s39, s40
  s_cbranch_scc1 L_go36
  s_mov_b32 s43, 1048576
L_poll36:
  ds_read_b128 v[8:11], v14 offset:0
  s_waitcnt lgkmcnt(0)
  v_min3_u32 v8, v8, v9, v10
  v_min_u32 v8, v8, v11
  s_sub_u32 s43, s43, 1
  v_readfirstlane_b32 s39, v8
  s_cbranch_scc1 L_end
  s_cmp_ge_i32 s39, s40
  s_cbranch_scc1 L_go36
  s_sleep 1
  s_branch L_poll36
L_go36:
  v_add_u32 v25, s41, v24
  s_waitcnt vmcnt(42)
  ds_write_b128 v25, v[192:195] offset:0
  ds_write_b128 v25, v[196:199] offset:1024
  ds_write_b128 v25, v[200:203] offset:2048
  ds_write_b128 v25, v[204:207] offset:3072
  s_add_u32 s49, s49, 1
  s_add_u32 s41, s41, 16384
  s_cmp_ge_u32 s41, s53
  s_cselect_b32 s34, s53, 0
  s_sub_u32 s41, s41, s34
  v_add_u32 v12, 1, v12
  s_waitcnt lgkmcnt(0)
  ds_write_b32 v13, v12
  s_waitcnt vmcnt(6)
  ds_read_b64_tr_b16 v[114:115], v20 offset:4096
  ds_read_b64_tr_b16 v[118:119], v21 offset:4096
  ds_read_b64_tr_b16 v[122:123], v22 offset:4096
  ds_read_b64_tr_b16 v[126:127], v23 offset:4096
  s_waitcnt lgkmcnt(0)
  s_mov_b32 s61, 212992
  s_add_u32 m0, s52, 2048
  s_nop 0
  buffer_load_dwordx4 v16, s[28:31], s61 offen offset:0 lds
  s_add_u32 m0, s52, 2048
  s_nop 0
  buffer_load_dwordx4 v17, s[28:31], s61 offen offset:1024 lds
  s_sub_u32 s40, s49, s60
  s_cmp_ge_i32 s39, s40
  s_cbranch_scc1 L_go37
  s_mov_b32 s43, 1048576
L_poll37:
  ds_read_b128 v[8:11], v14 offset:0
  s_waitcnt lgkmcnt(0)
  v_min3_u32 v8, v8, v9, v10
  v_min_u32 v8, v8, v11
  s_sub_u32 s43, s43, 1
  v_readfirstlane_b32 s39, v8
  s_cbranch_scc1 L_end
  s_cmp_ge_i32 s39, s40
  s_cbranch_scc1 L_go37
  s_sleep 1
  s_branch L_poll37
L_go37:
  v_add_u32 v25, s41, v24
  s_waitcnt vmcnt(40)
  ds_write_b128 v25, v[208:211] offset:0
  ds_write_b128 v25, v[212:215] offset:1024
  ds_write_b128 v25, v[216:219] offset:2048
  ds_write_b128 v25, v[220:223] offset:3072
  s_add_u32 s49, s49, 1
  s_add_u32 s41, s41, 16384
  s_cmp_ge_u32 s41, s53
  s_cselect_b32 s34, s53, 0
  s_sub_u32 s41, s41, s34
  v_add_u32 v12, 1, v12
  s_waitcnt lgkmcnt(0)
  ds_write_b32 v13, v12
  s_waitcnt vmcnt(4)
  ds_read_b64_tr_b16 v[144:145], v20 offset:0
  ds_read_b64_tr_b16 v[148:149], v21 offset:0
  ds_read_b64_tr_b16 v[152:153], v22 offset:0
  ds_read_b64_tr_b16 v[156:157], v23 offset:0
  s_waitcnt lgkmcnt(0)
  s_mov_b32 s61, 229376
  s_add_u32 m0, s52, 4096
  s_nop 0
  buffer_load_dwordx4 v16, s[28:31], s61 offen offset:0 lds
  s_add_u32 m0, s52, 4096
  s_nop 0
  buffer_load_dwordx4 v17, s[28:31], s61 offen offset:1024 lds
  s_sub_u32 s40, s49, s60
  s_cmp_ge_i32 s39, s40
  s_cbranch_scc1 L_go38
  s_mov_b32 s43, 1048576
L_poll38:
  ds_read_b128 v[8:11], v14 offset:0
  s_waitcnt lgkmcnt(0)
  v_min3_u32 v8, v8, v9, v10
  v_min_u32 v8, v8, v11
  s_sub_u32 s43, s43, 1
  v_readfirstlane_b32 s39, v8
  s_cbranch_scc1 L_end
  s_cmp_ge_i32 s39, s40
  s_cbranch_scc1 L_go38
  s_sleep 1
  s_branch L_poll38
L_go38:
  v_add_u32 v25, s41, v24
  s_waitcnt vmcnt(38)
  ds_write_b128 v25, v[224:227] offset:0
  ds_write_b128 v25, v[228:231] offset:1024
  ds_write_b128 v25, v[232:235] offset:2048
  ds_write_b128 v25, v[236:239] offset:3072
  s_add_u32 s49, s49, 1
  s_add_u32 s41, s41, 16384
  s_cmp_ge_u32 s41, s53
  s_cselect_b32 s34, s53, 0
  s_sub_u32 s41, s41, s34
  v_add_u32 v12, 1, v12
  s_waitcnt lgkmcnt(0)
  ds_write_b32 v13, v12
  s_waitcnt lgkmcnt(0)
  s_mov_b32 s61, 245760
  s_add_u32 m0, s52, 0
  s_nop 0
  buffer_load_dwordx4 v16, s[28:31], s61 offen offset:0 lds
  s_bitcmp1_b32 s81, 0
  s_waitcnt vmcnt(19)
  s_cbranch_scc0 L_w39
  s_waitcnt vmcnt(16)
L_w39:
  buffer_load_dwordx4 v[224:227], v4, s[20:23], s42 offen offset:0 nt
  s_bitcmp1_b32 s81, 1
  s_waitcnt vmcnt(19)
  s_cbranch_scc0 L_w40
  s_waitcnt vmcnt(12)
L_w40:
  buffer_load_dwordx4 v[228:231], v4, s[20:23], s42 offen offset:1024 nt
  s_add_u32 m0, s52, 0
  s_nop 0
  buffer_load_dwordx4 v17, s[28:31], s61 offen offset:1024 lds
  s_bitcmp1_b32 s81, 2
  s_waitcnt vmcnt(6)
  s_cbranch_scc0 L_w41
  s_waitcnt vmcnt(6)
L_w41:
  buffer_load_dwordx4 v[232:235], v5, s[20:23], s42 offen offset:2048 nt
  ds_read_b64_tr_b16 v[146:147], v20 offset:2048
  ds_read_b64_tr_b16 v[150:151], v21 offset:2048
  ds_read_b64_tr_b16 v[154:155], v22 offset:2048
  ds_read_b64_tr_b16 v[158:159], v23 offset:2048
  s_bitcmp1_b32 s81, 3
  s_waitcnt vmcnt(15)
  s_cbranch_scc0 L_w42
  s_waitcnt vmcnt(12)
L_w42:
  buffer_load_dwordx4 v[236:239], v5, s[20:23], s42 offen offset:3072 nt
  s_sub_u32 s40, s49, s60
  s_cmp_ge_i32 s39, s40
  s_cbranch_scc1 L_go43
  s_mov_b32 s43, 1048576
L_poll43:
  ds_read_b128 v[8:11], v14 offset:0
  s_waitcnt lgkmcnt(0)
  v_min3_u32 v8, v8, v9, v10
  v_min_u32 v8, v8, v11
  s_sub_u32 s43, s43, 1
  v_readfirstlane_b32 s39, v8
  s_cbranch_scc1 L_end
  s_cmp_ge_i32 s39, s40
  s_cbranch_scc1 L_go43
  s_sleep 1
  s_branch L_poll43
L_go43:
  v_add_u32 v25, s41, v24
  s_waitcnt vmcnt(40)
  ds_write_b128 v25, v[240:243] offset:0
  ds_write_b128 v25, v[244:247] offset:1024
  ds_write_b128 v25, v[248:251] offset:2048
  ds_write_b128 v25, v[252:255] offset:3072
  s_add_u32 s49, s49, 1
  s_add_u32 s41, s41, 16384
  s_cmp_ge_u32 s41, s53
  s_cselect_b32 s34, s53, 0
  s_sub_u32 s41, s41, s34
  v_add_u32 v12, 1, v12
  s_waitcnt lgkmcnt(0)
  ds_write_b32 v13, v12
  s_waitcnt vmcnt(6)
  ds_read_b64_tr_b16 v[160:161], v20 offset:4096
  ds_read_b64_tr_b16 v[164:165], v21 offset:4096
  ds_read_b64_tr_b16 v[168:169], v22 offset:4096
  ds_read_b64_tr_b16 v[172:173], v23 offset:4096
  s_waitcnt lgkmcnt(0)
  s_mov_b32 s61, 294912
  s_add_u32 m0, s52, 2048
  s_nop 0
  buffer_load_dwordx4 v16, s[28:31], s61 offen offset:0 lds
  s_add_u32 m0, s52, 2048
  s_nop 0
  buffer_load_dwordx4 v17, s[28:31], s61 offen offset:1024 lds
  s_sub_u32 s40, s49, s60
  s_cmp_ge_i32 s39, s40
  s_cbranch_scc1 L_go44
  s_mov_b32 s43, 1048576
L_poll44:
  ds_read_b128 v[8:11], v14 offset:0
  s_waitcnt lgkmcnt(0)
  v_min3_u32 v8, v8, v9, v10
  v_min_u32 v8, v8, v11
  s_sub_u32 s43, s43, 1
  v_readfirstlane_b32 s39, v8
  s_cbranch_scc1 L_end
  s_cmp_ge_i32 s39, s40
  s_cbranch_scc1 L_go44
  s_sleep 1
  s_branch L_poll44
L_go44:
  v_add_u32 v25, s41, v24
  s_waitcnt vmcnt(32)
  ds_write_b128 v25, v[80:83] offset:0
  ds_write_b128 v25, v[84:87] offset:1024
  ds_write_b128 v25, v[88:91] offset:2048
  ds_write_b128 v25, v[92:95] offset:3072
  s_add_u32 s49, s49, 1
  s_add_u32 s41, s41, 16384
  s_cmp_ge_u32 s41, s53
  s_cselect_b32 s34, s53, 0
  s_sub_u32 s41, s41, s34
  v_add_u32 v12, 1, v12
  s_waitcnt lgkmcnt(0)
  ds_write_b32 v13, v12
  s_waitcnt vmcnt(4)
  ds_read_b64_tr_b16 v[162:163], v20 offset:0
  ds_read_b64_tr_b16 v[166:167], v21 offset:0
  ds_read_b64_tr_b16 v[170:171], v22 offset:0
  ds_read_b64_tr_b16 v[174:175], v23 offset:0
  s_waitcnt lgkmcnt(0)
  s_mov_b32 s61, 65536
  s_add_u32 m0, s52, 4096
  s_nop 0
  buffer_load_dwordx4 v16, s[28:31], s61 offen offset:0 lds
  s_add_u32 m0, s52, 4096
  s_nop 0
  buffer_load_dwordx4 v17, s[28:31], s61 offen offset:1024 lds
  s_sub_u32 s40, s49, s60
  s_cmp_ge_i32 s39, s40
  s_cbranch_scc1 L_go45
  s_mov_b32 s43, 1048576
L_poll45:
  ds_read_b128 v[8:11], v14 offset:0
  s_waitcnt lgkmcnt(0)
  v_min3_u32 v8, v8, v9, v10
  v_min_u32 v8, v8, v11
  s_sub_u32 s43, s43, 1
  v_readfirstlane_b32 s39, v8
  s_cbranch_scc1 L_end
  s_cmp_ge_i32 s39, s40
  s_cbranch_scc1 L_go45
  s_sleep 1
  s_branch L_poll45
L_go45:
  v_add_u32 v25, s41, v24
  s_waitcnt vmcnt(24)
  ds_write_b128 v25, v[128:131] offset:0
  ds_write_b128 v25, v[132:135] offset:1024
  ds_write_b128 v25, v[136:139] offset:2048
  ds_write_b128 v25, v[140:143] offset:3072
  s_add_u32 s49, s49, 1
  s_add_u32 s41, s41, 16384
  s_cmp_ge_u32 s41, s53
  s_cselect_b32 s34, s53, 0
  s_sub_u32 s41, s41, s34
  v_add_u32 v12, 1, v12
  s_waitcnt lgkmcnt(0)
  ds_write_b32 v13, v12
  s_waitcnt lgkmcnt(0)
  s_mov_b32 s61, 81920
  s_add_u32 m0, s52, 0
  s_nop 0
  buffer_load_dwordx4 v16, s[28:31], s61 offen offset:0 lds
  s_bitcmp1_b32 s81, 0
  s_waitcnt vmcnt(19)
  s_cbranch_scc0 L_w46
  s_waitcnt vmcnt(16)
L_w46:
  buffer_load_dwordx4 v[128:131], v6, s[24:27], s42 offen offset:0 nt
  s_bitcmp1_b32 s81, 1
  s_waitcnt vmcnt(19)
  s_cbranch_scc0 L_w47
  s_waitcnt vmcnt(12)
L_w47:
  buffer_load_dwordx4 v[132:135], v7, s[24:27], s42 offen offset:1024 nt
  s_add_u32 m0, s52, 0
  s_nop 0
  buffer_load_dwordx4 v17, s[28:31], s61 offen offset:1024 lds
  s_bitcmp1_b32 s81, 2
  s_waitcnt vmcnt(6)
  s_cbranch_scc0 L_w48
  s_waitcnt vmcnt(6)
L_w48:
  buffer_load_dwordx4 v[136:139], v6, s[24:27], s42 offen offset:2048 nt
  ds_read_b64_tr_b16 v[192:193], v20 offset:2048
  ds_read_b64_tr_b16 v[196:197], v21 offset:2048
  ds_read_b64_tr_b16 v[200:201], v22 offset:2048
  ds_read_b64_tr_b16 v[204:205], v23 offset:2048
  s_bitcmp1_b32 s81, 3
  s_waitcnt vmcnt(15)
  s_cbranch_scc0 L_w49
  s_waitcnt vmcnt(12)
L_w49:
  buffer_load_dwordx4 v[140:143], v7, s[24:27], s42 offen offset:3072 nt
  s_add_u32 s42, s42, 16384
  s_sub_u32 s40, s49, s60
  s_cmp_ge_i32 s39, s40
  s_cbranch_scc1 L_go50
  s_mov_b32 s43, 1048576
L_poll50:
  ds_read_b128 v[8:11], v14 offset:0
  s_waitcnt lgkmcnt(0)
  v_min3_u32 v8, v8, v9, v10
  v_min_u32 v8, v8, v11
  s_sub_u32 s43, s43, 1
  v_readfirstlane_b32 s39, v8
  s_cbranch_scc1 L_end
  s_cmp_ge_i32 s39, s40
  s_cbranch_scc1 L_go50
  s_sleep 1
  s_branch L_poll50
L_go50:
  v_add_u32 v25, s41, v24
  s_waitcnt vmcnt(20)
  ds_write_b128 v25, v[176:179] offset:0
  ds_write_b128 v25, v[180:183] offset:1024
  ds_write_b128 v25, v[184:187] offset:2048
  ds_write_b128 v25, v[188:191] offset:3072
  s_add_u32 s49, s49, 1
  s_add_u32 s41, s41, 16384
  s_cmp_ge_u32 s41, s53
  s_cselect_b32 s34, s53, 0
  s_sub_u32 s41, s41, s34
  v_add_u32 v12, 1, v12
  s_waitcnt lgkmcnt(0)
  ds_write_b32 v13, v12
  s_waitcnt vmcnt(6)
  ds_read_b64_tr_b16 v[80:81], v20 offset:4096
  ds_read_b64_tr_b16 v[84:85], v21 offset:4096
  ds_read_b64_tr_b16 v[88:89], v22 offset:4096
  ds_read_b64_tr_b16 v[92:93], v23 offset:4096
  s_waitcnt lgkmcnt(0)
  s_mov_b32 s61, 262144
  s_add_u32 m0, s52, 2048
  s_nop 0
  buffer_load_dwordx4 v16, s[28:31], s61 offen offset:0 lds
  s_add_u32 m0, s52, 2048
  s_nop 0
  buffer_load_dwordx4 v17, s[28:31], s61 offen offset:1024 lds
  s_sub_u32 s40, s49, s60
  s_cmp_ge_i32 s39, s40
  s_cbranch_scc1 L_go51
  s_mov_b32 s43, 1048576
L_poll51:
  ds_read_b128 v[8:11], v14 offset:0
  s_waitcnt lgkmcnt(0)
  v_min3_u32 v8, v8, v9, v10
  v_min_u32 v8, v8, v11
  s_sub_u32 s43, s43, 1
  v_readfirstlane_b32 s39, v8
  s_cbranch_scc1 L_end
  s_cmp_ge_i32 s39, s40
  s_cbranch_scc1 L_go51
  s_sleep 1
  s_branch L_poll51
L_go51:
  v_add_u32 v25, s41, v24
  s_waitcnt vmcnt(12)
  ds_write_b128 v25, v[224:227] offset:0
  ds_write_b128 v25, v[228:231] offset:1024
  ds_write_b128 v25, v[232:235] offset:2048
  ds_write_b128 v25, v[236:239] offset:3072
  s_add_u32 s49, s49, 1
  s_add_u32 s41, s41, 16384
  s_cmp_ge_u32 s41, s53
  s_cselect_b32 s34, s53, 0
  s_sub_u32 s41, s41, s34
  v_add_u32 v12, 1, v12
  s_waitcnt lgkmcnt(0)
  ds_write_b32 v13, v12
  s_waitcnt vmcnt(4)
  ds_read_b64_tr_b16 v[82:83], v20 offset:0
  ds_read_b64_tr_b16 v[86:87], v21 offset:0
  ds_read_b64_tr_b16 v[90:91], v22 offset:0
  ds_read_b64_tr_b16 v[94:95], v23 offset:0
  s_waitcnt lgkmcnt(0)
  s_mov_b32 s61, 278528
  s_add_u32 m0, s52, 4096
  s_nop 0
  buffer_load_dwordx4 v16, s[28:31], s61 offen offset:0 lds
  s_add_u32 m0, s52, 4096
  s_nop 0
  buffer_load_dwordx4 v17, s[28:31], s61 offen offset:1024 lds
  s_sub_u32 s40, s49, s60
  s_cmp_ge_i32 s39, s40
  s_cbranch_scc1 L_go52
  s_mov_b32 s43, 1048576
L_poll52:
  ds_read_b128 v[8:11], v14 offset:0
  s_waitcnt lgkmcnt(0)
  v_min3_u32 v8, v8, v9, v10
  v_min_u32 v8, v8, v11
  s_sub_u32 s43, s43, 1
  v_readfirstlane_b32 s39, v8
  s_cbranch_scc1 L_end
  s_cmp_ge_i32 s39, s40
  s_cbranch_scc1 L_go52
  s_sleep 1
  s_branch L_poll52
L_go52:
  v_add_u32 v25, s41, v24
  s_waitcnt vmcnt(4)
  ds_write_b128 v25, v[128:131] offset:0
  ds_write_b128 v25, v[132:135] offset:1024
  ds_write_b128 v25, v[136:139] offset:2048
  ds_write_b128 v25, v[140:143] offset:3072
  s_add_u32 s49, s49, 1
  s_add_u32 s41, s41, 16384
  s_cmp_ge_u32 s41, s53
  s_cselect_b32 s34, s53, 0
  s_sub_u32 s41, s41, s34
  v_add_u32 v12, 1, v12
  s_waitcnt lgkmcnt(0)
  ds_write_b32 v13, v12
  s_waitcnt vmcnt(2)
  ds_read_b64_tr_b16 v[176:177], v20 offset:2048
  ds_read_b64_tr_b16 v[180:181], v21 offset:2048
  ds_read_b64_tr_b16 v[184:185], v22 offset:2048
  ds_read_b64_tr_b16 v[188:189], v23 offset:2048
  s_waitcnt lgkmcnt(0)
  s_mov_b32 s61, 163840
  s_add_u32 m0, s52, 0
  s_nop 0
  buffer_load_dwordx4 v16, s[28:31], s61 offen offset:0 lds
  s_add_u32 m0, s52, 0
  s_nop 0
  buffer_load_dwordx4 v17, s[28:31], s61 offen offset:1024 lds
  s_mov_b32 s81, 0
  s_sub_u32 s40, s49, s60
  s_cmp_ge_i32 s39, s40
  s_cbranch_scc1 L_go53
  s_mov_b32 s43, 1048576
L_poll53:
  ds_read_b128 v[8:11], v14 offset:0
  s_waitcnt lgkmcnt(0)
  v_min3_u32 v8, v8, v9, v10
  v_min_u32 v8, v8, v11
  s_sub_u32 s43, s43, 1
  v_readfirstlane_b32 s39, v8
  s_cbranch_scc1 L_end
  s_cmp_ge_i32 s39, s40
  s_cbranch_scc1 L_go53
  s_sleep 1
  s_branch L_poll53
L_go53:
  s_waitcnt lgkmcnt(0)
  s_mov_b32 s61, 180224
  s_add_u32 m0, s52, 2048
  s_nop 0
  buffer_load_dwordx4 v16, s[28:31], s61 offen offset:0 lds
  s_mov_b32 m0, s41
  s_bitcmp1_b32 s81, 0
  s_waitcnt vmcnt(21)
  s_cbranch_scc0 L_w54
  s_waitcnt vmcnt(18)
L_w54:
  buffer_load_dwordx4 v4, s[20:23], s42 offen offset:0 nt lds
  s_bitcmp1_b32 s81, 1
  s_waitcnt vmcnt(21)
  s_cbranch_scc0 L_w55
  s_waitcnt vmcnt(14)
L_w55:
  buffer_load_dwordx4 v4, s[20:23], s42 offen offset:1024 nt lds
  s_add_u32 m0, s52, 2048
  s_nop 0
  buffer_load_dwordx4 v17, s[28:31], s61 offen offset:1024 lds
  s_mov_b32 m0, s41
  s_bitcmp1_b32 s81, 2
  s_waitcnt vmcnt(6)
  s_cbranch_scc0 L_w56
  s_waitcnt vmcnt(6)
L_w56:
  buffer_load_dwordx4 v5, s[20:23], s42 offen offset:2048 nt lds
  ds_read_b64_tr_b16 v[178:179], v20 offset:4096
  ds_read_b64_tr_b16 v[182:183], v21 offset:4096
  ds_read_b64_tr_b16 v[186:187], v22 offset:4096
  ds_read_b64_tr_b16 v[190:191], v23 offset:4096
  s_bitcmp1_b32 s81, 3
  s_waitcnt vmcnt(17)
  s_cbranch_scc0 L_w57
  s_waitcnt vmcnt(14)
L_w57:
  buffer_load_dwordx4 v5, s[20:23], s42 offen offset:3072 nt lds
  s_add_u32 s49, s49, 1
  s_add_u32 s41, s41, 16384
  s_cmp_ge_u32 s41, s53
  s_cselect_b32 s34, s53, 0
  s_sub_u32 s41, s41, s34
  s_sub_u32 s40, s49, s60
  s_cmp_ge_i32 s39, s40
  s_cbranch_scc1 L_go58
  s_mov_b32 s43, 1048576
L_poll58:
  ds_read_b128 v[8:11], v14 offset:0
  s_waitcnt lgkmcnt(0)
  v_min3_u32 v8, v8, v9, v10
  v_min_u32 v8, v8, v11
  s_sub_u32 s43, s43, 1
  v_readfirstlane_b32 s39, v8
  s_cbranch_scc1 L_end
  s_cmp_ge_i32 s39, s40
  s_cbranch_scc1 L_go58
  s_sleep 1
  s_branch L_poll58
L_go58:
  s_waitcnt lgkmcnt(0)
  s_mov_b32 s61, 311296
  s_add_u32 m0, s52, 4096
  s_nop 0
  buffer_load_dwordx4 v16, s[28:31], s61 offen offset:0 lds
  s_mov_b32 m0, s41
  s_bitcmp1_b32 s81, 0
  s_waitcnt vmcnt(17)
  s_cbranch_scc0 L_w59
  s_waitcnt vmcnt(14)
L_w59:
  buffer_load_dwordx4 v6, s[24:27], s42 offen offset:0 nt lds
  s_bitcmp1_b32 s81, 1
  s_waitcnt vmcnt(17)
  s_cbranch_scc0 L_w60
  s_waitcnt vmcnt(8)
L_w60:
  buffer_load_dwordx4 v7, s[24:27], s42 offen offset:1024 nt lds
  s_add_u32 m0, s52, 4096
  s_nop 0
  buffer_load_dwordx4 v17, s[28:31], s61 offen offset:1024 lds
  s_mov_b32 m0, s41
  s_bitcmp1_b32 s81, 2
  s_waitcnt vmcnt(10)
  s_cbranch_scc0 L_w61
  s_waitcnt vmcnt(8)
L_w61:
  buffer_load_dwordx4 v6, s[24:27], s42 offen offset:2048 nt lds
  ds_read_b64_tr_b16 v[128:129], v20 offset:0
  ds_read_b64_tr_b16 v[132:133], v21 offset:0
  ds_read_b64_tr_b16 v[136:137], v22 offset:0
  ds_read_b64_tr_b16 v[140:141], v23 offset:0
  s_bitcmp1_b32 s81, 3
  s_waitcnt vmcnt(11)
  s_cbranch_scc0 L_w62
  s_waitcnt vmcnt(8)
L_w62:
  buffer_load_dwordx4 v7, s[24:27], s42 offen offset:3072 nt lds
  s_add_u32 s42, s42, 16384
  s_add_u32 s49, s49, 1
  s_add_u32 s41, s41, 16384
  s_cmp_ge_u32 s41, s53
  s_cselect_b32 s34, s53, 0
  s_sub_u32 s41, s41, s34
  s_sub_u32 s40, s49, s60
  s_cmp_ge_i32 s39, s40
  s_cbranch_scc1 L_go63
  s_mov_b32 s43, 1048576
L_poll63:
  ds_read_b128 v[8:11], v14 offset:0
  s_waitcnt lgkmcnt(0)
  v_min3_u32 v8, v8, v9, v10
  v_min_u32 v8, v8, v11
  s_sub_u32 s43, s43, 1
  v_readfirstlane_b32 s39, v8
  s_cbranch_scc1 L_end
  s_cmp_ge_i32 s39, s40
  s_cbranch_scc1 L_go63
  s_sleep 1
  s_branch L_poll63
L_go63:
  s_waitcnt lgkmcnt(0)
  s_mov_b32 s61, 327680
  s_add_u32 m0, s52, 0
  s_nop 0
  buffer_load_dwordx4 v16, s[28:31], s61 offen offset:0 lds
  s_mov_b32 m0, s41
  v_add_u32 v12, 1, v12
  s_bitcmp1_b32 s81, 0
  s_waitcnt vmcnt(11)
  s_cbranch_scc0 L_w64
  s_waitcnt vmcnt(8)
L_w64:
  buffer_load_dwordx4 v4, s[20:23], s42 offen offset:0 nt lds
  s_bitcmp1_b32 s81, 1
  s_waitcnt vmcnt(11)
  s_cbranch_scc0 L_w65
  s_waitcnt vmcnt(8)
  ds_write_b32 v13, v12
L_w65:
  buffer_load_dwordx4 v4, s[20:23], s42 offen offset:1024 nt lds
  s_add_u32 m0, s52, 0
  s_nop 0
  buffer_load_dwordx4 v17, s[28:31], s61 offen offset:1024 lds
  s_mov_b32 m0, s41
  s_bitcmp1_b32 s81, 2
  s_waitcnt vmcnt(11)
  s_cbranch_scc0 L_w66
  s_waitcnt vmcnt(8)
L_w66:
  buffer_load_dwordx4 v5, s[20:23], s42 offen offset:2048 nt lds
  ds_read_b64_tr_b16 v[130:131], v20 offset:2048
  ds_read_b64_tr_b16 v[134:135], v21 offset:2048
  ds_read_b64_tr_b16 v[138:139], v22 offset:2048
  ds_read_b64_tr_b16 v[142:143], v23 offset:2048
  s_bitcmp1_b32 s81, 3
  s_waitcnt vmcnt(11)
  ds_write_b32 v13, v12
  s_cbranch_scc0 L_w67
  s_waitcnt vmcnt(8)
L_w67:
  buffer_load_dwordx4 v5, s[20:23], s42 offen offset:3072 nt lds
  s_add_u32 s49, s49, 1
  s_add_u32 s41, s41, 16384
  s_cmp_ge_u32 s41, s53
  s_cselect_b32 s34, s53, 0
  s_sub_u32 s41, s41, s34
  s_sub_u32 s40, s49, s60
  s_cmp_ge_i32 s39, s40
  s_cbranch_scc1 L_go68
  s_mov_b32 s43, 1048576
L_poll68:
  ds_read_b128 v[8:11], v14 offset:0
  s_waitcnt lgkmcnt(0)
  v_min3_u32 v8, v8, v9, v10
  v_min_u32 v8, v8, v11
  s_sub_u32 s43, s43, 1
  v_readfirstlane_b32 s39, v8
  s_cbranch_scc1 L_end
  s_cmp_ge_i32 s39, s40
  s_cbranch_scc1 L_go68
  s_sleep 1
  s_branch L_poll68
L_go68:
  s_waitcnt lgkmcnt(0)
  s_mov_b32 s61, 344064
  s_add_u32 m0, s52, 2048
  s_nop 0
  buffer_load_dwordx4 v16, s[28:31], s61 offen offset:0 lds
  s_mov_b32 m0, s41
  v_add_u32 v12, 1, v12
  s_bitcmp1_b32 s81, 0
  s_waitcnt vmcnt(11)
  s_cbranch_scc0 L_w69
  s_waitcnt vmcnt(8)
L_w69:
  buffer_load_dwordx4 v6, s[24:27], s42 offen offset:0 nt lds
  s_bitcmp1_b32 s81, 1
  s_waitcnt vmcnt(11)
  s_cbranch_scc0 L_w70
  s_waitcnt vmcnt(8)
  ds_write_b32 v13, v12
L_w70:
  buffer_load_dwordx4 v7, s[24:27], s42 offen offset:1024 nt lds
  s_add_u32 m0, s52, 2048
  s_nop 0
  buffer_load_dwordx4 v17, s[28:31], s61 offen offset:1024 lds
  s_mov_b32 m0, s41
  s_bitcmp1_b32 s81, 2
  s_waitcnt vmcnt(11)
  s_cbranch_scc0 L_w71
  s_waitcnt vmcnt(8)
L_w71:
  buffer_load_dwordx4 v6, s[24:27], s42 offen offset:2048 nt lds
  ds_read_b64_tr_b16 v[194:195], v20 offset:4096
  ds_read_b64_tr_b16 v[198:199], v21 offset:4096
  ds_read_b64_tr_b16 v[202:203], v22 offset:4096
  ds_read_b64_tr_b16 v[206:207], v23 offset:4096
  s_bitcmp1_b32 s81, 3
  s_waitcnt vmcnt(11)
  ds_write_b32 v13, v12
  s_cbranch_scc0 L_w72
  s_waitcnt vmcnt(8)
L_w72:
  buffer_load_dwordx4 v7, s[24:27], s42 offen offset:3072 nt lds
  s_add_u32 s42, s42, 16384
  s_add_u32 s49, s49, 1
  s_add_u32 s41, s41, 16384
  s_cmp_ge_u32 s41, s53
  s_cselect_b32 s34, s53, 0
  s_sub_u32 s41, s41, s34
  s_sub_u32 s40, s49, s60
  s_cmp_ge_i32 s39, s40
  s_cbranch_scc1 L_go73
  s_mov_b32 s43, 1048576
L_poll73:
  ds_read_b128 v[8:11], v14 offset:0
  s_waitcnt lgkmcnt(0)
  v_min3_u32 v8, v8, v9, v10
  v_min_u32 v8, v8, v11
  s_sub_u32 s43, s43, 1
  v_readfirstlane_b32 s39, v8
  s_cbranch_scc1 L_end
  s_cmp_ge_i32 s39, s40
  s_cbranch_scc1 L_go73
  s_sleep 1
  s_branch L_poll73
L_go73:
  s_waitcnt lgkmcnt(0)
  s_mov_b32 s61, 360448
  s_add_u32 m0, s52, 4096
  s_nop 0
  buffer_load_dwordx4 v16, s[28:31], s61 offen offset:0 lds
  s_mov_b32 m0, s41
  v_add_u32 v12, 1, v12
  s_bitcmp1_b32 s81, 0
  s_waitcnt vmcnt(11)
  s_cbranch_scc0 L_w74
  s_waitcnt vmcnt(8)
L_w74:
  buffer_load_dwordx4 v4, s[20:23], s42 offen offset:0 nt lds
  s_bitcmp1_b32 s81, 1
  s_waitcnt vmcnt(11)
  s_cbranch_scc0 L_w75
  s_waitcnt vmcnt(8)
  ds_write_b32 v13, v12
L_w75:
  buffer_load_dwordx4 v4, s[20:23], s42 offen offset:1024 nt lds
  s_add_u32 m0, s52, 4096
  s_nop 0
  buffer_load_dwordx4 v17, s[28:31], s61 offen offset:1024 lds
  s_mov_b32 m0, s41
  s_bitcmp1_b32 s81, 2
  s_waitcnt vmcnt(11)
  s_cbranch_scc0 L_w76
  s_waitcnt vmcnt(8)
L_w76:
  buffer_load_dwordx4 v5, s[20:23], s42 offen offset:2048 nt lds
  ds_read_b64_tr_b16 v[208:209], v20 offset:0
  ds_read_b64_tr_b16 v[212:213], v21 offset:0
  ds_read_b64_tr_b16 v[216:217], v22 offset:0
  ds_read_b64_tr_b16 v[220:221], v23 offset:0
  s_bitcmp1_b32 s81, 3
  s_waitcnt vmcnt(11)
  ds_write_b32 v13, v12
  s_cbranch_scc0 L_w77
  s_waitcnt vmcnt(8)
L_w77:
  buffer_load_dwordx4 v5, s[20:23], s42 offen offset:3072 nt lds
  s_add_u32 s49, s49, 1
  s_add_u32 s41, s41, 16384
  s_cmp_ge_u32 s41, s53
  s_cselect_b32 s34, s53, 0
  s_sub_u32 s41, s41, s34
  s_sub_u32 s40, s49, s60
  s_cmp_ge_i32 s39, s40
  s_cbranch_scc1 L_go78
  s_mov_b32 s43, 1048576
L_poll78:
  ds_read_b128 v[8:11], v14 offset:0
  s_waitcnt lgkmcnt(0)
  v_min3_u32 v8, v8, v9, v10
  v_min_u32 v8, v8, v11
  s_sub_u32 s43, s43, 1
  v_readfirstlane_b32 s39, v8
  s_cbranch_scc1 L_end
  s_cmp_ge_i32 s39, s40
  s_cbranch_scc1 L_go78
  s_sleep 1
  s_branch L_poll78
L_go78:
  s_waitcnt lgkmcnt(0)
  s_mov_b32 s61, 376832
  s_add_u32 m0, s52, 0
  s_nop 0
  buffer_load_dwordx4 v16, s[28:31], s61 offen offset:0 lds
  s_mov_b32 m0, s41
  v_add_u32 v12, 1, v12
  s_bitcmp1_b32 s81, 0
  s_waitcnt vmcnt(11)
  s_cbranch_scc0 L_w79
  s_waitcnt vmcnt(8)
L_w79:
  buffer_load_dwordx4 v6, s[24:27], s42 offen offset:0 nt lds
  s_bitcmp1_b32 s81, 1
  s_waitcnt vmcnt(11)
  s_cbranch_scc0 L_w80
  s_waitcnt vmcnt(8)
  ds_write_b32 v13, v12
L_w80:
  buffer_load_dwordx4 v7, s[24:27], s42 offen offset:1024 nt lds
  s_add_u32 m0, s52, 0
  s_nop 0
  buffer_load_dwordx4 v17, s[28:31], s61 offen offset:1024 lds
  s_mov_b32 m0, s41
  s_bitcmp1_b32 s81, 2
  s_waitcnt vmcnt(11)
  s_cbranch_scc0 L_w81
  s_waitcnt vmcnt(8)
L_w81:
  buffer_load_dwordx4 v6, s[24:27], s42 offen offset:2048 nt lds
  ds_read_b64_tr_b16 v[210:211], v20 offset:2048
  ds_read_b64_tr_b16 v[214:215], v21 offset:2048
  ds_read_b64_tr_b16 v[218:219], v22 offset:2048
  ds_read_b64_tr_b16 v[222:223], v23 offset:2048
  s_bitcmp1_b32 s81, 3
  s_waitcnt vmcnt(11)
  ds_write_b32 v13, v12
  s_cbranch_scc0 L_w82
  s_waitcnt vmcnt(8)
L_w82:
  buffer_load_dwordx4 v7, s[24:27], s42 offen offset:3072 nt lds
  s_add_u32 s42, s42, 16384
  s_add_u32 s49, s49, 1
  s_add_u32 s41, s41, 16384
  s_cmp_ge_u32 s41, s53
  s_cselect_b32 s34, s53, 0
  s_sub_u32 s41, s41, s34
  s_mov_b32 s81, 15
  s_mov_b32 s53, 65536
  s_sub_u32 s40, s49, s60
  s_cmp_ge_i32 s39, s40
  s_cbranch_scc1 L_go83
  s_mov_b32 s43, 1048576
L_poll83:
  ds_read_b128 v[8:11], v14 offset:0
  s_waitcnt lgkmcnt(0)
  v_min3_u32 v8, v8, v9, v10
  v_min_u32 v8, v8, v11
  s_sub_u32 s43, s43, 1
  v_readfirstlane_b32 s39, v8
  s_cbranch_scc1 L_end
  s_cmp_ge_i32 s39, s40
  s_cbranch_scc1 L_go83
  s_sleep 1
  s_branch L_poll83
L_go83:
  s_waitcnt lgkmcnt(0)
  s_mov_b32 s61, 393216
  s_add_u32 m0, s52, 2048
  s_nop 0
  buffer_load_dwordx4 v16, s[28:31], s61 offen offset:0 lds
  s_mov_b32 m0, s41
  v_add_u32 v12, 1, v12
  s_bitcmp1_b32 s81, 0
  s_waitcnt vmcnt(11)
  s_cbranch_scc0 L_w84
  s_waitcnt vmcnt(8)
L_w84:
  buffer_load_dwordx4 v4, s[20:23], s42 offen offset:0 nt lds
  s_bitcmp1_b32 s81, 1
  s_waitcnt vmcnt(11)
  s_cbranch_scc0 L_w85
  s_waitcnt vmcnt(8)
  ds_write_b32 v13, v12
L_w85:
  buffer_load_dwordx4 v4, s[20:23], s42 offen offset:1024 nt lds
  s_add_u32 m0, s52, 2048
  s_nop 0
  buffer_load_dwordx4 v17, s[28:31], s61 offen offset:1024 lds
  s_mov_b32 m0, s41
  s_bitcmp1_b32 s81, 2
  s_waitcnt vmcnt(11)
  s_cbranch_scc0 L_w86
  s_waitcnt vmcnt(8)
L_w86:
  buffer_load_dwordx4 v5, s[20:23], s42 offen offset:2048 nt lds
  ds_read_b64_tr_b16 v[224:225], v20 offset:4096
  ds_read_b64_tr_b16 v[228:229], v21 offset:4096
  ds_read_b64_tr_b16 v[232:233], v22 offset:4096
  ds_read_b64_tr_b16 v[236:237], v23 offset:4096
  s_bitcmp1_b32 s81, 3
  s_waitcnt vmcnt(11)
  ds_write_b32 v13, v12
  s_cbranch_scc0 L_w87
  s_waitcnt vmcnt(8)
L_w87:
  buffer_load_dwordx4 v5, s[20:23], s42 offen offset:3072 nt lds
  s_add_u32 s49, s49, 1
  s_add_u32 s41, s41, 16384
  s_cmp_ge_u32 s41, s53
  s_cselect_b32 s34, s53, 0
  s_sub_u32 s41, s41, s34
  s_sub_u32 s40, s49, s60
  s_cmp_ge_i32 s39, s40
  s_cbranch_scc1 L_go88
  s_mov_b32 s43, 1048576
L_poll88:
  ds_read_b128 v[8:11], v14 offset:0
  s_waitcnt lgkmcnt(0)
  v_min3_u32 v8, v8, v9, v10
  v_min_u32 v8, v8, v11
  s_sub_u32 s43, s43, 1
  v_readfirstlane_b32 s39, v8
  s_cbranch_scc1 L_end
  s_cmp_ge_i32 s39, s40
  s_cbranch_scc1 L_go88
  s_sleep 1
  s_branch L_poll88
L_go88:
  s_waitcnt lgkmcnt(0)
  s_mov_b32 s61, 409600
  s_add_u32 m0, s52, 4096
  s_nop 0
  buffer_load_dwordx4 v16, s[28:31], s61 offen offset:0 lds
  s_mov_b32 m0, s41
  v_add_u32 v12, 1, v12
  s_bitcmp1_b32 s81, 0
  s_waitcnt vmcnt(11)
  s_cbranch_scc0 L_w89
  s_waitcnt vmcnt(8)
L_w89:
  buffer_load_dwordx4 v6, s[24:27], s42 offen offset:0 nt lds
  s_bitcmp1_b32 s81, 1
  s_waitcnt vmcnt(11)
  s_cbranch_scc0 L_w90
  s_waitcnt vmcnt(8)
  ds_write_b32 v13, v12
L_w90:
  buffer_load_dwordx4 v7, s[24:27], s42 offen offset:1024 nt lds
  s_add_u32 m0, s52, 4096
  s_nop 0
  buffer_load_dwordx4 v17, s[28:31], s61 offen offset:1024 lds
  s_mov_b32 m0, s41
  s_bitcmp1_b32 s81, 2
  s_waitcnt vmcnt(11)
  s_cbranch_scc0 L_w91
  s_waitcnt vmcnt(8)
L_w91:
  buffer_load_dwordx4 v6, s[24:27], s42 offen offset:2048 nt lds
  ds_read_b64_tr_b16 v[226:227], v20 offset:0
  ds_read_b64_tr_b16 v[230:231], v21 offset:0
  ds_read_b64_tr_b16 v[234:235], v22 offset:0
  ds_read_b64_tr_b16 v[238:239], v23 offset:0
  s_bitcmp1_b32 s81, 3
  s_waitcnt vmcnt(11)
  ds_write_b32 v13, v12
  s_cbranch_scc0 L_w92
  s_waitcnt vmcnt(8)
L_w92:
  buffer_load_dwordx4 v7, s[24:27], s42 offen offset:3072 nt lds
  s_add_u32 s42, s42, 16384
  s_add_u32 s49, s49, 1
  s_add_u32 s41, s41, 16384
  s_cmp_ge_u32 s41, s53
  s_cselect_b32 s34, s53, 0
  s_sub_u32 s41, s41, s34
  s_sub_u32 s40, s49, s60
  s_cmp_ge_i32 s39, s40
  s_cbranch_scc1 L_go93
  s_mov_b32 s43, 1048576
L_poll93:
  ds_read_b128 v[8:11], v14 offset:0
  s_waitcnt lgkmcnt(0)
  v_min3_u32 v8, v8, v9, v10
  v_min_u32 v8, v8, v11
  s_sub_u32 s43, s43, 1
  v_readfirstlane_b32 s39, v8
  s_cbranch_scc1 L_end
  s_cmp_ge_i32 s39, s40
  s_cbranch_scc1 L_go93
  s_sleep 1
  s_branch L_poll93
L_go93:
  s_waitcnt lgkmcnt(0)
  s_mov_b32 s61, 425984
  s_add_u32 m0, s52, 0
  s_nop 0
  buffer_load_dwordx4 v16, s[28:31], s61 offen offset:0 lds
  s_mov_b32 m0, s41
  v_add_u32 v12, 1, v12
  s_bitcmp1_b32 s81, 0
  s_waitcnt vmcnt(11)
  s_cbranch_scc0 L_w94
  s_waitcnt vmcnt(8)
L_w94:
  buffer_load_dwordx4 v4, s[20:23], s42 offen offset:0 nt lds
  s_bitcmp1_b32 s81, 1
  s_waitcnt vmcnt(11)
  s_cbranch_scc0 L_w95
  s_waitcnt vmcnt(8)
  ds_write_b32 v13, v12
L_w95:
  buffer_load_dwordx4 v4, s[20:23], s42 offen offset:1024 nt lds
  s_add_u32 m0, s52, 0
  s_nop 0
  buffer_load_dwordx4 v17, s[28:31], s61 offen offset:1024 lds
  s_mov_b32 m0, s41
  s_bitcmp1_b32 s81, 2
  s_waitcnt vmcnt(11)
  s_cbranch_scc0 L_w96
  s_waitcnt vmcnt(8)
L_w96:
  buffer_load_dwordx4 v5, s[20:23], s42 offen offset:2048 nt lds
  ds_read_b64_tr_b16 v[240:241], v20 offset:2048
  ds_read_b64_tr_b16 v[244:245], v21 offset:2048
  ds_read_b64_tr_b16 v[248:249], v22 offset:2048
  ds_read_b64_tr_b16 v[252:253], v23 offset:2048
  s_bitcmp1_b32 s81, 3
  s_waitcnt vmcnt(11)
  ds_write_b32 v13, v12
  s_cbranch_scc0 L_w97
  s_waitcnt vmcnt(8)
L_w97:
  buffer_load_dwordx4 v5, s[20:23], s42 offen offset:3072 nt lds
  s_add_u32 s49, s49, 1
  s_add_u32 s41, s41, 16384
  s_cmp_ge_u32 s41, s53
  s_cselect_b32 s34, s53, 0
  s_sub_u32 s41, s41, s34
  s_sub_u32 s40, s49, s60
  s_cmp_ge_i32 s39, s40
  s_cbranch_scc1 L_go98
  s_mov_b32 s43, 1048576
L_poll98:
  ds_read_b128 v[8:11], v14 offset:0
  s_waitcnt lgkmcnt(0)
  v_min3_u32 v8, v8, v9, v10
  v_min_u32 v8, v8, v11
  s_sub_u32 s43, s43, 1
  v_readfirstlane_b32 s39, v8
  s_cbranch_scc1 L_end
  s_cmp_ge_i32 s39, s40
  s_cbranch_scc1 L_go98
  s_sleep 1
  s_branch L_poll98
L_go98:
  s_waitcnt lgkmcnt(0)
  s_mov_b32 s61, 442368
  s_add_u32 m0, s52, 2048
  s_nop 0
  buffer_load_dwordx4 v16, s[28:31], s61 offen offset:0 lds
  s_mov_b32 m0, s41
  v_add_u32 v12, 1, v12
  s_bitcmp1_b32 s81, 0
  s_waitcnt vmcnt(11)
  s_cbranch_scc0 L_w99
  s_waitcnt vmcnt(8)
L_w99:
  buffer_load_dwordx4 v6, s[24:27], s42 offen offset:0 nt lds
  s_bitcmp1_b32 s81, 1
  s_waitcnt vmcnt(11)
  s_cbranch_scc0 L_w100
  s_waitcnt vmcnt(8)
  ds_write_b32 v13, v12
L_w100:
  buffer_load_dwordx4 v7, s[24:27], s42 offen offset:1024 nt lds
  s_add_u32 m0, s52, 2048
  s_nop 0
  buffer_load_dwordx4 v17, s[28:31], s61 offen offset:1024 lds
  s_mov_b32 m0, s41
  s_bitcmp1_b32 s81, 2
  s_waitcnt vmcnt(11)
  s_cbranch_scc0 L_w101
  s_waitcnt vmcnt(8)
L_w101:
  buffer_load_dwordx4 v6, s[24:27], s42 offen offset:2048 nt lds
  ds_read_b64_tr_b16 v[242:243], v20 offset:4096
  ds_read_b64_tr_b16 v[246:247], v21 offset:4096
  ds_read_b64_tr_b16 v[250:251], v22 offset:4096
  ds_read_b64_tr_b16 v[254:255], v23 offset:4096
  s_bitcmp1_b32 s81, 3
  s_waitcnt vmcnt(11)
  ds_write_b32 v13, v12
  s_cbranch_scc0 L_w102
  s_waitcnt vmcnt(8)
L_w102:
  buffer_load_dwordx4 v7, s[24:27], s42 offen offset:3072 nt lds
  s_add_u32 s42, s42, 16384
  s_add_u32 s49, s49, 1
  s_add_u32 s41, s41, 16384
  s_cmp_ge_u32 s41, s53
  s_cselect_b32 s34, s53, 0
  s_sub_u32 s41, s41, s34
  s_mov_b32 s60, 0
  s_sub_u32 s40, s49, s60
  s_cmp_ge_i32 s39, s40
  s_cbranch_scc1 L_go103
  s_mov_b32 s43, 1048576
L_poll103:
  ds_read_b128 v[8:11], v14 offset:0
  s_waitcnt lgkmcnt(0)
  v_min3_u32 v8, v8, v9, v10
  v_min_u32 v8, v8, v11
  s_sub_u32 s43, s43, 1
  v_readfirstlane_b32 s39, v8
  s_cbranch_scc1 L_end
  s_cmp_ge_i32 s39, s40
  s_cbranch_scc1 L_go103
  s_sleep 1
  s_branch L_poll103
L_go103:
  s_mov_b32 m0, s41
  v_add_u32 v12, 1, v12
  s_bitcmp1_b32 s81, 0
  s_waitcnt vmcnt(10)
  s_cbranch_scc0 L_w104
  s_waitcnt vmcnt(7)
L_w104:
  buffer_load_dwordx4 v4, s[20:23], s42 offen offset:0 nt lds
  s_bitcmp1_b32 s81, 1
  s_waitcnt vmcnt(10)
  s_cbranch_scc0 L_w105
  s_waitcnt vmcnt(7)
  ds_write_b32 v13, v12
L_w105:
  buffer_load_dwordx4 v4, s[20:23], s42 offen offset:1024 nt lds
  s_bitcmp1_b32 s81, 2
  s_waitcnt vmcnt(9)
  s_cbranch_scc0 L_w106
  s_waitcnt vmcnt(6)
L_w106:
  buffer_load_dwordx4 v5, s[20:23], s42 offen offset:2048 nt lds
  s_bitcmp1_b32 s81, 3
  s_waitcnt vmcnt(9)
  ds_write_b32 v13, v12
  s_cbranch_scc0 L_w107
  s_waitcnt vmcnt(6)
L_w107:
  buffer_load_dwordx4 v5, s[20:23], s42 offen offset:3072 nt lds
  s_add_u32 s49, s49, 1
  s_add_u32 s41, s41, 16384
  s_cmp_ge_u32 s41, s53
  s_cselect_b32 s34, s53, 0
  s_sub_u32 s41, s41, s34
  s_sub_u32 s40, s49, s60
  s_cmp_ge_i32 s39, s40
  s_cbranch_scc1 L_go108
  s_mov_b32 s43, 1048576
L_poll108:
  ds_read_b128 v[8:11], v14 offset:0
  s_waitcnt lgkmcnt(0)
  v_min3_u32 v8, v8, v9, v10
  v_min_u32 v8, v8, v11
  s_sub_u32 s43, s43, 1
  v_readfirstlane_b32 s39, v8
  s_cbranch_scc1 L_end
  s_cmp_ge_i32 s39, s40
  s_cbranch_scc1 L_go108
  s_sleep 1
  s_branch L_poll108
L_go108:
  s_mov_b32 m0, s41
  v_add_u32 v12, 1, v12
  s_bitcmp1_b32 s81, 0
  s_waitcnt vmcnt(8)
  s_cbranch_scc0 L_w109
  s_waitcnt vmcnt(5)
L_w109:
  buffer_load_dwordx4 v6, s[24:27], s42 offen offset:0 nt lds
  s_bitcmp1_b32 s81, 1
  s_waitcnt vmcnt(8)
  s_cbranch_scc0 L_w110
  s_waitcnt vmcnt(5)
  ds_write_b32 v13, v12
L_w110:
  buffer_load_dwordx4 v7, s[24:27], s42 offen offset:1024 nt lds
  s_bitcmp1_b32 s81, 2
  s_waitcnt vmcnt(7)
  s_cbranch_scc0 L_w111
  s_waitcnt vmcnt(5)
L_w111:
  buffer_load_dwordx4 v6, s[24:27], s42 offen offset:2048 nt lds
  s_bitcmp1_b32 s81, 3
  s_waitcnt vmcnt(7)
  ds_write_b32 v13, v12
  s_cbranch_scc0 L_w112
  s_waitcnt vmcnt(5)
L_w112:
  buffer_load_dwordx4 v7, s[24:27], s42 offen offset:3072 nt lds
  s_add_u32 s42, s42, 16384
  s_add_u32 s49, s49, 1
  s_add_u32 s41, s41, 16384
  s_cmp_ge_u32 s41, s53
  s_cselect_b32 s34, s53, 0
  s_sub_u32 s41, s41, s34
  s_branch L_join
L_even:
  s_waitcnt lgkmcnt(0)
  s_add_u32 s20, s6, s34
  s_addc_u32 s21, s7, 0
  s_mov_b32 s22, 0x80000
  s_mov_b32 s23, 0x20000
  s_add_u32 s24, s8, s34
  s_addc_u32 s25, s9, 0
  s_mov_b32 s26, 0x80000
  s_mov_b32 s27, 0x20000
  s_barrier
  s_mul_i32 s34, s32, 131072
  s_add_u32 s54, s18, s34
  s_addc_u32 s55, s19, 0
  s_mul_i32 s34, s32, 2048
  s_add_u32 s34, s34, 12582912
  s_add_u32 s56, s18, s34
  s_addc_u32 s57, s19, 0
  s_lshl_b32 s34, s33, 19
  s_lshl_b32 s35, s3, 7
  s_add_u32 s34, s34, s35
  s_add_u32 s28, s12, s34
  s_addc_u32 s29, s13, 0
  s_sub_u32 s30, 0x80000, s35
  s_mov_b32 s31, 0x20000
  s_mov_b32 s61, 0
  v_lshlrev_b32 v8, 1, v1
  v_and_b32 v9, 7, v0
  v_xor_b32 v8, v8, v9
  v_lshlrev_b32 v8, 4, v8
  v_lshrrev_b32 v9, 3, v0
  v_lshl_add_u32 v16, v9, 10, v8
  v_add_u32 v17, 7168, v16
  v_lshrrev_b32 v8, 2, v0
  v_bfe_u32 v9, v0, 3, 2
  v_lshlrev_b32 v9, 5, v9
  v_lshl_add_u32 v8, v8, 7, v9
  v_and_b32 v9, 3, v0
  v_lshl_add_u32 v8, v9, 3, v8
  v_add_u32 v20, s52, v8
  v_xor_b32 v21, 32, v20
  v_xor_b32 v22, 64, v20
  v_xor_b32 v23, 96, v20
  v_lshlrev_b32 v8, 4, v0
  v_add_u32 v15, 32768, v8
  s_sub_u32 s44, s28, 512
  s_subb_u32 s45, s29, 0
  s_add_u32 s46, s30, 512
  s_mov_b32 s47, 0x20000
  s_sub_u32 s48, s3, 4
  s_lshl_b32 s48, s48, 17
  s_sub_u32 s34, s42, s52
  s_add_u32 s34, s34, 49152
  s_add_u32 s62, s42, 49152
  v_add_u32 v28, s34, v20
  v_add_u32 v29, s34, v21
  v_add_u32 v30, s34, v22
  v_add_u32 v31, s34, v23
  s_cmp_ge_i32 s39, s40
  s_cbranch_scc1 L_go113
  s_mov_b32 s43, 1048576
L_poll113:
  ds_read_b128 v[8:11], v14 offset:0
  s_waitcnt lgkmcnt(0)
  v_min3_u32 v8, v8, v9, v10
  v_min_u32 v8, v8, v11
  s_sub_u32 s43, s43, 1
  v_readfirstlane_b32 s39, v8
  s_cbranch_scc1 L_end
  s_cmp_ge_i32 s39, s40
  s_cbranch_scc1 L_go113
  s_sleep 1
  s_branch L_poll113
L_go113:
  s_add_u32 m0, s62, 0
  s_add_u32 s37, s61, 14336
  buffer_load_dwordx4 v16, s[28:31], s61 offen offset:0 lds
  buffer_load_dwordx4 v17, s[28:31], s61 offen offset:1024 lds
  buffer_load_dwordx4 v16, s[28:31], s37 offen offset:2048 lds
  buffer_load_dwordx4 v17, s[28:31], s37 offen offset:3072 lds
  s_add_u32 s61, s61, 32768
  s_add_u32 m0, s62, 16384
  s_add_u32 s37, s61, 14336
  buffer_load_dwordx4 v16, s[28:31], s61 offen offset:0 lds
  buffer_load_dwordx4 v17, s[28:31], s61 offen offset:1024 lds
  buffer_load_dwordx4 v16, s[28:31], s37 offen offset:2048 lds
  buffer_load_dwordx4 v17, s[28:31], s37 offen offset:3072 lds
  s_add_u32 s61, s61, 32768
  s_add_u32 m0, s62, 32768
  s_add_u32 s37, s61, 14336
  buffer_load_dwordx4 v16, s[28:31], s61 offen offset:0 lds
  buffer_load_dwordx4 v17, s[28:31], s61 offen offset:1024 lds
  buffer_load_dwordx4 v16, s[28:31], s37 offen offset:2048 lds
  buffer_load_dwordx4 v17, s[28:31], s37 offen offset:3072 lds
  s_add_u32 s61, s61, 32768
  s_waitcnt vmcnt(8)
  ds_read_b64_tr_b16 v[48:49], v28 offset:0
  ds_read_b64_tr_b16 v[50:51], v28 offset:2048
  ds_read_b64_tr_b16 v[52:53], v29 offset:0
  ds_read_b64_tr_b16 v[54:55], v29 offset:2048
  ds_read_b64_tr_b16 v[56:57], v30 offset:0
  ds_read_b64_tr_b16 v[58:59], v30 offset:2048
  ds_read_b64_tr_b16 v[60:61], v31 offset:0
  ds_read_b64_tr_b16 v[62:63], v31 offset:2048
  s_add_u32 m0, s62, 49152
  s_add_u32 s37, s61, 14336
  buffer_load_dwordx4 v16, s[28:31], s61 offen offset:0 lds
  buffer_load_dwordx4 v17, s[28:31], s61 offen offset:1024 lds
  buffer_load_dwordx4 v16, s[28:31], s37 offen offset:2048 lds
  buffer_load_dwordx4 v17, s[28:31], s37 offen offset:3072 lds
  s_add_u32 s61, s61, 32768
  s_waitcnt vmcnt(8)
  ds_read_b64_tr_b16 v[64:65], v28 offset:16384
  ds_read_b64_tr_b16 v[66:67], v28 offset:18432
  ds_read_b64_tr_b16 v[68:69], v29 offset:16384
  ds_read_b64_tr_b16 v[70:71], v29 offset:18432
  ds_read_b64_tr_b16 v[72:73], v30 offset:16384
  ds_read_b64_tr_b16 v[74:75], v30 offset:18432
  ds_read_b64_tr_b16 v[76:77], v31 offset:16384
  ds_read_b64_tr_b16 v[78:79], v31 offset:18432
  s_waitcnt lgkmcnt(8)
  s_add_u32 m0, s62, 0
  s_add_u32 s37, s61, 14336
  buffer_load_dwordx4 v16, s[28:31], s61 offen offset:0 lds
  buffer_load_dwordx4 v17, s[28:31], s61 offen offset:1024 lds
  buffer_load_dwordx4 v16, s[28:31], s37 offen offset:2048 lds
  buffer_load_dwordx4 v17, s[28:31], s37 offen offset:3072 lds
  s_add_u32 s61, s61, 32768
  s_waitcnt vmcnt(8)
  ds_read_b64_tr_b16 v[80:81], v28 offset:32768
  ds_read_b64_tr_b16 v[82:83], v28 offset:34816
  ds_read_b64_tr_b16 v[84:85], v29 offset:32768
  ds_read_b64_tr_b16 v[86:87], v29 offset:34816
  ds_read_b64_tr_b16 v[88:89], v30 offset:32768
  ds_read_b64_tr_b16 v[90:91], v30 offset:34816
  ds_read_b64_tr_b16 v[92:93], v31 offset:32768
  ds_read_b64_tr_b16 v[94:95], v31 offset:34816
  s_waitcnt lgkmcnt(8)
  s_add_u32 m0, s62, 16384
  s_add_u32 s37, s61, 14336
  buffer_load_dwordx4 v16, s[28:31], s61 offen offset:0 lds
  buffer_load_dwordx4 v17, s[28:31], s61 offen offset:1024 lds
  buffer_load_dwordx4 v16, s[28:31], s37 offen offset:2048 lds
  buffer_load_dwordx4 v17, s[28:31], s37 offen offset:3072 lds
  s_add_u32 s61, s61, 32768
  s_waitcnt vmcnt(8)
  ds_read_b64_tr_b16 v[96:97], v28 offset:49152
  ds_read_b64_tr_b16 v[98:99], v28 offset:51200
  ds_read_b64_tr_b16 v[100:101], v29 offset:49152
  ds_read_b64_tr_b16 v[102:103], v29 offset:51200
  ds_read_b64_tr_b16 v[104:105], v30 offset:49152
  ds_read_b64_tr_b16 v[106:107], v30 offset:51200
  ds_read_b64_tr_b16 v[108:109], v31 offset:49152
  ds_read_b64_tr_b16 v[110:111], v31 offset:51200
  s_waitcnt lgkmcnt(8)
  s_add_u32 m0, s62, 32768
  s_add_u32 s37, s61, 14336
  buffer_load_dwordx4 v16, s[28:31], s61 offen offset:0 lds
  buffer_load_dwordx4 v17, s[28:31], s61 offen offset:1024 lds
  buffer_load_dwordx4 v16, s[28:31], s37 offen offset:2048 lds
  buffer_load_dwordx4 v17, s[28:31], s37 offen offset:3072 lds
  s_add_u32 s61, s61, 32768
  s_waitcnt vmcnt(8)
  ds_read_b64_tr_b16 v[112:113], v28 offset:0
  ds_read_b64_tr_b16 v[114:115], v28 offset:2048
  ds_read_b64_tr_b16 v[116:117], v29 offset:0
  ds_read_b64_tr_b16 v[118:119], v29 offset:2048
  ds_read_b64_tr_b16 v[120:121], v30 offset:0
  ds_read_b64_tr_b16 v[122:123], v30 offset:2048
  ds_read_b64_tr_b16 v[124:125], v31 offset:0
  ds_read_b64_tr_b16 v[126:127], v31 offset:2048
  s_waitcnt lgkmcnt(8)
  s_add_u32 m0, s62, 49152
  s_add_u32 s37, s61, 14336
  buffer_load_dwordx4 v16, s[28:31], s61 offen offset:0 lds
  buffer_load_dwordx4 v17, s[28:31], s61 offen offset:1024 lds
  buffer_load_dwordx4 v16, s[28:31], s37 offen offset:2048 lds
  buffer_load_dwordx4 v17, s[28:31], s37 offen offset:3072 lds
  s_add_u32 s61, s61, 32768
  s_waitcnt vmcnt(8)
  ds_read_b64_tr_b16 v[128:129], v28 offset:16384
  ds_read_b64_tr_b16 v[130:131], v28 offset:18432
  ds_read_b64_tr_b16 v[132:133], v29 offset:16384
  ds_read_b64_tr_b16 v[134:135], v29 offset:18432
  ds_read_b64_tr_b16 v[136:137], v30 offset:16384
  ds_read_b64_tr_b16 v[138:139], v30 offset:18432
  ds_read_b64_tr_b16 v[140:141], v31 offset:16384
  ds_read_b64_tr_b16 v[142:143], v31 offset:18432
  s_waitcnt lgkmcnt(8)
  s_add_u32 m0, s62, 0
  s_add_u32 s37, s61, 14336
  buffer_load_dwordx4 v16, s[28:31], s61 offen offset:0 lds
  buffer_load_dwordx4 v17, s[28:31], s61 offen offset:1024 lds
  buffer_load_dwordx4 v16, s[28:31], s37 offen offset:2048 lds
  buffer_load_dwordx4 v17, s[28:31], s37 offen offset:3072 lds
  s_add_u32 s61, s61, 32768
  s_waitcnt vmcnt(8)
  ds_read_b64_tr_b16 v[144:145], v28 offset:32768
  ds_read_b64_tr_b16 v[146:147], v28 offset:34816
  ds_read_b64_tr_b16 v[148:149], v29 offset:32768
  ds_read_b64_tr_b16 v[150:151], v29 offset:34816
  ds_read_b64_tr_b16 v[152:153], v30 offset:32768
  ds_read_b64_tr_b16 v[154:155], v30 offset:34816
  ds_read_b64_tr_b16 v[156:157], v31 offset:32768
  ds_read_b64_tr_b16 v[158:159], v31 offset:34816
  s_waitcnt lgkmcnt(8)
  s_add_u32 m0, s62, 16384
  s_add_u32 s37, s61, 14336
  buffer_load_dwordx4 v16, s[28:31], s61 offen offset:0 lds
  buffer_load_dwordx4 v17, s[28:31], s61 offen offset:1024 lds
  buffer_load_dwordx4 v16, s[28:31], s37 offen offset:2048 lds
  buffer_load_dwordx4 v17, s[28:31], s37 offen offset:3072 lds
  s_add_u32 s61, s61, 32768
  s_waitcnt vmcnt(8)
  ds_read_b64_tr_b16 v[160:161], v28 offset:49152
  ds_read_b64_tr_b16 v[162:163], v28 offset:51200
  ds_read_b64_tr_b16 v[164:165], v29 offset:49152
  ds_read_b64_tr_b16 v[166:167], v29 offset:51200
  ds_read_b64_tr_b16 v[168:169], v30 offset:49152
  ds_read_b64_tr_b16 v[170:171], v30 offset:51200
  ds_read_b64_tr_b16 v[172:173], v31 offset:49152
  ds_read_b64_tr_b16 v[174:175], v31 offset:51200
  s_waitcnt lgkmcnt(8)
  s_add_u32 m0, s62, 32768
  s_add_u32 s37, s61, 14336
  buffer_load_dwordx4 v16, s[28:31], s61 offen offset:0 lds
  buffer_load_dwordx4 v17, s[28:31], s61 offen offset:1024 lds
  buffer_load_dwordx4 v16, s[28:31], s37 offen offset:2048 lds
  buffer_load_dwordx4 v17, s[28:31], s37 offen offset:3072 lds
  s_add_u32 s61, s61, 32768
  s_waitcnt vmcnt(8)
  ds_read_b64_tr_b16 v[176:177], v28 offset:0
  ds_read_b64_tr_b16 v[178:179], v28 offset:2048
  ds_read_b64_tr_b16 v[180:181], v29 offset:0
  ds_read_b64_tr_b16 v[182:183], v29 offset:2048
  ds_read_b64_tr_b16 v[184:185], v30 offset:0
  ds_read_b64_tr_b16 v[186:187], v30 offset:2048
  ds_read_b64_tr_b16 v[188:189], v31 offset:0
  ds_read_b64_tr_b16 v[190:191], v31 offset:2048
  s_waitcnt lgkmcnt(8)
  s_add_u32 m0, s62, 49152
  s_add_u32 s37, s61, 14336
  buffer_load_dwordx4 v16, s[28:31], s61 offen offset:0 lds
  buffer_load_dwordx4 v17, s[28:31], s61 offen offset:1024 lds
  buffer_load_dwordx4 v16, s[28:31], s37 offen offset:2048 lds
  buffer_load_dwordx4 v17, s[28:31], s37 offen offset:3072 lds
  s_add_u32 s61, s61, 32768
  s_waitcnt vmcnt(8)
  ds_read_b64_tr_b16 v[192:193], v28 offset:16384
  ds_read_b64_tr_b16 v[194:195], v28 offset:18432
  ds_read_b64_tr_b16 v[196:197], v29 offset:16384
  ds_read_b64_tr_b16 v[198:199], v29 offset:18432
  ds_read_b64_tr_b16 v[200:201], v30 offset:16384
  ds_read_b64_tr_b16 v[202:203], v30 offset:18432
  ds_read_b64_tr_b16 v[204:205], v31 offset:16384
  ds_read_b64_tr_b16 v[206:207], v31 offset:18432
  s_waitcnt lgkmcnt(8)
  s_add_u32 m0, s62, 0
  s_add_u32 s37, s61, 14336
  buffer_load_dwordx4 v16, s[28:31], s61 offen offset:0 lds
  buffer_load_dwordx4 v17, s[28:31], s61 offen offset:1024 lds
  buffer_load_dwordx4 v16, s[28:31], s37 offen offset:2048 lds
  buffer_load_dwordx4 v17, s[28:31], s37 offen offset:3072 lds
  s_add_u32 s61, s61, 32768
  s_mov_b32 m0, s41
  s_nop 0
  buffer_load_dwordx4 v4, s[20:23], s42 offen offset:0 nt lds
  buffer_load_dwordx4 v4, s[20:23], s42 offen offset:1024 nt lds
  buffer_load_dwordx4 v5, s[20:23], s42 offen offset:2048 nt lds
  buffer_load_dwordx4 v5, s[20:23], s42 offen offset:3072 nt lds
  s_waitcnt vmcnt(12)
  ds_read_b64_tr_b16 v[208:209], v28 offset:32768
  ds_read_b64_tr_b16 v[210:211], v28 offset:34816
  ds_read_b64_tr_b16 v[212:213], v29 offset:32768
  ds_read_b64_tr_b16 v[214:215], v29 offset:34816
  ds_read_b64_tr_b16 v[216:217], v30 offset:32768
  ds_read_b64_tr_b16 v[218:219], v30 offset:34816
  ds_read_b64_tr_b16 v[220:221], v31 offset:32768
  ds_read_b64_tr_b16 v[222:223], v31 offset:34816
  s_add_u32 s49, s49, 1
  s_add_u32 s41, s41, 16384
  s_cmp_ge_u32 s41, s53
  s_cselect_b32 s34, s53, 0
  s_sub_u32 s41, s41, s34
  s_mov_b32 m0, s41
  s_nop 0
  buffer_load_dwordx4 v6, s[24:27], s42 offen offset:0 nt lds
  buffer_load_dwordx4 v7, s[24:27], s42 offen offset:1024 nt lds
  s_waitcnt vmcnt(10)
  ds_read_b64_tr_b16 v[224:225], v28 offset:49152
  ds_read_b64_tr_b16 v[226:227], v28 offset:51200
  ds_read_b64_tr_b16 v[228:229], v29 offset:49152
  ds_read_b64_tr_b16 v[230:231], v29 offset:51200
  ds_read_b64_tr_b16 v[232:233], v30 offset:49152
  ds_read_b64_tr_b16 v[234:235], v30 offset:51200
  ds_read_b64_tr_b16 v[236:237], v31 offset:49152
  ds_read_b64_tr_b16 v[238:239], v31 offset:51200
  buffer_load_dwordx4 v6, s[24:27], s42 offen offset:2048 nt lds
  buffer_load_dwordx4 v7, s[24:27], s42 offen offset:3072 nt lds
  s_waitcnt vmcnt(8)
  ds_read_b64_tr_b16 v[240:241], v28 offset:0
  ds_read_b64_tr_b16 v[242:243], v28 offset:2048
  ds_read_b64_tr_b16 v[244:245], v29 offset:0
  ds_read_b64_tr_b16 v[246:247], v29 offset:2048
  ds_read_b64_tr_b16 v[248:249], v30 offset:0
  ds_read_b64_tr_b16 v[250:251], v30 offset:2048
  ds_read_b64_tr_b16 v[252:253], v31 offset:0
  ds_read_b64_tr_b16 v[254:255], v31 offset:2048
  s_add_u32 s42, s42, 16384
  s_add_u32 s49, s49, 1
  s_add_u32 s41, s41, 16384
  s_cmp_ge_u32 s41, s53
  s_cselect_b32 s34, s53, 0
  s_sub_u32 s41, s41, s34
  s_mov_b32 m0, s41
  s_waitcnt vmcnt(7)
  buffer_load_dwordx4 v4, s[20:23], s42 offen offset:0 nt lds
  s_waitcnt vmcnt(7)
  buffer_load_dwordx4 v4, s[20:23], s42 offen offset:1024 nt lds
  s_waitcnt vmcnt(7)
  buffer_load_dwordx4 v5, s[20:23], s42 offen offset:2048 nt lds
  s_waitcnt vmcnt(7)
  v_add_u32 v12, 1, v12
  ds_write_b32 v13, v12
  buffer_load_dwordx4 v5, s[20:23], s42 offen offset:3072 nt lds
  s_add_u32 s49, s49, 1
  s_add_u32 s41, s41, 16384
  s_cmp_ge_u32 s41, s53
  s_cselect_b32 s34, s53, 0
  s_sub_u32 s41, s41, s34
  s_waitcnt lgkmcnt(0)
  s_mov_b32 m0, s41
  s_waitcnt vmcnt(7)
  buffer_load_dwordx4 v6, s[24:27], s42 offen offset:0 nt lds
  s_waitcnt vmcnt(7)
  buffer_load_dwordx4 v7, s[24:27], s42 offen offset:1024 nt lds
  s_waitcnt vmcnt(7)
  buffer_load_dwordx4 v6, s[24:27], s42 offen offset:2048 nt lds
  s_waitcnt vmcnt(7)
  v_add_u32 v12, 1, v12
  ds_write_b32 v13, v12
  buffer_load_dwordx4 v7, s[24:27], s42 offen offset:3072 nt lds
  s_add_u32 s42, s42, 16384
  s_add_u32 s49, s49, 1
  s_add_u32 s41, s41, 16384
  s_cmp_ge_u32 s41, s53
  s_cselect_b32 s34, s53, 0
  s_sub_u32 s41, s41, s34
  s_mov_b32 m0, s41
  s_waitcnt vmcnt(7)
  buffer_load_dwordx4 v4, s[20:23], s42 offen offset:0 nt lds
  s_waitcnt vmcnt(7)
  buffer_load_dwordx4 v4, s[20:23], s42 offen offset:1024 nt lds
  s_waitcnt vmcnt(7)
  buffer_load_dwordx4 v5, s[20:23], s42 offen offset:2048 nt lds
  s_waitcnt vmcnt(7)
  v_add_u32 v12, 1, v12
  ds_write_b32 v13, v12
  buffer_load_dwordx4 v5, s[20:23], s42 offen offset:3072 nt lds
  s_add_u32 s49, s49, 1
  s_add_u32 s41, s41, 16384
  s_cmp_ge_u32 s41, s53
  s_cselect_b32 s34, s53, 0
  s_sub_u32 s41, s41, s34
  s_mov_b32 m0, s41
  s_waitcnt vmcnt(7)
  buffer_load_dwordx4 v6, s[24:27], s42 offen offset:0 nt lds
  s_waitcnt vmcnt(7)
  buffer_load_dwordx4 v7, s[24:27], s42 offen offset:1024 nt lds
  s_waitcnt vmcnt(7)
  buffer_load_dwordx4 v6, s[24:27], s42 offen offset:2048 nt lds
  s_waitcnt vmcnt(7)
  v_add_u32 v12, 1, v12
  ds_write_b32 v13, v12
  buffer_load_dwordx4 v7, s[24:27], s42 offen offset:3072 nt lds
  s_add_u32 s42, s42, 16384
  s_add_u32 s49, s49, 1
  s_add_u32 s41, s41, 16384
  s_cmp_ge_u32 s41, s53
  s_cselect_b32 s34, s53, 0
  s_sub_u32 s41, s41, s34
  s_mov_b32 m0, s41
  s_waitcnt vmcnt(7)
  buffer_load_dwordx4 v4, s[20:23], s42 offen offset:0 nt lds
  s_waitcnt vmcnt(7)
  buffer_load_dwordx4 v4, s[20:23], s42 offen offset:1024 nt lds
  s_waitcnt vmcnt(7)
  buffer_load_dwordx4 v5, s[20:23], s42 offen offset:2048 nt lds
  s_waitcnt vmcnt(7)
  v_add_u32 v12, 1, v12
  ds_write_b32 v13, v12
  buffer_load_dwordx4 v5, s[20:23], s42 offen offset:3072 nt lds
  s_add_u32 s49, s49, 1
  s_add_u32 s41, s41, 16384
  s_cmp_ge_u32 s41, s53
  s_cselect_b32 s34, s53, 0
  s_sub_u32 s41, s41, s34
  s_mov_b32 s40, 3
  s_cmp_ge_i32 s39, s40
  s_cbranch_scc1 L_go114
  s_mov_b32 s43, 1048576
L_poll114:
  ds_read_b128 v[8:11], v14 offset:0
  s_waitcnt lgkmcnt(0)
  v_min3_u32 v8, v8, v9, v10
  v_min_u32 v8, v8, v11
  s_sub_u32 s43, s43, 1
  v_readfirstlane_b32 s39, v8
  s_cbranch_scc1 L_end
  s_cmp_ge_i32 s39, s40
  s_cbranch_scc1 L_go114
  s_sleep 1
  s_branch L_poll114
L_go114:
  s_mov_b32 m0, s41
  s_waitcnt vmcnt(7)
  buffer_load_dwordx4 v6, s[24:27], s42 offen offset:0 nt lds
  s_waitcnt vmcnt(7)
  buffer_load_dwordx4 v7, s[24:27], s42 offen offset:1024 nt lds
  s_waitcnt vmcnt(7)
  buffer_load_dwordx4 v6, s[24:27], s42 offen offset:2048 nt lds
  s_waitcnt vmcnt(7)
  v_add_u32 v12, 1, v12
  ds_write_b32 v13, v12
  buffer_load_dwordx4 v7, s[24:27], s42 offen offset:3072 nt lds
  s_add_u32 s42, s42, 16384
  s_add_u32 s49, s49, 1
  s_add_u32 s41, s41, 16384
  s_cmp_ge_u32 s41, s53
  s_cselect_b32 s34, s53, 0
  s_sub_u32 s41, s41, s34
  s_mov_b32 s81, 0
  s_sub_u32 s40, s49, s60
  s_cmp_ge_i32 s39, s40
  s_cbranch_scc1 L_go115
  s_mov_b32 s43, 1048576
L_poll115:
  ds_read_b128 v[8:11], v14 offset:0
  s_waitcnt lgkmcnt(0)
  v_min3_u32 v8, v8, v9, v10
  v_min_u32 v8, v8, v11
  s_sub_u32 s43, s43, 1
  v_readfirstlane_b32 s39, v8
  s_cbranch_scc1 L_end
  s_cmp_ge_i32 s39, s40
  s_cbranch_scc1 L_go115
  s_sleep 1
  s_branch L_poll115
L_go115:
  s_mov_b32 m0, s41
  v_add_u32 v12, 1, v12
  s_bitcmp1_b32 s81, 0
  s_waitcnt vmcnt(7)
  s_cbranch_scc0 L_w116
  s_waitcnt vmcnt(5)
L_w116:
  buffer_load_dwordx4 v4, s[20:23], s42 offen offset:0 nt lds
  s_bitcmp1_b32 s81, 1
  s_waitcnt vmcnt(7)
  s_cbranch_scc0 L_w117
  s_waitcnt vmcnt(5)
  ds_write_b32 v13, v12
L_w117:
  buffer_load_dwordx4 v4, s[20:23], s42 offen offset:1024 nt lds
  s_bitcmp1_b32 s81, 2
  s_waitcnt vmcnt(7)
  s_cbranch_scc0 L_w118
  s_waitcnt vmcnt(5)
L_w118:
  buffer_load_dwordx4 v5, s[20:23], s42 offen offset:2048 nt lds
  s_bitcmp1_b32 s81, 3
  s_waitcnt vmcnt(7)
  ds_write_b32 v13, v12
  s_cbranch_scc0 L_w119
  s_waitcnt vmcnt(5)
L_w119:
  buffer_load_dwordx4 v5, s[20:23], s42 offen offset:3072 nt lds
  s_add_u32 s49, s49, 1
  s_add_u32 s41, s41, 16384
  s_cmp_ge_u32 s41, s53
  s_cselect_b32 s34, s53, 0
  s_sub_u32 s41, s41, s34
  s_sub_u32 s40, s49, s60
  s_cmp_ge_i32 s39, s40
  s_cbranch_scc1 L_go120
  s_mov_b32 s43, 1048576
L_poll120:
  ds_read_b128 v[8:11], v14 offset:0
  s_waitcnt lgkmcnt(0)
  v_min3_u32 v8, v8, v9, v10
  v_min_u32 v8, v8, v11
  s_sub_u32 s43, s43, 1
  v_readfirstlane_b32 s39, v8
  s_cbranch_scc1 L_end
  s_cmp_ge_i32 s39, s40
  s_cbranch_scc1 L_go120
  s_sleep 1
  s_branch L_poll120
L_go120:
  s_mov_b32 m0, s41
  v_add_u32 v12, 1, v12
  s_bitcmp1_b32 s81, 0
  s_waitcnt vmcnt(7)
  s_cbranch_scc0 L_w121
  s_waitcnt vmcnt(5)
L_w121:
  buffer_load_dwordx4 v6, s[24:27], s42 offen offset:0 nt lds
  s_bitcmp1_b32 s81, 1
  s_waitcnt vmcnt(7)
  s_cbranch_scc0 L_w122
  s_waitcnt vmcnt(5)
  ds_write_b32 v13, v12
L_w122:
  buffer_load_dwordx4 v7, s[24:27], s42 offen offset:1024 nt lds
  s_bitcmp1_b32 s81, 2
  s_waitcnt vmcnt(7)
  s_cbranch_scc0 L_w123
  s_waitcnt vmcnt(5)
L_w123:
  buffer_load_dwordx4 v6, s[24:27], s42 offen offset:2048 nt lds
  s_bitcmp1_b32 s81, 3
  s_waitcnt vmcnt(7)
  ds_write_b32 v13, v12
  s_cbranch_scc0 L_w124
  s_waitcnt vmcnt(5)
L_w124:
  buffer_load_dwordx4 v7, s[24:27], s42 offen offset:3072 nt lds
  s_add_u32 s42, s42, 16384
  s_add_u32 s49, s49, 1
  s_add_u32 s41, s41, 16384
  s_cmp_ge_u32 s41, s53
  s_cselect_b32 s34, s53, 0
  s_sub_u32 s41, s41, s34
  s_sub_u32 s40, s49, s60
  s_cmp_ge_i32 s39, s40
  s_cbranch_scc1 L_go125
  s_mov_b32 s43, 1048576
L_poll125:
  ds_read_b128 v[8:11], v14 offset:0
  s_waitcnt lgkmcnt(0)
  v_min3_u32 v8, v8, v9, v10
  v_min_u32 v8, v8, v11
  s_sub_u32 s43, s43, 1
  v_readfirstlane_b32 s39, v8
  s_cbranch_scc1 L_end
  s_cmp_ge_i32 s39, s40
  s_cbranch_scc1 L_go125
  s_sleep 1
  s_branch L_poll125
L_go125:
  s_waitcnt lgkmcnt(0)
  s_mov_b32 s61, 425984
  s_add_u32 m0, s52, 0
  s_nop 0
  buffer_load_dwordx4 v16, s[28:31], s61 offen offset:0 lds
  s_mov_b32 m0, s41
  v_add_u32 v12, 1, v12
  s_bitcmp1_b32 s81, 0
  s_waitcnt vmcnt(8)
  s_cbranch_scc0 L_w126
  s_waitcnt vmcnt(6)
L_w126:
  buffer_load_dwordx4 v4, s[20:23], s42 offen offset:0 nt lds
  s_bitcmp1_b32 s81, 1
  s_waitcnt vmcnt(8)
  s_cbranch_scc0 L_w127
  s_waitcnt vmcnt(6)
  ds_write_b32 v13, v12
L_w127:
  buffer_load_dwordx4 v4, s[20:23], s42 offen offset:1024 nt lds
  s_add_u32 m0, s52, 0
  s_nop 0
  buffer_load_dwordx4 v17, s[28:31], s61 offen offset:1024 lds
  s_mov_b32 m0, s41
  s_bitcmp1_b32 s81, 2
  s_waitcnt vmcnt(9)
  s_cbranch_scc0 L_w128
  s_waitcnt vmcnt(7)
L_w128:
  buffer_load_dwordx4 v5, s[20:23], s42 offen offset:2048 nt lds
  s_bitcmp1_b32 s81, 3
  s_waitcnt vmcnt(9)
  ds_write_b32 v13, v12
  s_cbranch_scc0 L_w129
  s_waitcnt vmcnt(7)
L_w129:
  buffer_load_dwordx4 v5, s[20:23], s42 offen offset:3072 nt lds
  s_add_u32 s49, s49, 1
  s_add_u32 s41, s41, 16384
  s_cmp_ge_u32 s41, s53
  s_cselect_b32 s34, s53, 0
  s_sub_u32 s41, s41, s34
  s_sub_u32 s40, s49, s60
  s_cmp_ge_i32 s39, s40
  s_cbranch_scc1 L_go130
  s_mov_b32 s43, 1048576
L_poll130:
  ds_read_b128 v[8:11], v14 offset:0
  s_waitcnt lgkmcnt(0)
  v_min3_u32 v8, v8, v9, v10
  v_min_u32 v8, v8, v11
  s_sub_u32 s43, s43, 1
  v_readfirstlane_b32 s39, v8
  s_cbranch_scc1 L_end
  s_cmp_ge_i32 s39, s40
  s_cbranch_scc1 L_go130
  s_sleep 1
  s_branch L_poll130
L_go130:
  s_waitcnt lgkmcnt(0)
  s_mov_b32 s61, 442368
  s_add_u32 m0, s52, 2048
  s_nop 0
  buffer_load_dwordx4 v16, s[28:31], s61 offen offset:0 lds
  s_mov_b32 m0, s41
  v_add_u32 v12, 1, v12
  s_bitcmp1_b32 s81, 0
  s_waitcnt vmcnt(10)
  s_cbranch_scc0 L_w131
  s_waitcnt vmcnt(8)
L_w131:
  buffer_load_dwordx4 v6, s[24:27], s42 offen offset:0 nt lds
  s_bitcmp1_b32 s81, 1
  s_waitcnt vmcnt(10)
  s_cbranch_scc0 L_w132
  s_waitcnt vmcnt(8)
  ds_write_b32 v13, v12
L_w132:
  buffer_load_dwordx4 v7, s[24:27], s42 offen offset:1024 nt lds
  s_add_u32 m0, s52, 2048
  s_nop 0
  buffer_load_dwordx4 v17, s[28:31], s61 offen offset:1024 lds
  s_mov_b32 m0, s41
  s_bitcmp1_b32 s81, 2
  s_waitcnt vmcnt(11)
  s_cbranch_scc0 L_w133
  s_waitcnt vmcnt(8)
L_w133:
  buffer_load_dwordx4 v6, s[24:27], s42 offen offset:2048 nt lds
  s_bitcmp1_b32 s81, 3
  s_waitcnt vmcnt(11)
  ds_write_b32 v13, v12
  s_cbranch_scc0 L_w134
  s_waitcnt vmcnt(8)
L_w134:
  buffer_load_dwordx4 v7, s[24:27], s42 offen offset:3072 nt lds
  s_add_u32 s42, s42, 16384
  s_add_u32 s49, s49, 1
  s_add_u32 s41, s41, 16384
  s_cmp_ge_u32 s41, s53
  s_cselect_b32 s34, s53, 0
  s_sub_u32 s41, s41, s34
  s_sub_u32 s40, s49, s60
  s_cmp_ge_i32 s39, s40
  s_cbranch_scc1 L_go135
  s_mov_b32 s43, 1048576
L_poll135:
  ds_read_b128 v[8:11], v14 offset:0
  s_waitcnt lgkmcnt(0)
  v_min3_u32 v8, v8, v9, v10
  v_min_u32 v8, v8, v11
  s_sub_u32 s43, s43, 1
  v_readfirstlane_b32 s39, v8
  s_cbranch_scc1 L_end
  s_cmp_ge_i32 s39, s40
  s_cbranch_scc1 L_go135
  s_sleep 1
  s_branch L_poll135
L_go135:
  s_mov_b32 m0, s41
  v_add_u32 v12, 1, v12
  s_bitcmp1_b32 s81, 0
  s_waitcnt vmcnt(10)
  s_cbranch_scc0 L_w136
  s_waitcnt vmcnt(7)
L_w136:
  buffer_load_dwordx4 v4, s[20:23], s42 offen offset:0 nt lds
  s_bitcmp1_b32 s81, 1
  s_waitcnt vmcnt(10)
  s_cbranch_scc0 L_w137
  s_waitcnt vmcnt(7)
  ds_write_b32 v13, v12
L_w137:
  buffer_load_dwordx4 v4, s[20:23], s42 offen offset:1024 nt lds
  s_bitcmp1_b32 s81, 2
  s_waitcnt vmcnt(9)
  s_cbranch_scc0 L_w138
  s_waitcnt vmcnt(6)
L_w138:
  buffer_load_dwordx4 v5, s[20:23], s42 offen offset:2048 nt lds
  s_bitcmp1_b32 s81, 3
  s_waitcnt vmcnt(9)
  ds_write_b32 v13, v12
  s_cbranch_scc0 L_w139
  s_waitcnt vmcnt(6)
L_w139:
  buffer_load_dwordx4 v5, s[20:23], s42 offen offset:3072 nt lds
  s_add_u32 s49, s49, 1
  s_add_u32 s41, s41, 16384
  s_cmp_ge_u32 s41, s53
  s_cselect_b32 s34, s53, 0
  s_sub_u32 s41, s41, s34
  s_sub_u32 s40, s49, s60
  s_cmp_ge_i32 s39, s40
  s_cbranch_scc1 L_go140
  s_mov_b32 s43, 1048576
L_poll140:
  ds_read_b128 v[8:11], v14 offset:0
  s_waitcnt lgkmcnt(0)
  v_min3_u32 v8, v8, v9, v10
  v_min_u32 v8, v8, v11
  s_sub_u32 s43, s43, 1
  v_readfirstlane_b32 s39, v8
  s_cbranch_scc1 L_end
  s_cmp_ge_i32 s39, s40
  s_cbranch_scc1 L_go140
  s_sleep 1
  s_branch L_poll140
L_go140:
  s_mov_b32 m0, s41
  v_add_u32 v12, 1, v12
  s_bitcmp1_b32 s81, 0
  s_waitcnt vmcnt(8)
  s_cbranch_scc0 L_w141
  s_waitcnt vmcnt(5)
L_w141:
  buffer_load_dwordx4 v6, s[24:27], s42 offen offset:0 nt lds
  s_bitcmp1_b32 s81, 1
  s_waitcnt vmcnt(8)
  s_cbranch_scc0 L_w142
  s_waitcnt vmcnt(5)
  ds_write_b32 v13, v12
L_w142:
  buffer_load_dwordx4 v7, s[24:27], s42 offen offset:1024 nt lds
  s_bitcmp1_b32 s81, 2
  s_waitcnt vmcnt(7)
  s_cbranch_scc0 L_w143
  s_waitcnt vmcnt(5)
L_w143:
  buffer_load_dwordx4 v6, s[24:27], s42 offen offset:2048 nt lds
  s_bitcmp1_b32 s81, 3
  s_waitcnt vmcnt(7)
  ds_write_b32 v13, v12
  s_cbranch_scc0 L_w144
  s_waitcnt vmcnt(5)
L_w144:
  buffer_load_dwordx4 v7, s[24:27], s42 offen offset:3072 nt lds
  s_add_u32 s42, s42, 16384
  s_add_u32 s49, s49, 1
  s_add_u32 s41, s41, 16384
  s_cmp_ge_u32 s41, s53
  s_cselect_b32 s34, s53, 0
  s_sub_u32 s41, s41, s34
  s_sub_u32 s40, s49, s60
  s_cmp_ge_i32 s39, s40
  s_cbranch_scc1 L_go145
  s_mov_b32 s43, 1048576
L_poll145:
  ds_read_b128 v[8:11], v14 offset:0
  s_waitcnt lgkmcnt(0)
  v_min3_u32 v8, v8, v9, v10
  v_min_u32 v8, v8, v11
  s_sub_u32 s43, s43, 1
  v_readfirstlane_b32 s39, v8
  s_cbranch_scc1 L_end
  s_cmp_ge_i32 s39, s40
  s_cbranch_scc1 L_go145
  s_sleep 1
  s_branch L_poll145
L_go145:
  s_mov_b32 m0, s41
  v_add_u32 v12, 1, v12
  s_bitcmp1_b32 s81, 0
  s_waitcnt vmcnt(7)
  s_cbranch_scc0 L_w146
  s_waitcnt vmcnt(5)
L_w146:
  buffer_load_dwordx4 v4, s[20:23], s42 offen offset:0 nt lds
  s_bitcmp1_b32 s81, 1
  s_waitcnt vmcnt(7)
  s_cbranch_scc0 L_w147
  s_waitcnt vmcnt(5)
  ds_write_b32 v13, v12
L_w147:
  buffer_load_dwordx4 v4, s[20:23], s42 offen offset:1024 nt lds
  s_bitcmp1_b32 s81, 2
  s_waitcnt vmcnt(7)
  s_cbranch_scc0 L_w148
  s_waitcnt vmcnt(5)
L_w148:
  buffer_load_dwordx4 v5, s[20:23], s42 offen offset:2048 nt lds
  s_bitcmp1_b32 s81, 3
  s_waitcnt vmcnt(7)
  ds_write_b32 v13, v12
  s_cbranch_scc0 L_w149
  s_waitcnt vmcnt(5)
L_w149:
  buffer_load_dwordx4 v5, s[20:23], s42 offen offset:3072 nt lds
  s_add_u32 s49, s49, 1
  s_add_u32 s41, s41, 16384
  s_cmp_ge_u32 s41, s53
  s_cselect_b32 s34, s53, 0
  s_sub_u32 s41, s41, s34
  s_sub_u32 s40, s49, s60
  s_cmp_ge_i32 s39, s40
  s_cbranch_scc1 L_go150
  s_mov_b32 s43, 1048576
L_poll150:
  ds_read_b128 v[8:11], v14 offset:0
  s_waitcnt lgkmcnt(0)
  v_min3_u32 v8, v8, v9, v10
  v_min_u32 v8, v8, v11
  s_sub_u32 s43, s43, 1
  v_readfirstlane_b32 s39, v8
  s_cbranch_scc1 L_end
  s_cmp_ge_i32 s39, s40
  s_cbranch_scc1 L_go150
  s_sleep 1
  s_branch L_poll150
L_go150:
  s_mov_b32 m0, s41
  v_add_u32 v12, 1, v12
  s_bitcmp1_b32 s81, 0
  s_waitcnt vmcnt(7)
  s_cbranch_scc0 L_w151
  s_waitcnt vmcnt(5)
L_w151:
  buffer_load_dwordx4 v6, s[24:27], s42 offen offset:0 nt lds
  s_bitcmp1_b32 s81, 1
  s_waitcnt vmcnt(7)
  s_cbranch_scc0 L_w152
  s_waitcnt vmcnt(5)
  ds_write_b32 v13, v12
L_w152:
  buffer_load_dwordx4 v7, s[24:27], s42 offen offset:1024 nt lds
  s_bitcmp1_b32 s81, 2
  s_waitcnt vmcnt(7)
  s_cbranch_scc0 L_w153
  s_waitcnt vmcnt(5)
L_w153:
  buffer_load_dwordx4 v6, s[24:27], s42 offen offset:2048 nt lds
  s_bitcmp1_b32 s81, 3
  s_waitcnt vmcnt(7)
  ds_write_b32 v13, v12
  s_cbranch_scc0 L_w154
  s_waitcnt vmcnt(5)
L_w154:
  buffer_load_dwordx4 v7, s[24:27], s42 offen offset:3072 nt lds
  s_add_u32 s42, s42, 16384
  s_add_u32 s49, s49, 1
  s_add_u32 s41, s41, 16384
  s_cmp_ge_u32 s41, s53
  s_cselect_b32 s34, s53, 0
  s_sub_u32 s41, s41, s34
  s_sub_u32 s40, s49, s60
  s_cmp_ge_i32 s39, s40
  s_cbranch_scc1 L_go155
  s_mov_b32 s43, 1048576
L_poll155:
  ds_read_b128 v[8:11], v14 offset:0
  s_waitcnt lgkmcnt(0)
  v_min3_u32 v8, v8, v9, v10
  v_min_u32 v8, v8, v11
  s_sub_u32 s43, s43, 1
  v_readfirstlane_b32 s39, v8
  s_cbranch_scc1 L_end
  s_cmp_ge_i32 s39, s40
  s_cbranch_scc1 L_go155
  s_sleep 1
  s_branch L_poll155
L_go155:
  s_mov_b32 m0, s41
  v_add_u32 v12, 1, v12
  s_bitcmp1_b32 s81, 0
  s_waitcnt vmcnt(7)
  s_cbranch_scc0 L_w156
  s_waitcnt vmcnt(5)
L_w156:
  buffer_load_dwordx4 v4, s[20:23], s42 offen offset:0 nt lds
  s_bitcmp1_b32 s81, 1
  s_waitcnt vmcnt(7)
  s_cbranch_scc0 L_w157
  s_waitcnt vmcnt(5)
  ds_write_b32 v13, v12
L_w157:
  buffer_load_dwordx4 v4, s[20:23], s42 offen offset:1024 nt lds
  s_bitcmp1_b32 s81, 2
  s_waitcnt vmcnt(7)
  s_cbranch_scc0 L_w158
  s_waitcnt vmcnt(5)
L_w158:
  buffer_load_dwordx4 v5, s[20:23], s42 offen offset:2048 nt lds
  s_bitcmp1_b32 s81, 3
  s_waitcnt vmcnt(7)
  ds_write_b32 v13, v12
  s_cbranch_scc0 L_w159
  s_waitcnt vmcnt(5)
L_w159:
  buffer_load_dwordx4 v5, s[20:23], s42 offen offset:3072 nt lds
  s_add_u32 s49, s49, 1
  s_add_u32 s41, s41, 16384
  s_cmp_ge_u32 s41, s53
  s_cselect_b32 s34, s53, 0
  s_sub_u32 s41, s41, s34
  s_sub_u32 s40, s49, s60
  s_cmp_ge_i32 s39, s40
  s_cbranch_scc1 L_go160
  s_mov_b32 s43, 1048576
L_poll160:
  ds_read_b128 v[8:11], v14 offset:0
  s_waitcnt lgkmcnt(0)
  v_min3_u32 v8, v8, v9, v10
  v_min_u32 v8, v8, v11
  s_sub_u32 s43, s43, 1
  v_readfirstlane_b32 s39, v8
  s_cbranch_scc1 L_end
  s_cmp_ge_i32 s39, s40
  s_cbranch_scc1 L_go160
  s_sleep 1
  s_branch L_poll160
L_go160:
  s_mov_b32 m0, s41
  v_add_u32 v12, 1, v12
  s_bitcmp1_b32 s81, 0
  s_waitcnt vmcnt(7)
  s_cbranch_scc0 L_w161
  s_waitcnt vmcnt(5)
L_w161:
  buffer_load_dwordx4 v6, s[24:27], s42 offen offset:0 nt lds
  s_bitcmp1_b32 s81, 1
  s_waitcnt vmcnt(7)
  s_cbranch_scc0 L_w162
  s_waitcnt vmcnt(5)
  ds_write_b32 v13, v12
L_w162:
  buffer_load_dwordx4 v7, s[24:27], s42 offen offset:1024 nt lds
  s_bitcmp1_b32 s81, 2
  s_waitcnt vmcnt(7)
  s_cbranch_scc0 L_w163
  s_waitcnt vmcnt(5)
L_w163:
  buffer_load_dwordx4 v6, s[24:27], s42 offen offset:2048 nt lds
  s_bitcmp1_b32 s81, 3
  s_waitcnt vmcnt(7)
  ds_write_b32 v13, v12
  s_cbranch_scc0 L_w164
  s_waitcnt vmcnt(5)
L_w164:
  buffer_load_dwordx4 v7, s[24:27], s42 offen offset:3072 nt lds
  s_add_u32 s42, s42, 16384
  s_add_u32 s49, s49, 1
  s_add_u32 s41, s41, 16384
  s_cmp_ge_u32 s41, s53
  s_cselect_b32 s34, s53, 0
  s_sub_u32 s41, s41, s34
  s_sub_u32 s40, s49, s60
  s_cmp_ge_i32 s39, s40
  s_cbranch_scc1 L_go165
  s_mov_b32 s43, 1048576
L_poll165:
  ds_read_b128 v[8:11], v14 offset:0
  s_waitcnt lgkmcnt(0)
  v_min3_u32 v8, v8, v9, v10
  v_min_u32 v8, v8, v11
  s_sub_u32 s43, s43, 1
  v_readfirstlane_b32 s39, v8
  s_cbranch_scc1 L_end
  s_cmp_ge_i32 s39, s40
  s_cbranch_scc1 L_go165
  s_sleep 1
  s_branch L_poll165
L_go165:
  s_mov_b32 m0, s41
  v_add_u32 v12, 1, v12
  s_bitcmp1_b32 s81, 0
  s_waitcnt vmcnt(7)
  s_cbranch_scc0 L_w166
  s_waitcnt vmcnt(5)
L_w166:
  buffer_load_dwordx4 v4, s[20:23], s42 offen offset:0 nt lds
  s_bitcmp1_b32 s81, 1
  s_waitcnt vmcnt(7)
  s_cbranch_scc0 L_w167
  s_waitcnt vmcnt(5)
  ds_write_b32 v13, v12
L_w167:
  buffer_load_dwordx4 v4, s[20:23], s42 offen offset:1024 nt lds
  s_bitcmp1_b32 s81, 2
  s_waitcnt vmcnt(7)
  s_cbranch_scc0 L_w168
  s_waitcnt vmcnt(5)
L_w168:
  buffer_load_dwordx4 v5, s[20:23], s42 offen offset:2048 nt lds
  s_bitcmp1_b32 s81, 3
  s_waitcnt vmcnt(7)
  ds_write_b32 v13, v12
  s_cbranch_scc0 L_w169
  s_waitcnt vmcnt(5)
L_w169:
  buffer_load_dwordx4 v5, s[20:23], s42 offen offset:3072 nt lds
  s_add_u32 s49, s49, 1
  s_add_u32 s41, s41, 16384
  s_cmp_ge_u32 s41, s53
  s_cselect_b32 s34, s53, 0
  s_sub_u32 s41, s41, s34
  s_sub_u32 s40, s49, s60
  s_cmp_ge_i32 s39, s40
  s_cbranch_scc1 L_go170
  s_mov_b32 s43, 1048576
L_poll170:
  ds_read_b128 v[8:11], v14 offset:0
  s_waitcnt lgkmcnt(0)
  v_min3_u32 v8, v8, v9, v10
  v_min_u32 v8, v8, v11
  s_sub_u32 s43, s43, 1
  v_readfirstlane_b32 s39, v8
  s_cbranch_scc1 L_end
  s_cmp_ge_i32 s39, s40
  s_cbranch_scc1 L_go170
  s_sleep 1
  s_branch L_poll170
L_go170:
  s_mov_b32 m0, s41
  v_add_u32 v12, 1, v12
  s_bitcmp1_b32 s81, 0
  s_waitcnt vmcnt(7)
  s_cbranch_scc0 L_w171
  s_waitcnt vmcnt(5)
L_w171:
  buffer_load_dwordx4 v6, s[24:27], s42 offen offset:0 nt lds
  s_bitcmp1_b32 s81, 1
  s_waitcnt vmcnt(7)
  s_cbranch_scc0 L_w172
  s_waitcnt vmcnt(5)
  ds_write_b32 v13, v12
L_w172:
  buffer_load_dwordx4 v7, s[24:27], s42 offen offset:1024 nt lds
  s_bitcmp1_b32 s81, 2
  s_waitcnt vmcnt(7)
  s_cbranch_scc0 L_w173
  s_waitcnt vmcnt(5)
L_w173:
  buffer_load_dwordx4 v6, s[24:27], s42 offen offset:2048 nt lds
  s_bitcmp1_b32 s81, 3
  s_waitcnt vmcnt(7)
  ds_write_b32 v13, v12
  s_cbranch_scc0 L_w174
  s_waitcnt vmcnt(5)
L_w174:
  buffer_load_dwordx4 v7, s[24:27], s42 offen offset:3072 nt lds
  s_add_u32 s42, s42, 16384
  s_add_u32 s49, s49, 1
  s_add_u32 s41, s41, 16384
  s_cmp_ge_u32 s41, s53
  s_cselect_b32 s34, s53, 0
  s_sub_u32 s41, s41, s34
  s_sub_u32 s40, s49, s60
  s_cmp_ge_i32 s39, s40
  s_cbranch_scc1 L_go175
  s_mov_b32 s43, 1048576
L_poll175:
  ds_read_b128 v[8:11], v14 offset:0
  s_waitcnt lgkmcnt(0)
  v_min3_u32 v8, v8, v9, v10
  v_min_u32 v8, v8, v11
  s_sub_u32 s43, s43, 1
  v_readfirstlane_b32 s39, v8
  s_cbranch_scc1 L_end
  s_cmp_ge_i32 s39, s40
  s_cbranch_scc1 L_go175
  s_sleep 1
  s_branch L_poll175
L_go175:
  s_mov_b32 m0, s41
  v_add_u32 v12, 1, v12
  s_bitcmp1_b32 s81, 0
  s_waitcnt vmcnt(7)
  s_cbranch_scc0 L_w176
  s_waitcnt vmcnt(5)
L_w176:
  buffer_load_dwordx4 v4, s[20:23], s42 offen offset:0 nt lds
  s_bitcmp1_b32 s81, 1
  s_waitcnt vmcnt(7)
  s_cbranch_scc0 L_w177
  s_waitcnt vmcnt(5)
  ds_write_b32 v13, v12
L_w177:
  buffer_load_dwordx4 v4, s[20:23], s42 offen offset:1024 nt lds
  s_bitcmp1_b32 s81, 2
  s_waitcnt vmcnt(7)
  s_cbranch_scc0 L_w178
  s_waitcnt vmcnt(5)
L_w178:
  buffer_load_dwordx4 v5, s[20:23], s42 offen offset:2048 nt lds
  s_bitcmp1_b32 s81, 3
  s_waitcnt vmcnt(7)
  ds_write_b32 v13, v12
  s_cbranch_scc0 L_w179
  s_waitcnt vmcnt(5)
L_w179:
  buffer_load_dwordx4 v5, s[20:23], s42 offen offset:3072 nt lds
  s_add_u32 s49, s49, 1
  s_add_u32 s41, s41, 16384
  s_cmp_ge_u32 s41, s53
  s_cselect_b32 s34, s53, 0
  s_sub_u32 s41, s41, s34
  s_sub_u32 s40, s49, s60
  s_cmp_ge_i32 s39, s40
  s_cbranch_scc1 L_go180
  s_mov_b32 s43, 1048576
L_poll180:
  ds_read_b128 v[8:11], v14 offset:0
  s_waitcnt lgkmcnt(0)
  v_min3_u32 v8, v8, v9, v10
  v_min_u32 v8, v8, v11
  s_sub_u32 s43, s43, 1
  v_readfirstlane_b32 s39, v8
  s_cbranch_scc1 L_end
  s_cmp_ge_i32 s39, s40
  s_cbranch_scc1 L_go180
  s_sleep 1
  s_branch L_poll180
L_go180:
  s_mov_b32 m0, s41
  v_add_u32 v12, 1, v12
  s_bitcmp1_b32 s81, 0
  s_waitcnt vmcnt(7)
  s_cbranch_scc0 L_w181
  s_waitcnt vmcnt(5)
L_w181:
  buffer_load_dwordx4 v6, s[24:27], s42 offen offset:0 nt lds
  s_bitcmp1_b32 s81, 1
  s_waitcnt vmcnt(7)
  s_cbranch_scc0 L_w182
  s_waitcnt vmcnt(5)
  ds_write_b32 v13, v12
L_w182:
  buffer_load_dwordx4 v7, s[24:27], s42 offen offset:1024 nt lds
  s_bitcmp1_b32 s81, 2
  s_waitcnt vmcnt(7)
  s_cbranch_scc0 L_w183
  s_waitcnt vmcnt(5)
L_w183:
  buffer_load_dwordx4 v6, s[24:27], s42 offen offset:2048 nt lds
  s_bitcmp1_b32 s81, 3
  s_waitcnt vmcnt(7)
  ds_write_b32 v13, v12
  s_cbranch_scc0 L_w184
  s_waitcnt vmcnt(5)
L_w184:
  buffer_load_dwordx4 v7, s[24:27], s42 offen offset:3072 nt lds
  s_add_u32 s42, s42, 16384
  s_add_u32 s49, s49, 1
  s_add_u32 s41, s41, 16384
  s_cmp_ge_u32 s41, s53
  s_cselect_b32 s34, s53, 0
  s_sub_u32 s41, s41, s34
  s_sub_u32 s40, s49, s60
  s_cmp_ge_i32 s39, s40
  s_cbranch_scc1 L_go185
  s_mov_b32 s43, 1048576
L_poll185:
  ds_read_b128 v[8:11], v14 offset:0
  s_waitcnt lgkmcnt(0)
  v_min3_u32 v8, v8, v9, v10
  v_min_u32 v8, v8, v11
  s_sub_u32 s43, s43, 1
  v_readfirstlane_b32 s39, v8
  s_cbranch_scc1 L_end
  s_cmp_ge_i32 s39, s40
  s_cbranch_scc1 L_go185
  s_sleep 1
  s_branch L_poll185
L_go185:
  s_mov_b32 m0, s41
  v_add_u32 v12, 1, v12
  s_bitcmp1_b32 s81, 0
  s_waitcnt vmcnt(7)
  s_cbranch_scc0 L_w186
  s_waitcnt vmcnt(5)
L_w186:
  buffer_load_dwordx4 v4, s[20:23], s42 offen offset:0 nt lds
  s_bitcmp1_b32 s81, 1
  s_waitcnt vmcnt(7)
  s_cbranch_scc0 L_w187
  s_waitcnt vmcnt(5)
  ds_write_b32 v13, v12
L_w187:
  buffer_load_dwordx4 v4, s[20:23], s42 offen offset:1024 nt lds
  s_bitcmp1_b32 s81, 2
  s_waitcnt vmcnt(7)
  s_cbranch_scc0 L_w188
  s_waitcnt vmcnt(5)
L_w188:
  buffer_load_dwordx4 v5, s[20:23], s42 offen offset:2048 nt lds
  s_bitcmp1_b32 s81, 3
  s_waitcnt vmcnt(7)
  ds_write_b32 v13, v12
  s_cbranch_scc0 L_w189
  s_waitcnt vmcnt(5)
L_w189:
  buffer_load_dwordx4 v5, s[20:23], s42 offen offset:3072 nt lds
  s_add_u32 s49, s49, 1
  s_add_u32 s41, s41, 16384
  s_cmp_ge_u32 s41, s53
  s_cselect_b32 s34, s53, 0
  s_sub_u32 s41, s41, s34
  s_sub_u32 s40, s49, s60
  s_cmp_ge_i32 s39, s40
  s_cbranch_scc1 L_go190
  s_mov_b32 s43, 1048576
L_poll190:
  ds_read_b128 v[8:11], v14 offset:0
  s_waitcnt lgkmcnt(0)
  v_min3_u32 v8, v8, v9, v10
  v_min_u32 v8, v8, v11
  s_sub_u32 s43, s43, 1
  v_readfirstlane_b32 s39, v8
  s_cbranch_scc1 L_end
  s_cmp_ge_i32 s39, s40
  s_cbranch_scc1 L_go190
  s_sleep 1
  s_branch L_poll190
L_go190:
  s_mov_b32 m0, s41
  v_add_u32 v12, 1, v12
  s_bitcmp1_b32 s81, 0
  s_waitcnt vmcnt(7)
  s_cbranch_scc0 L_w191
  s_waitcnt vmcnt(5)
L_w191:
  buffer_load_dwordx4 v6, s[24:27], s42 offen offset:0 nt lds
  s_bitcmp1_b32 s81, 1
  s_waitcnt vmcnt(7)
  s_cbranch_scc0 L_w192
  s_waitcnt vmcnt(5)
  ds_write_b32 v13, v12
L_w192:
  buffer_load_dwordx4 v7, s[24:27], s42 offen offset:1024 nt lds
  s_bitcmp1_b32 s81, 2
  s_waitcnt vmcnt(7)
  s_cbranch_scc0 L_w193
  s_waitcnt vmcnt(5)
L_w193:
  buffer_load_dwordx4 v6, s[24:27], s42 offen offset:2048 nt lds
  s_bitcmp1_b32 s81, 3
  s_waitcnt vmcnt(7)
  ds_write_b32 v13, v12
  s_cbranch_scc0 L_w194
  s_waitcnt vmcnt(5)
L_w194:
  buffer_load_dwordx4 v7, s[24:27], s42 offen offset:3072 nt lds
  s_add_u32 s42, s42, 16384
  s_add_u32 s49, s49, 1
  s_add_u32 s41, s41, 16384
  s_cmp_ge_u32 s41, s53
  s_cselect_b32 s34, s53, 0
  s_sub_u32 s41, s41, s34
  s_sub_u32 s40, s49, s60
  s_cmp_ge_i32 s39, s40
  s_cbranch_scc1 L_go195
  s_mov_b32 s43, 1048576
L_poll195:
  ds_read_b128 v[8:11], v14 offset:0
  s_waitcnt lgkmcnt(0)
  v_min3_u32 v8, v8, v9, v10
  v_min_u32 v8, v8, v11
  s_sub_u32 s43, s43, 1
  v_readfirstlane_b32 s39, v8
  s_cbranch_scc1 L_end
  s_cmp_ge_i32 s39, s40
  s_cbranch_scc1 L_go195
  s_sleep 1
  s_branch L_poll195
L_go195:
  s_mov_b32 m0, s41
  v_add_u32 v12, 1, v12
  s_bitcmp1_b32 s81, 0
  s_waitcnt vmcnt(7)
  s_cbranch_scc0 L_w196
  s_waitcnt vmcnt(5)
L_w196:
  buffer_load_dwordx4 v4, s[20:23], s42 offen offset:0 nt lds
  s_bitcmp1_b32 s81, 1
  s_waitcnt vmcnt(7)
  s_cbranch_scc0 L_w197
  s_waitcnt vmcnt(5)
  ds_write_b32 v13, v12
L_w197:
  buffer_load_dwordx4 v4, s[20:23], s42 offen offset:1024 nt lds
  s_bitcmp1_b32 s81, 2
  s_waitcnt vmcnt(7)
  s_cbranch_scc0 L_w198
  s_waitcnt vmcnt(5)
L_w198:
  buffer_load_dwordx4 v5, s[20:23], s42 offen offset:2048 nt lds
  s_bitcmp1_b32 s81, 3
  s_waitcnt vmcnt(7)
  ds_write_b32 v13, v12
  s_cbranch_scc0 L_w199
  s_waitcnt vmcnt(5)
L_w199:
  buffer_load_dwordx4 v5, s[20:23], s42 offen offset:3072 nt lds
  s_add_u32 s49, s49, 1
  s_add_u32 s41, s41, 16384
  s_cmp_ge_u32 s41, s53
  s_cselect_b32 s34, s53, 0
  s_sub_u32 s41, s41, s34
  s_sub_u32 s40, s49, s60
  s_cmp_ge_i32 s39, s40
  s_cbranch_scc1 L_go200
  s_mov_b32 s43, 1048576
L_poll200:
  ds_read_b128 v[8:11], v14 offset:0
  s_waitcnt lgkmcnt(0)
  v_min3_u32 v8, v8, v9, v10
  v_min_u32 v8, v8, v11
  s_sub_u32 s43, s43, 1
  v_readfirstlane_b32 s39, v8
  s_cbranch_scc1 L_end
  s_cmp_ge_i32 s39, s40
  s_cbranch_scc1 L_go200
  s_sleep 1
  s_branch L_poll200
L_go200:
  s_mov_b32 m0, s41
  v_add_u32 v12, 1, v12
  s_bitcmp1_b32 s81, 0
  s_waitcnt vmcnt(7)
  s_cbranch_scc0 L_w201
  s_waitcnt vmcnt(5)
L_w201:
  buffer_load_dwordx4 v6, s[24:27], s42 offen offset:0 nt lds
  s_bitcmp1_b32 s81, 1
  s_waitcnt vmcnt(7)
  s_cbranch_scc0 L_w202
  s_waitcnt vmcnt(5)
  ds_write_b32 v13, v12
L_w202:
  buffer_load_dwordx4 v7, s[24:27], s42 offen offset:1024 nt lds
  s_bitcmp1_b32 s81, 2
  s_waitcnt vmcnt(7)
  s_cbranch_scc0 L_w203
  s_waitcnt vmcnt(5)
L_w203:
  buffer_load_dwordx4 v6, s[24:27], s42 offen offset:2048 nt lds
  s_bitcmp1_b32 s81, 3
  s_waitcnt vmcnt(7)
  ds_write_b32 v13, v12
  s_cbranch_scc0 L_w204
  s_waitcnt vmcnt(5)
L_w204:
  buffer_load_dwordx4 v7, s[24:27], s42 offen offset:3072 nt lds
  s_add_u32 s42, s42, 16384
  s_add_u32 s49, s49, 1
  s_add_u32 s41, s41, 16384
  s_cmp_ge_u32 s41, s53
  s_cselect_b32 s34, s53, 0
  s_sub_u32 s41, s41, s34
  s_sub_u32 s40, s49, s60
  s_cmp_ge_i32 s39, s40
  s_cbranch_scc1 L_go205
  s_mov_b32 s43, 1048576
L_poll205:
  ds_read_b128 v[8:11], v14 offset:0
  s_waitcnt lgkmcnt(0)
  v_min3_u32 v8, v8, v9, v10
  v_min_u32 v8, v8, v11
  s_sub_u32 s43, s43, 1
  v_readfirstlane_b32 s39, v8
  s_cbranch_scc1 L_end
  s_cmp_ge_i32 s39, s40
  s_cbranch_scc1 L_go205
  s_sleep 1
  s_branch L_poll205
L_go205:
  s_mov_b32 m0, s41
  v_add_u32 v12, 1, v12
  s_bitcmp1_b32 s81, 0
  s_waitcnt vmcnt(7)
  s_cbranch_scc0 L_w206
  s_waitcnt vmcnt(5)
L_w206:
  buffer_load_dwordx4 v4, s[20:23], s42 offen offset:0 nt lds
  s_bitcmp1_b32 s81, 1
  s_waitcnt vmcnt(7)
  s_cbranch_scc0 L_w207
  s_waitcnt vmcnt(5)
  ds_write_b32 v13, v12
L_w207:
  buffer_load_dwordx4 v4, s[20:23], s42 offen offset:1024 nt lds
  s_bitcmp1_b32 s81, 2
  s_waitcnt vmcnt(7)
  s_cbranch_scc0 L_w208
  s_waitcnt vmcnt(5)
L_w208:
  buffer_load_dwordx4 v5, s[20:23], s42 offen offset:2048 nt lds
  s_bitcmp1_b32 s81, 3
  s_waitcnt vmcnt(7)
  ds_write_b32 v13, v12
  s_cbranch_scc0 L_w209
  s_waitcnt vmcnt(5)
L_w209:
  buffer_load_dwordx4 v5, s[20:23], s42 offen offset:3072 nt lds
  s_add_u32 s49, s49, 1
  s_add_u32 s41, s41, 16384
  s_cmp_ge_u32 s41, s53
  s_cselect_b32 s34, s53, 0
  s_sub_u32 s41, s41, s34
  s_sub_u32 s40, s49, s60
  s_cmp_ge_i32 s39, s40
  s_cbranch_scc1 L_go210
  s_mov_b32 s43, 1048576
L_poll210:
  ds_read_b128 v[8:11], v14 offset:0
  s_waitcnt lgkmcnt(0)
  v_min3_u32 v8, v8, v9, v10
  v_min_u32 v8, v8, v11
  s_sub_u32 s43, s43, 1
  v_readfirstlane_b32 s39, v8
  s_cbranch_scc1 L_end
  s_cmp_ge_i32 s39, s40
  s_cbranch_scc1 L_go210
  s_sleep 1
  s_branch L_poll210
L_go210:
  s_mov_b32 m0, s41
  v_add_u32 v12, 1, v12
  s_bitcmp1_b32 s81, 0
  s_waitcnt vmcnt(7)
  s_cbranch_scc0 L_w211
  s_waitcnt vmcnt(5)
L_w211:
  buffer_load_dwordx4 v6, s[24:27], s42 offen offset:0 nt lds
  s_bitcmp1_b32 s81, 1
  s_waitcnt vmcnt(7)
  s_cbranch_scc0 L_w212
  s_waitcnt vmcnt(5)
  ds_write_b32 v13, v12
L_w212:
  buffer_load_dwordx4 v7, s[24:27], s42 offen offset:1024 nt lds
  s_bitcmp1_b32 s81, 2
  s_waitcnt vmcnt(7)
  s_cbranch_scc0 L_w213
  s_waitcnt vmcnt(5)
L_w213:
  buffer_load_dwordx4 v6, s[24:27], s42 offen offset:2048 nt lds
  s_bitcmp1_b32 s81, 3
  s_waitcnt vmcnt(7)
  ds_write_b32 v13, v12
  s_cbranch_scc0 L_w214
  s_waitcnt vmcnt(5)
L_w214:
  buffer_load_dwordx4 v7, s[24:27], s42 offen offset:3072 nt lds
  s_add_u32 s42, s42, 16384
  s_add_u32 s49, s49, 1
  s_add_u32 s41, s41, 16384
  s_cmp_ge_u32 s41, s53
  s_cselect_b32 s34, s53, 0
  s_sub_u32 s41, s41, s34
  s_sub_u32 s40, s49, s60
  s_cmp_ge_i32 s39, s40
  s_cbranch_scc1 L_go215
  s_mov_b32 s43, 1048576
L_poll215:
  ds_read_b128 v[8:11], v14 offset:0
  s_waitcnt lgkmcnt(0)
  v_min3_u32 v8, v8, v9, v10
  v_min_u32 v8, v8, v11
  s_sub_u32 s43, s43, 1
  v_readfirstlane_b32 s39, v8
  s_cbranch_scc1 L_end
  s_cmp_ge_i32 s39, s40
  s_cbranch_scc1 L_go215
  s_sleep 1
  s_branch L_poll215
L_go215:
  s_mov_b32 m0, s41
  v_add_u32 v12, 1, v12
  s_bitcmp1_b32 s81, 0
  s_waitcnt vmcnt(7)
  s_cbranch_scc0 L_w216
  s_waitcnt vmcnt(5)
L_w216:
  buffer_load_dwordx4 v4, s[20:23], s42 offen offset:0 nt lds
  s_bitcmp1_b32 s81, 1
  s_waitcnt vmcnt(7)
  s_cbranch_scc0 L_w217
  s_waitcnt vmcnt(5)
  ds_write_b32 v13, v12
L_w217:
  buffer_load_dwordx4 v4, s[20:23], s42 offen offset:1024 nt lds
  s_bitcmp1_b32 s81, 2
  s_waitcnt vmcnt(7)
  s_cbranch_scc0 L_w218
  s_waitcnt vmcnt(5)
L_w218:
  buffer_load_dwordx4 v5, s[20:23], s42 offen offset:2048 nt lds
  s_bitcmp1_b32 s81, 3
  s_waitcnt vmcnt(7)
  ds_write_b32 v13, v12
  s_cbranch_scc0 L_w219
  s_waitcnt vmcnt(5)
L_w219:
  buffer_load_dwordx4 v5, s[20:23], s42 offen offset:3072 nt lds
  s_add_u32 s49, s49, 1
  s_add_u32 s41, s41, 16384
  s_cmp_ge_u32 s41, s53
  s_cselect_b32 s34, s53, 0
  s_sub_u32 s41, s41, s34
  s_sub_u32 s40, s49, s60
  s_cmp_ge_i32 s39, s40
  s_cbranch_scc1 L_go220
  s_mov_b32 s43, 1048576
L_poll220:
  ds_read_b128 v[8:11], v14 offset:0
  s_waitcnt lgkmcnt(0)
  v_min3_u32 v8, v8, v9, v10
  v_min_u32 v8, v8, v11
  s_sub_u32 s43, s43, 1
  v_readfirstlane_b32 s39, v8
  s_cbranch_scc1 L_end
  s_cmp_ge_i32 s39, s40
  s_cbranch_scc1 L_go220
  s_sleep 1
  s_branch L_poll220
L_go220:
  s_mov_b32 m0, s41
  v_add_u32 v12, 1, v12
  s_bitcmp1_b32 s81, 0
  s_waitcnt vmcnt(7)
  s_cbranch_scc0 L_w221
  s_waitcnt vmcnt(5)
L_w221:
  buffer_load_dwordx4 v6, s[24:27], s42 offen offset:0 nt lds
  s_bitcmp1_b32 s81, 1
  s_waitcnt vmcnt(7)
  s_cbranch_scc0 L_w222
  s_waitcnt vmcnt(5)
  ds_write_b32 v13, v12
L_w222:
  buffer_load_dwordx4 v7, s[24:27], s42 offen offset:1024 nt lds
  s_bitcmp1_b32 s81, 2
  s_waitcnt vmcnt(7)
  s_cbranch_scc0 L_w223
  s_waitcnt vmcnt(5)
L_w223:
  buffer_load_dwordx4 v6, s[24:27], s42 offen offset:2048 nt lds
  s_bitcmp1_b32 s81, 3
  s_waitcnt vmcnt(7)
  ds_write_b32 v13, v12
  s_cbranch_scc0 L_w224
  s_waitcnt vmcnt(5)
L_w224:
  buffer_load_dwordx4 v7, s[24:27], s42 offen offset:3072 nt lds
  s_add_u32 s42, s42, 16384
  s_add_u32 s49, s49, 1
  s_add_u32 s41, s41, 16384
  s_cmp_ge_u32 s41, s53
  s_cselect_b32 s34, s53, 0
  s_sub_u32 s41, s41, s34
  s_sub_u32 s40, s49, s60
  s_cmp_ge_i32 s39, s40
  s_cbranch_scc1 L_go225
  s_mov_b32 s43, 1048576
L_poll225:
  ds_read_b128 v[8:11], v14 offset:0
  s_waitcnt lgkmcnt(0)
  v_min3_u32 v8, v8, v9, v10
  v_min_u32 v8, v8, v11
  s_sub_u32 s43, s43, 1
  v_readfirstlane_b32 s39, v8
  s_cbranch_scc1 L_end
  s_cmp_ge_i32 s39, s40
  s_cbranch_scc1 L_go225
  s_sleep 1
  s_branch L_poll225
L_go225:
  s_mov_b32 m0, s41
  v_add_u32 v12, 1, v12
  s_bitcmp1_b32 s81, 0
  s_waitcnt vmcnt(7)
  s_cbranch_scc0 L_w226
  s_waitcnt vmcnt(5)
L_w226:
  buffer_load_dwordx4 v4, s[20:23], s42 offen offset:0 nt lds
  s_bitcmp1_b32 s81, 1
  s_waitcnt vmcnt(7)
  s_cbranch_scc0 L_w227
  s_waitcnt vmcnt(5)
  ds_write_b32 v13, v12
L_w227:
  buffer_load_dwordx4 v4, s[20:23], s42 offen offset:1024 nt lds
  s_bitcmp1_b32 s81, 2
  s_waitcnt vmcnt(7)
  s_cbranch_scc0 L_w228
  s_waitcnt vmcnt(5)
L_w228:
  buffer_load_dwordx4 v5, s[20:23], s42 offen offset:2048 nt lds
  s_bitcmp1_b32 s81, 3
  s_waitcnt vmcnt(7)
  ds_write_b32 v13, v12
  s_cbranch_scc0 L_w229
  s_waitcnt vmcnt(5)
L_w229:
  buffer_load_dwordx4 v5, s[20:23], s42 offen offset:3072 nt lds
  s_add_u32 s49, s49, 1
  s_add_u32 s41, s41, 16384
  s_cmp_ge_u32 s41, s53
  s_cselect_b32 s34, s53, 0
  s_sub_u32 s41, s41, s34
  s_sub_u32 s40, s49, s60
  s_cmp_ge_i32 s39, s40
  s_cbranch_scc1 L_go230
  s_mov_b32 s43, 1048576
L_poll230:
  ds_read_b128 v[8:11], v14 offset:0
  s_waitcnt lgkmcnt(0)
  v_min3_u32 v8, v8, v9, v10
  v_min_u32 v8, v8, v11
  s_sub_u32 s43, s43, 1
  v_readfirstlane_b32 s39, v8
  s_cbranch_scc1 L_end
  s_cmp_ge_i32 s39, s40
  s_cbranch_scc1 L_go230
  s_sleep 1
  s_branch L_poll230
L_go230:
  s_mov_b32 m0, s41
  v_add_u32 v12, 1, v12
  s_bitcmp1_b32 s81, 0
  s_waitcnt vmcnt(7)
  s_cbranch_scc0 L_w231
  s_waitcnt vmcnt(5)
L_w231:
  buffer_load_dwordx4 v6, s[24:27], s42 offen offset:0 nt lds
  s_bitcmp1_b32 s81, 1
  s_waitcnt vmcnt(7)
  s_cbranch_scc0 L_w232
  s_waitcnt vmcnt(5)
  ds_write_b32 v13, v12
L_w232:
  buffer_load_dwordx4 v7, s[24:27], s42 offen offset:1024 nt lds
  s_bitcmp1_b32 s81, 2
  s_waitcnt vmcnt(7)
  s_cbranch_scc0 L_w233
  s_waitcnt vmcnt(5)
L_w233:
  buffer_load_dwordx4 v6, s[24:27], s42 offen offset:2048 nt lds
  s_bitcmp1_b32 s81, 3
  s_waitcnt vmcnt(7)
  ds_write_b32 v13, v12
  s_cbranch_scc0 L_w234
  s_waitcnt vmcnt(5)
L_w234:
  buffer_load_dwordx4 v7, s[24:27], s42 offen offset:3072 nt lds
  s_add_u32 s42, s42, 16384
  s_add_u32 s49, s49, 1
  s_add_u32 s41, s41, 16384
  s_cmp_ge_u32 s41, s53
  s_cselect_b32 s34, s53, 0
  s_sub_u32 s41, s41, s34
  s_mov_b32 s53, 65536
  s_sub_u32 s40, s49, s60
  s_cmp_ge_i32 s39, s40
  s_cbranch_scc1 L_go235
  s_mov_b32 s43, 1048576
L_poll235:
  ds_read_b128 v[8:11], v14 offset:0
  s_waitcnt lgkmcnt(0)
  v_min3_u32 v8, v8, v9, v10
  v_min_u32 v8, v8, v11
  s_sub_u32 s43, s43, 1
  v_readfirstlane_b32 s39, v8
  s_cbranch_scc1 L_end
  s_cmp_ge_i32 s39, s40
  s_cbranch_scc1 L_go235
  s_sleep 1
  s_branch L_poll235
L_go235:
  s_mov_b32 m0, s41
  v_add_u32 v12, 1, v12
  s_bitcmp1_b32 s81, 0
  s_waitcnt vmcnt(7)
  s_cbranch_scc0 L_w236
  s_waitcnt vmcnt(5)
L_w236:
  buffer_load_dwordx4 v4, s[20:23], s42 offen offset:0 nt lds
  s_bitcmp1_b32 s81, 1
  s_waitcnt vmcnt(7)
  s_cbranch_scc0 L_w237
  s_waitcnt vmcnt(5)
  ds_write_b32 v13, v12
L_w237:
  buffer_load_dwordx4 v4, s[20:23], s42 offen offset:1024 nt lds
  s_bitcmp1_b32 s81, 2
  s_waitcnt vmcnt(7)
  s_cbranch_scc0 L_w238
  s_waitcnt vmcnt(5)
L_w238:
  buffer_load_dwordx4 v5, s[20:23], s42 offen offset:2048 nt lds
  s_bitcmp1_b32 s81, 3
  s_waitcnt vmcnt(7)
  ds_write_b32 v13, v12
  s_cbranch_scc0 L_w239
  s_waitcnt vmcnt(5)
L_w239:
  buffer_load_dwordx4 v5, s[20:23], s42 offen offset:3072 nt lds
  s_add_u32 s49, s49, 1
  s_add_u32 s41, s41, 16384
  s_cmp_ge_u32 s41, s53
  s_cselect_b32 s34, s53, 0
  s_sub_u32 s41, s41, s34
  s_sub_u32 s40, s49, s60
  s_cmp_ge_i32 s39, s40
  s_cbranch_scc1 L_go240
  s_mov_b32 s43, 1048576
L_poll240:
  ds_read_b128 v[8:11], v14 offset:0
  s_waitcnt lgkmcnt(0)
  v_min3_u32 v8, v8, v9, v10
  v_min_u32 v8, v8, v11
  s_sub_u32 s43, s43, 1
  v_readfirstlane_b32 s39, v8
  s_cbranch_scc1 L_end
  s_cmp_ge_i32 s39, s40
  s_cbranch_scc1 L_go240
  s_sleep 1
  s_branch L_poll240
L_go240:
  s_mov_b32 m0, s41
  v_add_u32 v12, 1, v12
  s_bitcmp1_b32 s81, 0
  s_waitcnt vmcnt(7)
  s_cbranch_scc0 L_w241
  s_waitcnt vmcnt(5)
L_w241:
  buffer_load_dwordx4 v6, s[24:27], s42 offen offset:0 nt lds
  s_bitcmp1_b32 s81, 1
  s_waitcnt vmcnt(7)
  s_cbranch_scc0 L_w242
  s_waitcnt vmcnt(5)
  ds_write_b32 v13, v12
L_w242:
  buffer_load_dwordx4 v7, s[24:27], s42 offen offset:1024 nt lds
  s_bitcmp1_b32 s81, 2
  s_waitcnt vmcnt(7)
  s_cbranch_scc0 L_w243
  s_waitcnt vmcnt(5)
L_w243:
  buffer_load_dwordx4 v6, s[24:27], s42 offen offset:2048 nt lds
  s_bitcmp1_b32 s81, 3
  s_waitcnt vmcnt(7)
  ds_write_b32 v13, v12
  s_cbranch_scc0 L_w244
  s_waitcnt vmcnt(5)
L_w244:
  buffer_load_dwordx4 v7, s[24:27], s42 offen offset:3072 nt lds
  s_add_u32 s42, s42, 16384
  s_add_u32 s49, s49, 1
  s_add_u32 s41, s41, 16384
  s_cmp_ge_u32 s41, s53
  s_cselect_b32 s34, s53, 0
  s_sub_u32 s41, s41, s34
  s_sub_u32 s40, s49, s60
  s_cmp_ge_i32 s39, s40
  s_cbranch_scc1 L_go245
  s_mov_b32 s43, 1048576
L_poll245:
  ds_read_b128 v[8:11], v14 offset:0
  s_waitcnt lgkmcnt(0)
  v_min3_u32 v8, v8, v9, v10
  v_min_u32 v8, v8, v11
  s_sub_u32 s43, s43, 1
  v_readfirstlane_b32 s39, v8
  s_cbranch_scc1 L_end
  s_cmp_ge_i32 s39, s40
  s_cbranch_scc1 L_go245
  s_sleep 1
  s_branch L_poll245
L_go245:
  s_mov_b32 m0, s41
  v_add_u32 v12, 1, v12
  s_bitcmp1_b32 s81, 0
  s_waitcnt vmcnt(7)
  s_cbranch_scc0 L_w246
  s_waitcnt vmcnt(5)
L_w246:
  buffer_load_dwordx4 v4, s[20:23], s42 offen offset:0 nt lds
  s_bitcmp1_b32 s81, 1
  s_waitcnt vmcnt(7)
  s_cbranch_scc0 L_w247
  s_waitcnt vmcnt(5)
  ds_write_b32 v13, v12
L_w247:
  buffer_load_dwordx4 v4, s[20:23], s42 offen offset:1024 nt lds
  s_bitcmp1_b32 s81, 2
  s_waitcnt vmcnt(7)
  s_cbranch_scc0 L_w248
  s_waitcnt vmcnt(5)
L_w248:
  buffer_load_dwordx4 v5, s[20:23], s42 offen offset:2048 nt lds
  s_bitcmp1_b32 s81, 3
  s_waitcnt vmcnt(7)
  ds_write_b32 v13, v12
  s_cbranch_scc0 L_w249
  s_waitcnt vmcnt(5)
L_w249:
  buffer_load_dwordx4 v5, s[20:23], s42 offen offset:3072 nt lds
  s_add_u32 s49, s49, 1
  s_add_u32 s41, s41, 16384
  s_cmp_ge_u32 s41, s53
  s_cselect_b32 s34, s53, 0
  s_sub_u32 s41, s41, s34
  s_sub_u32 s40, s49, s60
  s_cmp_ge_i32 s39, s40
  s_cbranch_scc1 L_go250
  s_mov_b32 s43, 1048576
L_poll250:
  ds_read_b128 v[8:11], v14 offset:0
  s_waitcnt lgkmcnt(0)
  v_min3_u32 v8, v8, v9, v10
  v_min_u32 v8, v8, v11
  s_sub_u32 s43, s43, 1
  v_readfirstlane_b32 s39, v8
  s_cbranch_scc1 L_end
  s_cmp_ge_i32 s39, s40
  s_cbranch_scc1 L_go250
  s_sleep 1
  s_branch L_poll250
L_go250:
  s_mov_b32 m0, s41
  v_add_u32 v12, 1, v12
  s_bitcmp1_b32 s81, 0
  s_waitcnt vmcnt(7)
  s_cbranch_scc0 L_w251
  s_waitcnt vmcnt(5)
L_w251:
  buffer_load_dwordx4 v6, s[24:27], s42 offen offset:0 nt lds
  s_bitcmp1_b32 s81, 1
  s_waitcnt vmcnt(7)
  s_cbranch_scc0 L_w252
  s_waitcnt vmcnt(5)
  ds_write_b32 v13, v12
L_w252:
  buffer_load_dwordx4 v7, s[24:27], s42 offen offset:1024 nt lds
  s_bitcmp1_b32 s81, 2
  s_waitcnt vmcnt(7)
  s_cbranch_scc0 L_w253
  s_waitcnt vmcnt(5)
L_w253:
  buffer_load_dwordx4 v6, s[24:27], s42 offen offset:2048 nt lds
  s_bitcmp1_b32 s81, 3
  s_waitcnt vmcnt(7)
  ds_write_b32 v13, v12
  s_cbranch_scc0 L_w254
  s_waitcnt vmcnt(5)
L_w254:
  buffer_load_dwordx4 v7, s[24:27], s42 offen offset:3072 nt lds
  s_add_u32 s42, s42, 16384
  s_add_u32 s49, s49, 1
  s_add_u32 s41, s41, 16384
  s_cmp_ge_u32 s41, s53
  s_cselect_b32 s34, s53, 0
  s_sub_u32 s41, s41, s34
  s_mov_b32 s81, 15
  s_mov_b32 s60, 0
  s_sub_u32 s40, s49, s60
  s_cmp_ge_i32 s39, s40
  s_cbranch_scc1 L_go255
  s_mov_b32 s43, 1048576
L_poll255:
  ds_read_b128 v[8:11], v14 offset:0
  s_waitcnt lgkmcnt(0)
  v_min3_u32 v8, v8, v9, v10
  v_min_u32 v8, v8, v11
  s_sub_u32 s43, s43, 1
  v_readfirstlane_b32 s39, v8
  s_cbranch_scc1 L_end
  s_cmp_ge_i32 s39, s40
  s_cbranch_scc1 L_go255
  s_sleep 1
  s_branch L_poll255
L_go255:
  s_mov_b32 m0, s41
  v_add_u32 v12, 1, v12
  s_bitcmp1_b32 s81, 0
  s_waitcnt vmcnt(7)
  s_cbranch_scc0 L_w256
  s_waitcnt vmcnt(5)
L_w256:
  buffer_load_dwordx4 v4, s[20:23], s42 offen offset:0 nt lds
  s_bitcmp1_b32 s81, 1
  s_waitcnt vmcnt(7)
  s_cbranch_scc0 L_w257
  s_waitcnt vmcnt(5)
  ds_write_b32 v13, v12
L_w257:
  buffer_load_dwordx4 v4, s[20:23], s42 offen offset:1024 nt lds
  s_bitcmp1_b32 s81, 2
  s_waitcnt vmcnt(7)
  s_cbranch_scc0 L_w258
  s_waitcnt vmcnt(5)
L_w258:
  buffer_load_dwordx4 v5, s[20:23], s42 offen offset:2048 nt lds
  s_bitcmp1_b32 s81, 3
  s_waitcnt vmcnt(7)
  ds_write_b32 v13, v12
  s_cbranch_scc0 L_w259
  s_waitcnt vmcnt(5)
L_w259:
  buffer_load_dwordx4 v5, s[20:23], s42 offen offset:3072 nt lds
  s_add_u32 s49, s49, 1
  s_add_u32 s41, s41, 16384
  s_cmp_ge_u32 s41, s53
  s_cselect_b32 s34, s53, 0
  s_sub_u32 s41, s41, s34
  s_sub_u32 s40, s49, s60
  s_cmp_ge_i32 s39, s40
  s_cbranch_scc1 L_go260
  s_mov_b32 s43, 1048576
L_poll260:
  ds_read_b128 v[8:11], v14 offset:0
  s_waitcnt lgkmcnt(0)
  v_min3_u32 v8, v8, v9, v10
  v_min_u32 v8, v8, v11
  s_sub_u32 s43, s43, 1
  v_readfirstlane_b32 s39, v8
  s_cbranch_scc1 L_end
  s_cmp_ge_i32 s39, s40
  s_cbranch_scc1 L_go260
  s_sleep 1
  s_branch L_poll260
L_go260:
  s_mov_b32 m0, s41
  v_add_u32 v12, 1, v12
  s_bitcmp1_b32 s81, 0
  s_waitcnt vmcnt(7)
  s_cbranch_scc0 L_w261
  s_waitcnt vmcnt(5)
L_w261:
  buffer_load_dwordx4 v6, s[24:27], s42 offen offset:0 nt lds
  s_bitcmp1_b32 s81, 1
  s_waitcnt vmcnt(7)
  s_cbranch_scc0 L_w262
  s_waitcnt vmcnt(5)
  ds_write_b32 v13, v12
L_w262:
  buffer_load_dwordx4 v7, s[24:27], s42 offen offset:1024 nt lds
  s_bitcmp1_b32 s81, 2
  s_waitcnt vmcnt(7)
  s_cbranch_scc0 L_w263
  s_waitcnt vmcnt(5)
L_w263:
  buffer_load_dwordx4 v6, s[24:27], s42 offen offset:2048 nt lds
  s_bitcmp1_b32 s81, 3
  s_waitcnt vmcnt(7)
  ds_write_b32 v13, v12
  s_cbranch_scc0 L_w264
  s_waitcnt vmcnt(5)
L_w264:
  buffer_load_dwordx4 v7, s[24:27], s42 offen offset:3072 nt lds
  s_add_u32 s42, s42, 16384
  s_add_u32 s49, s49, 1
  s_add_u32 s41, s41, 16384
  s_cmp_ge_u32 s41, s53
  s_cselect_b32 s34, s53, 0
  s_sub_u32 s41, s41, s34
L_join:
  s_mov_b32 s61, 458752
  s_bitcmp1_b32 s32, 0
  s_cselect_b32 s81, 15, 15
  s_sub_u32 s40, s49, s60
  s_cmp_ge_i32 s39, s40
  s_cbranch_scc1 L_go265
  s_mov_b32 s43, 1048576
L_poll265:
  ds_read_b128 v[8:11], v14 offset:0
  s_waitcnt lgkmcnt(0)
  v_min3_u32 v8, v8, v9, v10
  v_min_u32 v8, v8, v11
  s_sub_u32 s43, s43, 1
  v_readfirstlane_b32 s39, v8
  s_cbranch_scc1 L_end
  s_cmp_ge_i32 s39, s40
  s_cbranch_scc1 L_go265
  s_sleep 1
  s_branch L_poll265
L_go265:
  s_waitcnt lgkmcnt(0)
  s_xor_b32 s36, s48, 0
  s_add_u32 m0, s51, 4096
  s_nop 0
  buffer_load_dwordx4 v16, s[44:47], s36 offen offset:0 lds
  s_mov_b32 m0, s41
  v_add_u32 v12, 1, v12
  s_bitcmp1_b32 s81, 0
  s_waitcnt vmcnt(8)
  s_cbranch_scc0 L_w266
  s_waitcnt vmcnt(6)
L_w266:
  buffer_load_dwordx4 v4, s[20:23], s42 offen offset:0 nt lds
  s_bitcmp1_b32 s81, 1
  s_waitcnt vmcnt(8)
  s_cbranch_scc0 L_w267
  s_waitcnt vmcnt(6)
  ds_write_b32 v13, v12
L_w267:
  buffer_load_dwordx4 v4, s[20:23], s42 offen offset:1024 nt lds
  s_add_u32 m0, s51, 4096
  s_nop 0
  buffer_load_dwordx4 v17, s[44:47], s36 offen offset:1024 lds
  s_mov_b32 m0, s41
  s_bitcmp1_b32 s81, 2
  s_waitcnt vmcnt(9)
  s_cbranch_scc0 L_w268
  s_waitcnt vmcnt(7)
L_w268:
  buffer_load_dwordx4 v5, s[20:23], s42 offen offset:2048 nt lds
  s_bitcmp1_b32 s81, 3
  s_waitcnt vmcnt(9)
  ds_write_b32 v13, v12
  s_cbranch_scc0 L_w269
  s_waitcnt vmcnt(7)
L_w269:
  buffer_load_dwordx4 v5, s[20:23], s42 offen offset:3072 nt lds
  s_add_u32 s49, s49, 1
  s_add_u32 s41, s41, 16384
  s_cmp_ge_u32 s41, s53
  s_cselect_b32 s34, s53, 0
  s_sub_u32 s41, s41, s34
  s_sub_u32 s40, s49, s60
  s_cmp_ge_i32 s39, s40
  s_cbranch_scc1 L_go270
  s_mov_b32 s43, 1048576
L_poll270:
  ds_read_b128 v[8:11], v14 offset:0
  s_waitcnt lgkmcnt(0)
  v_min3_u32 v8, v8, v9, v10
  v_min_u32 v8, v8, v11
  s_sub_u32 s43, s43, 1
  v_readfirstlane_b32 s39, v8
  s_cbranch_scc1 L_end
  s_cmp_ge_i32 s39, s40
  s_cbranch_scc1 L_go270
  s_sleep 1
  s_branch L_poll270
L_go270:
  s_xor_b32 s36, s48, 16384
  s_add_u32 m0, s51, 6144
  s_nop 0
  buffer_load_dwordx4 v16, s[44:47], s36 offen offset:0 lds
  s_mov_b32 m0, s41
  v_add_u32 v12, 1, v12
  s_bitcmp1_b32 s81, 0
  s_waitcnt vmcnt(10)
  s_cbranch_scc0 L_w271
  s_waitcnt vmcnt(8)
L_w271:
  buffer_load_dwordx4 v6, s[24:27], s42 offen offset:0 nt lds
  s_bitcmp1_b32 s81, 1
  s_waitcnt vmcnt(10)
  s_cbranch_scc0 L_w272
  s_waitcnt vmcnt(8)
  ds_write_b32 v13, v12
L_w272:
  buffer_load_dwordx4 v7, s[24:27], s42 offen offset:1024 nt lds
  s_add_u32 m0, s51, 6144
  s_nop 0
  buffer_load_dwordx4 v17, s[44:47], s36 offen offset:1024 lds
  s_mov_b32 m0, s41
  s_bitcmp1_b32 s81, 2
  s_waitcnt vmcnt(11)
  s_cbranch_scc0 L_w273
  s_waitcnt vmcnt(8)
L_w273:
  buffer_load_dwordx4 v6, s[24:27], s42 offen offset:2048 nt lds
  s_bitcmp1_b32 s81, 3
  s_waitcnt vmcnt(11)
  ds_write_b32 v13, v12
  s_cbranch_scc0 L_w274
  s_waitcnt vmcnt(8)
L_w274:
  buffer_load_dwordx4 v7, s[24:27], s42 offen offset:3072 nt lds
  s_add_u32 s42, s42, 16384
  s_add_u32 s49, s49, 1
  s_add_u32 s41, s41, 16384
  s_cmp_ge_u32 s41, s53
  s_cselect_b32 s34, s53, 0
  s_sub_u32 s41, s41, s34
  s_sub_u32 s40, s49, s60
  s_cmp_ge_i32 s39, s40
  s_cbranch_scc1 L_go275
  s_mov_b32 s43, 1048576
L_poll275:
  ds_read_b128 v[8:11], v14 offset:0
  s_waitcnt lgkmcnt(0)
  v_min3_u32 v8, v8, v9, v10
  v_min_u32 v8, v8, v11
  s_sub_u32 s43, s43, 1
  v_readfirstlane_b32 s39, v8
  s_cbranch_scc1 L_end
  s_cmp_ge_i32 s39, s40
  s_cbranch_scc1 L_go275
  s_sleep 1
  s_branch L_poll275
L_go275:
  s_xor_b32 s36, s48, 32768
  s_add_u32 m0, s51, 8192
  s_nop 0
  buffer_load_dwordx4 v16, s[44:47], s36 offen offset:0 lds
  s_mov_b32 m0, s41
  v_add_u32 v12, 1, v12
  s_bitcmp1_b32 s81, 0
  s_waitcnt vmcnt(11)
  s_cbranch_scc0 L_w276
  s_waitcnt vmcnt(8)
L_w276:
  buffer_load_dwordx4 v4, s[20:23], s42 offen offset:0 nt lds
  s_bitcmp1_b32 s81, 1
  s_waitcnt vmcnt(11)
  s_cbranch_scc0 L_w277
  s_waitcnt vmcnt(8)
  ds_write_b32 v13, v12
L_w277:
  buffer_load_dwordx4 v4, s[20:23], s42 offen offset:1024 nt lds
  s_add_u32 m0, s51, 8192
  s_nop 0
  buffer_load_dwordx4 v17, s[44:47], s36 offen offset:1024 lds
  s_mov_b32 m0, s41
  s_bitcmp1_b32 s81, 2
  s_waitcnt vmcnt(11)
  s_cbranch_scc0 L_w278
  s_waitcnt vmcnt(8)
L_w278:
  buffer_load_dwordx4 v5, s[20:23], s42 offen offset:2048 nt lds
  s_bitcmp1_b32 s81, 3
  s_waitcnt vmcnt(11)
  ds_write_b32 v13, v12
  s_cbranch_scc0 L_w279
  s_waitcnt vmcnt(8)
L_w279:
  buffer_load_dwordx4 v5, s[20:23], s42 offen offset:3072 nt lds
  s_add_u32 s49, s49, 1
  s_add_u32 s41, s41, 16384
  s_cmp_ge_u32 s41, s53
  s_cselect_b32 s34, s53, 0
  s_sub_u32 s41, s41, s34
  s_sub_u32 s40, s49, s60
  s_cmp_ge_i32 s39, s40
  s_cbranch_scc1 L_go280
  s_mov_b32 s43, 1048576
L_poll280:
  ds_read_b128 v[8:11], v14 offset:0
  s_waitcnt lgkmcnt(0)
  v_min3_u32 v8, v8, v9, v10
  v_min_u32 v8, v8, v11
  s_sub_u32 s43, s43, 1
  v_readfirstlane_b32 s39, v8
  s_cbranch_scc1 L_end
  s_cmp_ge_i32 s39, s40
  s_cbranch_scc1 L_go280
  s_sleep 1
  s_branch L_poll280
L_go280:
  s_xor_b32 s36, s48, 49152
  s_add_u32 m0, s51, 10240
  s_nop 0
  buffer_load_dwordx4 v16, s[44:47], s36 offen offset:0 lds
  s_mov_b32 m0, s41
  v_add_u32 v12, 1, v12
  s_bitcmp1_b32 s81, 0
  s_waitcnt vmcnt(11)
  s_cbranch_scc0 L_w281
  s_waitcnt vmcnt(8)
L_w281:
  buffer_load_dwordx4 v6, s[24:27], s42 offen offset:0 nt lds
  s_bitcmp1_b32 s81, 1
  s_waitcnt vmcnt(11)
  s_cbranch_scc0 L_w282
  s_waitcnt vmcnt(8)
  ds_write_b32 v13, v12
L_w282:
  buffer_load_dwordx4 v7, s[24:27], s42 offen offset:1024 nt lds
  s_add_u32 m0, s51, 10240
  s_nop 0
  buffer_load_dwordx4 v17, s[44:47], s36 offen offset:1024 lds
  s_mov_b32 m0, s41
  s_bitcmp1_b32 s81, 2
  s_waitcnt vmcnt(11)
  s_cbranch_scc0 L_w283
  s_waitcnt vmcnt(8)
L_w283:
  buffer_load_dwordx4 v6, s[24:27], s42 offen offset:2048 nt lds
  s_bitcmp1_b32 s81, 3
  s_waitcnt vmcnt(11)
  ds_write_b32 v13, v12
  s_cbranch_scc0 L_w284
  s_waitcnt vmcnt(8)
L_w284:
  buffer_load_dwordx4 v7, s[24:27], s42 offen offset:3072 nt lds
  s_add_u32 s42, s42, 16384
  s_add_u32 s49, s49, 1
  s_add_u32 s41, s41, 16384
  s_cmp_ge_u32 s41, s53
  s_cselect_b32 s34, s53, 0
  s_sub_u32 s41, s41, s34
  s_sub_u32 s40, s49, s60
  s_cmp_ge_i32 s39, s40
  s_cbranch_scc1 L_go285
  s_mov_b32 s43, 1048576
L_poll285:
  ds_read_b128 v[8:11], v14 offset:0
  s_waitcnt lgkmcnt(0)
  v_min3_u32 v8, v8, v9, v10
  v_min_u32 v8, v8, v11
  s_sub_u32 s43, s43, 1
  v_readfirstlane_b32 s39, v8
  s_cbranch_scc1 L_end
  s_cmp_ge_i32 s39, s40
  s_cbranch_scc1 L_go285
  s_sleep 1
  s_branch L_poll285
L_go285:
  s_xor_b32 s36, s48, 65536
  s_add_u32 m0, s51, 12288
  s_nop 0
  buffer_load_dwordx4 v16, s[44:47], s36 offen offset:0 lds
  s_mov_b32 m0, s41
  v_add_u32 v12, 1, v12
  s_bitcmp1_b32 s81, 0
  s_waitcnt vmcnt(11)
  s_cbranch_scc0 L_w286
  s_waitcnt vmcnt(8)
L_w286:
  buffer_load_dwordx4 v4, s[20:23], s42 offen offset:0 nt lds
  s_bitcmp1_b32 s81, 1
  s_waitcnt vmcnt(11)
  s_cbranch_scc0 L_w287
  s_waitcnt vmcnt(8)
  ds_write_b32 v13, v12
L_w287:
  buffer_load_dwordx4 v4, s[20:23], s42 offen offset:1024 nt lds
  s_add_u32 m0, s51, 12288
  s_nop 0
  buffer_load_dwordx4 v17, s[44:47], s36 offen offset:1024 lds
  s_mov_b32 m0, s41
  s_bitcmp1_b32 s81, 2
  s_waitcnt vmcnt(11)
  s_cbranch_scc0 L_w288
  s_waitcnt vmcnt(8)
L_w288:
  buffer_load_dwordx4 v5, s[20:23], s42 offen offset:2048 nt lds
  s_bitcmp1_b32 s81, 3
  s_waitcnt vmcnt(11)
  ds_write_b32 v13, v12
  s_cbranch_scc0 L_w289
  s_waitcnt vmcnt(8)
L_w289:
  buffer_load_dwordx4 v5, s[20:23], s42 offen offset:3072 nt lds
  s_add_u32 s49, s49, 1
  s_add_u32 s41, s41, 16384
  s_cmp_ge_u32 s41, s53
  s_cselect_b32 s34, s53, 0
  s_sub_u32 s41, s41, s34
  s_sub_u32 s40, s49, s60
  s_cmp_ge_i32 s39, s40
  s_cbranch_scc1 L_go290
  s_mov_b32 s43, 1048576
L_poll290:
  ds_read_b128 v[8:11], v14 offset:0
  s_waitcnt lgkmcnt(0)
  v_min3_u32 v8, v8, v9, v10
  v_min_u32 v8, v8, v11
  s_sub_u32 s43, s43, 1
  v_readfirstlane_b32 s39, v8
  s_cbranch_scc1 L_end
  s_cmp_ge_i32 s39, s40
  s_cbranch_scc1 L_go290
  s_sleep 1
  s_branch L_poll290
L_go290:
  s_xor_b32 s36, s48, 81920
  s_add_u32 m0, s51, 14336
  s_nop 0
  buffer_load_dwordx4 v16, s[44:47], s36 offen offset:0 lds
  s_mov_b32 m0, s41
  v_add_u32 v12, 1, v12
  s_bitcmp1_b32 s81, 0
  s_waitcnt vmcnt(11)
  s_cbranch_scc0 L_w291
  s_waitcnt vmcnt(8)
L_w291:
  buffer_load_dwordx4 v6, s[24:27], s42 offen offset:0 nt lds
  s_bitcmp1_b32 s81, 1
  s_waitcnt vmcnt(11)
  s_cbranch_scc0 L_w292
  s_waitcnt vmcnt(8)
  ds_write_b32 v13, v12
L_w292:
  buffer_load_dwordx4 v7, s[24:27], s42 offen offset:1024 nt lds
  s_add_u32 m0, s51, 14336
  s_nop 0
  buffer_load_dwordx4 v17, s[44:47], s36 offen offset:1024 lds
  s_mov_b32 m0, s41
  s_bitcmp1_b32 s81, 2
  s_waitcnt vmcnt(11)
  s_cbranch_scc0 L_w293
  s_waitcnt vmcnt(8)
L_w293:
  buffer_load_dwordx4 v6, s[24:27], s42 offen offset:2048 nt lds
  s_bitcmp1_b32 s81, 3
  s_waitcnt vmcnt(11)
  ds_write_b32 v13, v12
  s_cbranch_scc0 L_w294
  s_waitcnt vmcnt(8)
L_w294:
  buffer_load_dwordx4 v7, s[24:27], s42 offen offset:3072 nt lds
  s_add_u32 s42, s42, 16384
  s_add_u32 s49, s49, 1
  s_add_u32 s41, s41, 16384
  s_cmp_ge_u32 s41, s53
  s_cselect_b32 s34, s53, 0
  s_sub_u32 s41, s41, s34
  s_sub_u32 s40, s49, s60
  s_cmp_ge_i32 s39, s40
  s_cbranch_scc1 L_go295
  s_mov_b32 s43, 1048576
L_poll295:
  ds_read_b128 v[8:11], v14 offset:0
  s_waitcnt lgkmcnt(0)
  v_min3_u32 v8, v8, v9, v10
  v_min_u32 v8, v8, v11
  s_sub_u32 s43, s43, 1
  v_readfirstlane_b32 s39, v8
  s_cbranch_scc1 L_end
  s_cmp_ge_i32 s39, s40
  s_cbranch_scc1 L_go295
  s_sleep 1
  s_branch L_poll295
L_go295:
  s_xor_b32 s36, s48, 98304
  s_add_u32 m0, s51, 0
  s_nop 0
  buffer_load_dwordx4 v16, s[44:47], s36 offen offset:0 lds
  s_mov_b32 m0, s41
  v_add_u32 v12, 1, v12
  s_bitcmp1_b32 s81, 0
  s_waitcnt vmcnt(11)
  s_cbranch_scc0 L_w296
  s_waitcnt vmcnt(8)
L_w296:
  buffer_load_dwordx4 v4, s[20:23], s42 offen offset:0 nt lds
  s_bitcmp1_b32 s81, 1
  s_waitcnt vmcnt(11)
  s_cbranch_scc0 L_w297
  s_waitcnt vmcnt(8)
  ds_write_b32 v13, v12
L_w297:
  buffer_load_dwordx4 v4, s[20:23], s42 offen offset:1024 nt lds
  s_add_u32 m0, s51, 0
  s_nop 0
  buffer_load_dwordx4 v17, s[44:47], s36 offen offset:1024 lds
  s_mov_b32 m0, s41
  s_bitcmp1_b32 s81, 2
  s_waitcnt vmcnt(11)
  s_cbranch_scc0 L_w298
  s_waitcnt vmcnt(8)
L_w298:
  buffer_load_dwordx4 v5, s[20:23], s42 offen offset:2048 nt lds
  s_bitcmp1_b32 s81, 3
  s_waitcnt vmcnt(11)
  ds_write_b32 v13, v12
  s_cbranch_scc0 L_w299
  s_waitcnt vmcnt(8)
L_w299:
  buffer_load_dwordx4 v5, s[20:23], s42 offen offset:3072 nt lds
  s_add_u32 s49, s49, 1
  s_add_u32 s41, s41, 16384
  s_cmp_ge_u32 s41, s53
  s_cselect_b32 s34, s53, 0
  s_sub_u32 s41, s41, s34
  s_sub_u32 s40, s49, s60
  s_cmp_ge_i32 s39, s40
  s_cbranch_scc1 L_go300
  s_mov_b32 s43, 1048576
L_poll300:
  ds_read_b128 v[8:11], v14 offset:0
  s_waitcnt lgkmcnt(0)
  v_min3_u32 v8, v8, v9, v10
  v_min_u32 v8, v8, v11
  s_sub_u32 s43, s43, 1
  v_readfirstlane_b32 s39, v8
  s_cbranch_scc1 L_end
  s_cmp_ge_i32 s39, s40
  s_cbranch_scc1 L_go300
  s_sleep 1
  s_branch L_poll300
L_go300:
  s_xor_b32 s36, s48, 114688
  s_add_u32 m0, s51, 2048
  s_nop 0
  buffer_load_dwordx4 v16, s[44:47], s36 offen offset:0 lds
  s_mov_b32 m0, s41
  v_add_u32 v12, 1, v12
  s_bitcmp1_b32 s81, 0
  s_waitcnt vmcnt(11)
  s_cbranch_scc0 L_w301
  s_waitcnt vmcnt(8)
L_w301:
  buffer_load_dwordx4 v6, s[24:27], s42 offen offset:0 nt lds
  s_bitcmp1_b32 s81, 1
  s_waitcnt vmcnt(11)
  s_cbranch_scc0 L_w302
  s_waitcnt vmcnt(8)
  ds_write_b32 v13, v12
L_w302:
  buffer_load_dwordx4 v7, s[24:27], s42 offen offset:1024 nt lds
  s_add_u32 m0, s51, 2048
  s_nop 0
  buffer_load_dwordx4 v17, s[44:47], s36 offen offset:1024 lds
  s_mov_b32 m0, s41
  s_bitcmp1_b32 s81, 2
  s_waitcnt vmcnt(11)
  s_cbranch_scc0 L_w303
  s_waitcnt vmcnt(8)
L_w303:
  buffer_load_dwordx4 v6, s[24:27], s42 offen offset:2048 nt lds
  s_bitcmp1_b32 s81, 3
  s_waitcnt vmcnt(11)
  ds_write_b32 v13, v12
  s_cbranch_scc0 L_w304
  s_waitcnt vmcnt(8)
L_w304:
  buffer_load_dwordx4 v7, s[24:27], s42 offen offset:3072 nt lds
  s_add_u32 s42, s42, 16384
  s_add_u32 s49, s49, 1
  s_add_u32 s41, s41, 16384
  s_cmp_ge_u32 s41, s53
  s_cselect_b32 s34, s53, 0
  s_sub_u32 s41, s41, s34
  s_sub_u32 s40, s49, s60
  s_cmp_ge_i32 s39, s40
  s_cbranch_scc1 L_go305
  s_mov_b32 s43, 1048576
L_poll305:
  ds_read_b128 v[8:11], v14 offset:0
  s_waitcnt lgkmcnt(0)
  v_min3_u32 v8, v8, v9, v10
  v_min_u32 v8, v8, v11
  s_sub_u32 s43, s43, 1
  v_readfirstlane_b32 s39, v8
  s_cbranch_scc1 L_end
  s_cmp_ge_i32 s39, s40
  s_cbranch_scc1 L_go305
  s_sleep 1
  s_branch L_poll305
L_go305:
  s_xor_b32 s36, s48, 131072
  s_add_u32 m0, s51, 4096
  s_nop 0
  buffer_load_dwordx4 v16, s[44:47], s36 offen offset:0 lds
  s_mov_b32 m0, s41
  v_add_u32 v12, 1, v12
  s_bitcmp1_b32 s81, 0
  s_waitcnt vmcnt(11)
  s_cbranch_scc0 L_w306
  s_waitcnt vmcnt(8)
L_w306:
  buffer_load_dwordx4 v4, s[20:23], s42 offen offset:0 nt lds
  s_bitcmp1_b32 s81, 1
  s_waitcnt vmcnt(11)
  s_cbranch_scc0 L_w307
  s_waitcnt vmcnt(8)
  ds_write_b32 v13, v12
L_w307:
  buffer_load_dwordx4 v4, s[20:23], s42 offen offset:1024 nt lds
  s_add_u32 m0, s51, 4096
  s_nop 0
  buffer_load_dwordx4 v17, s[44:47], s36 offen offset:1024 lds
  s_mov_b32 m0, s41
  s_bitcmp1_b32 s81, 2
  s_waitcnt vmcnt(11)
  s_cbranch_scc0 L_w308
  s_waitcnt vmcnt(8)
L_w308:
  buffer_load_dwordx4 v5, s[20:23], s42 offen offset:2048 nt lds
  s_bitcmp1_b32 s81, 3
  s_waitcnt vmcnt(11)
  ds_write_b32 v13, v12
  s_cbranch_scc0 L_w309
  s_waitcnt vmcnt(8)
L_w309:
  buffer_load_dwordx4 v5, s[20:23], s42 offen offset:3072 nt lds
  s_add_u32 s49, s49, 1
  s_add_u32 s41, s41, 16384
  s_cmp_ge_u32 s41, s53
  s_cselect_b32 s34, s53, 0
  s_sub_u32 s41, s41, s34
  s_sub_u32 s40, s49, s60
  s_cmp_ge_i32 s39, s40
  s_cbranch_scc1 L_go310
  s_mov_b32 s43, 1048576
L_poll310:
  ds_read_b128 v[8:11], v14 offset:0
  s_waitcnt lgkmcnt(0)
  v_min3_u32 v8, v8, v9, v10
  v_min_u32 v8, v8, v11
  s_sub_u32 s43, s43, 1
  v_readfirstlane_b32 s39, v8
  s_cbranch_scc1 L_end
  s_cmp_ge_i32 s39, s40
  s_cbranch_scc1 L_go310
  s_sleep 1
  s_branch L_poll310
L_go310:
  s_xor_b32 s36, s48, 147456
  s_add_u32 m0, s51, 6144
  s_nop 0
  buffer_load_dwordx4 v16, s[44:47], s36 offen offset:0 lds
  s_mov_b32 m0, s41
  v_add_u32 v12, 1, v12
  s_bitcmp1_b32 s81, 0
  s_waitcnt vmcnt(11)
  s_cbranch_scc0 L_w311
  s_waitcnt vmcnt(8)
L_w311:
  buffer_load_dwordx4 v6, s[24:27], s42 offen offset:0 nt lds
  s_bitcmp1_b32 s81, 1
  s_waitcnt vmcnt(11)
  s_cbranch_scc0 L_w312
  s_waitcnt vmcnt(8)
  ds_write_b32 v13, v12
L_w312:
  buffer_load_dwordx4 v7, s[24:27], s42 offen offset:1024 nt lds
  s_add_u32 m0, s51, 6144
  s_nop 0
  buffer_load_dwordx4 v17, s[44:47], s36 offen offset:1024 lds
  s_mov_b32 m0, s41
  s_bitcmp1_b32 s81, 2
  s_waitcnt vmcnt(11)
  s_cbranch_scc0 L_w313
  s_waitcnt vmcnt(8)
L_w313:
  buffer_load_dwordx4 v6, s[24:27], s42 offen offset:2048 nt lds
  s_bitcmp1_b32 s81, 3
  s_waitcnt vmcnt(11)
  ds_write_b32 v13, v12
  s_cbranch_scc0 L_w314
  s_waitcnt vmcnt(8)
L_w314:
  buffer_load_dwordx4 v7, s[24:27], s42 offen offset:3072 nt lds
  s_add_u32 s42, s42, 16384
  s_add_u32 s49, s49, 1
  s_add_u32 s41, s41, 16384
  s_cmp_ge_u32 s41, s53
  s_cselect_b32 s34, s53, 0
  s_sub_u32 s41, s41, s34
  s_sub_u32 s40, s49, s60
  s_cmp_ge_i32 s39, s40
  s_cbranch_scc1 L_go315
  s_mov_b32 s43, 1048576
L_poll315:
  ds_read_b128 v[8:11], v14 offset:0
  s_waitcnt lgkmcnt(0)
  v_min3_u32 v8, v8, v9, v10
  v_min_u32 v8, v8, v11
  s_sub_u32 s43, s43, 1
  v_readfirstlane_b32 s39, v8
  s_cbranch_scc1 L_end
  s_cmp_ge_i32 s39, s40
  s_cbranch_scc1 L_go315
  s_sleep 1
  s_branch L_poll315
L_go315:
  s_xor_b32 s36, s48, 163840
  s_add_u32 m0, s51, 8192
  s_nop 0
  buffer_load_dwordx4 v16, s[44:47], s36 offen offset:0 lds
  s_mov_b32 m0, s41
  v_add_u32 v12, 1, v12
  s_bitcmp1_b32 s81, 0
  s_waitcnt vmcnt(11)
  s_cbranch_scc0 L_w316
  s_waitcnt vmcnt(8)
L_w316:
  buffer_load_dwordx4 v4, s[20:23], s42 offen offset:0 nt lds
  s_bitcmp1_b32 s81, 1
  s_waitcnt vmcnt(11)
  s_cbranch_scc0 L_w317
  s_waitcnt vmcnt(8)
  ds_write_b32 v13, v12
L_w317:
  buffer_load_dwordx4 v4, s[20:23], s42 offen offset:1024 nt lds
  s_add_u32 m0, s51, 8192
  s_nop 0
  buffer_load_dwordx4 v17, s[44:47], s36 offen offset:1024 lds
  s_mov_b32 m0, s41
  s_bitcmp1_b32 s81, 2
  s_waitcnt vmcnt(11)
  s_cbranch_scc0 L_w318
  s_waitcnt vmcnt(8)
L_w318:
  buffer_load_dwordx4 v5, s[20:23], s42 offen offset:2048 nt lds
  s_bitcmp1_b32 s81, 3
  s_waitcnt vmcnt(11)
  ds_write_b32 v13, v12
  s_cbranch_scc0 L_w319
  s_waitcnt vmcnt(8)
L_w319:
  buffer_load_dwordx4 v5, s[20:23], s42 offen offset:3072 nt lds
  s_add_u32 s49, s49, 1
  s_add_u32 s41, s41, 16384
  s_cmp_ge_u32 s41, s53
  s_cselect_b32 s34, s53, 0
  s_sub_u32 s41, s41, s34
  s_sub_u32 s40, s49, s60
  s_cmp_ge_i32 s39, s40
  s_cbranch_scc1 L_go320
  s_mov_b32 s43, 1048576
L_poll320:
  ds_read_b128 v[8:11], v14 offset:0
  s_waitcnt lgkmcnt(0)
  v_min3_u32 v8, v8, v9, v10
  v_min_u32 v8, v8, v11
  s_sub_u32 s43, s43, 1
  v_readfirstlane_b32 s39, v8
  s_cbranch_scc1 L_end
  s_cmp_ge_i32 s39, s40
  s_cbranch_scc1 L_go320
  s_sleep 1
  s_branch L_poll320
L_go320:
  s_xor_b32 s36, s48, 180224
  s_add_u32 m0, s51, 10240
  s_nop 0
  buffer_load_dwordx4 v16, s[44:47], s36 offen offset:0 lds
  s_mov_b32 m0, s41
  v_add_u32 v12, 1, v12
  s_bitcmp1_b32 s81, 0
  s_waitcnt vmcnt(11)
  s_cbranch_scc0 L_w321
  s_waitcnt vmcnt(8)
L_w321:
  buffer_load_dwordx4 v6, s[24:27], s42 offen offset:0 nt lds
  s_bitcmp1_b32 s81, 1
  s_waitcnt vmcnt(11)
  s_cbranch_scc0 L_w322
  s_waitcnt vmcnt(8)
  ds_write_b32 v13, v12
L_w322:
  buffer_load_dwordx4 v7, s[24:27], s42 offen offset:1024 nt lds
  s_add_u32 m0, s51, 10240
  s_nop 0
  buffer_load_dwordx4 v17, s[44:47], s36 offen offset:1024 lds
  s_mov_b32 m0, s41
  s_bitcmp1_b32 s81, 2
  s_waitcnt vmcnt(11)
  s_cbranch_scc0 L_w323
  s_waitcnt vmcnt(8)
L_w323:
  buffer_load_dwordx4 v6, s[24:27], s42 offen offset:2048 nt lds
  s_bitcmp1_b32 s81, 3
  s_waitcnt vmcnt(11)
  ds_write_b32 v13, v12
  s_cbranch_scc0 L_w324
  s_waitcnt vmcnt(8)
L_w324:
  buffer_load_dwordx4 v7, s[24:27], s42 offen offset:3072 nt lds
  s_add_u32 s42, s42, 16384
  s_add_u32 s49, s49, 1
  s_add_u32 s41, s41, 16384
  s_cmp_ge_u32 s41, s53
  s_cselect_b32 s34, s53, 0
  s_sub_u32 s41, s41, s34
  s_sub_u32 s40, s49, s60
  s_cmp_ge_i32 s39, s40
  s_cbranch_scc1 L_go325
  s_mov_b32 s43, 1048576
L_poll325:
  ds_read_b128 v[8:11], v14 offset:0
  s_waitcnt lgkmcnt(0)
  v_min3_u32 v8, v8, v9, v10
  v_min_u32 v8, v8, v11
  s_sub_u32 s43, s43, 1
  v_readfirstlane_b32 s39, v8
  s_cbranch_scc1 L_end
  s_cmp_ge_i32 s39, s40
  s_cbranch_scc1 L_go325
  s_sleep 1
  s_branch L_poll325
L_go325:
  s_xor_b32 s36, s48, 196608
  s_add_u32 m0, s51, 12288
  s_nop 0
  buffer_load_dwordx4 v16, s[44:47], s36 offen offset:0 lds
  s_mov_b32 m0, s41
  v_add_u32 v12, 1, v12
  s_bitcmp1_b32 s81, 0
  s_waitcnt vmcnt(11)
  s_cbranch_scc0 L_w326
  s_waitcnt vmcnt(8)
L_w326:
  buffer_load_dwordx4 v4, s[20:23], s42 offen offset:0 nt lds
  s_bitcmp1_b32 s81, 1
  s_waitcnt vmcnt(11)
  s_cbranch_scc0 L_w327
  s_waitcnt vmcnt(8)
  ds_write_b32 v13, v12
L_w327:
  buffer_load_dwordx4 v4, s[20:23], s42 offen offset:1024 nt lds
  s_add_u32 m0, s51, 12288
  s_nop 0
  buffer_load_dwordx4 v17, s[44:47], s36 offen offset:1024 lds
  s_mov_b32 m0, s41
  s_bitcmp1_b32 s81, 2
  s_waitcnt vmcnt(11)
  s_cbranch_scc0 L_w328
  s_waitcnt vmcnt(8)
L_w328:
  buffer_load_dwordx4 v5, s[20:23], s42 offen offset:2048 nt lds
  s_bitcmp1_b32 s81, 3
  s_waitcnt vmcnt(11)
  ds_write_b32 v13, v12
  s_cbranch_scc0 L_w329
  s_waitcnt vmcnt(8)
L_w329:
  buffer_load_dwordx4 v5, s[20:23], s42 offen offset:3072 nt lds
  s_add_u32 s49, s49, 1
  s_add_u32 s41, s41, 16384
  s_cmp_ge_u32 s41, s53
  s_cselect_b32 s34, s53, 0
  s_sub_u32 s41, s41, s34
  s_sub_u32 s40, s49, s60
  s_cmp_ge_i32 s39, s40
  s_cbranch_scc1 L_go330
  s_mov_b32 s43, 1048576
L_poll330:
  ds_read_b128 v[8:11], v14 offset:0
  s_waitcnt lgkmcnt(0)
  v_min3_u32 v8, v8, v9, v10
  v_min_u32 v8, v8, v11
  s_sub_u32 s43, s43, 1
  v_readfirstlane_b32 s39, v8
  s_cbranch_scc1 L_end
  s_cmp_ge_i32 s39, s40
  s_cbranch_scc1 L_go330
  s_sleep 1
  s_branch L_poll330
L_go330:
  s_xor_b32 s36, s48, 212992
  s_add_u32 m0, s51, 14336
  s_nop 0
  buffer_load_dwordx4 v16, s[44:47], s36 offen offset:0 lds
  s_mov_b32 m0, s41
  v_add_u32 v12, 1, v12
  s_bitcmp1_b32 s81, 0
  s_waitcnt vmcnt(11)
  s_cbranch_scc0 L_w331
  s_waitcnt vmcnt(8)
L_w331:
  buffer_load_dwordx4 v6, s[24:27], s42 offen offset:0 nt lds
  s_bitcmp1_b32 s81, 1
  s_waitcnt vmcnt(11)
  s_cbranch_scc0 L_w332
  s_waitcnt vmcnt(8)
  ds_write_b32 v13, v12
L_w332:
  buffer_load_dwordx4 v7, s[24:27], s42 offen offset:1024 nt lds
  s_add_u32 m0, s51, 14336
  s_nop 0
  buffer_load_dwordx4 v17, s[44:47], s36 offen offset:1024 lds
  s_mov_b32 m0, s41
  s_bitcmp1_b32 s81, 2
  s_waitcnt vmcnt(11)
  s_cbranch_scc0 L_w333
  s_waitcnt vmcnt(8)
L_w333:
  buffer_load_dwordx4 v6, s[24:27], s42 offen offset:2048 nt lds
  s_bitcmp1_b32 s81, 3
  s_waitcnt vmcnt(11)
  ds_write_b32 v13, v12
  s_cbranch_scc0 L_w334
  s_waitcnt vmcnt(8)
L_w334:
  buffer_load_dwordx4 v7, s[24:27], s42 offen offset:3072 nt lds
  s_add_u32 s42, s42, 16384
  s_add_u32 s49, s49, 1
  s_add_u32 s41, s41, 16384
  s_cmp_ge_u32 s41, s53
  s_cselect_b32 s34, s53, 0
  s_sub_u32 s41, s41, s34
  s_sub_u32 s40, s49, s60
  s_cmp_ge_i32 s39, s40
  s_cbranch_scc1 L_go335
  s_mov_b32 s43, 1048576
L_poll335:
  ds_read_b128 v[8:11], v14 offset:0
  s_waitcnt lgkmcnt(0)
  v_min3_u32 v8, v8, v9, v10
  v_min_u32 v8, v8, v11
  s_sub_u32 s43, s43, 1
  v_readfirstlane_b32 s39, v8
  s_cbranch_scc1 L_end
  s_cmp_ge_i32 s39, s40
  s_cbranch_scc1 L_go335
  s_sleep 1
  s_branch L_poll335
L_go335:
  s_xor_b32 s36, s48, 229376
  s_add_u32 m0, s51, 0
  s_nop 0
  buffer_load_dwordx4 v16, s[44:47], s36 offen offset:0 lds
  s_mov_b32 m0, s41
  v_add_u32 v12, 1, v12
  s_bitcmp1_b32 s81, 0
  s_waitcnt vmcnt(11)
  s_cbranch_scc0 L_w336
  s_waitcnt vmcnt(8)
L_w336:
  buffer_load_dwordx4 v4, s[20:23], s42 offen offset:0 nt lds
  s_bitcmp1_b32 s81, 1
  s_waitcnt vmcnt(11)
  s_cbranch_scc0 L_w337
  s_waitcnt vmcnt(8)
  ds_write_b32 v13, v12
L_w337:
  buffer_load_dwordx4 v4, s[20:23], s42 offen offset:1024 nt lds
  s_add_u32 m0, s51, 0
  s_nop 0
  buffer_load_dwordx4 v17, s[44:47], s36 offen offset:1024 lds
  s_mov_b32 m0, s41
  s_bitcmp1_b32 s81, 2
  s_waitcnt vmcnt(11)
  s_cbranch_scc0 L_w338
  s_waitcnt vmcnt(8)
L_w338:
  buffer_load_dwordx4 v5, s[20:23], s42 offen offset:2048 nt lds
  s_bitcmp1_b32 s81, 3
  s_waitcnt vmcnt(11)
  ds_write_b32 v13, v12
  s_cbranch_scc0 L_w339
  s_waitcnt vmcnt(8)
L_w339:
  buffer_load_dwordx4 v5, s[20:23], s42 offen offset:3072 nt lds
  s_add_u32 s49, s49, 1
  s_add_u32 s41, s41, 16384
  s_cmp_ge_u32 s41, s53
  s_cselect_b32 s34, s53, 0
  s_sub_u32 s41, s41, s34
  s_sub_u32 s40, s49, s60
  s_cmp_ge_i32 s39, s40
  s_cbranch_scc1 L_go340
  s_mov_b32 s43, 1048576
L_poll340:
  ds_read_b128 v[8:11], v14 offset:0
  s_waitcnt lgkmcnt(0)
  v_min3_u32 v8, v8, v9, v10
  v_min_u32 v8, v8, v11
  s_sub_u32 s43, s43, 1
  v_readfirstlane_b32 s39, v8
  s_cbranch_scc1 L_end
  s_cmp_ge_i32 s39, s40
  s_cbranch_scc1 L_go340
  s_sleep 1
  s_branch L_poll340
L_go340:
  s_xor_b32 s36, s48, 245760
  s_add_u32 m0, s51, 2048
  s_nop 0
  buffer_load_dwordx4 v16, s[44:47], s36 offen offset:0 lds
  s_mov_b32 m0, s41
  v_add_u32 v12, 1, v12
  s_bitcmp1_b32 s81, 0
  s_waitcnt vmcnt(11)
  s_cbranch_scc0 L_w341
  s_waitcnt vmcnt(8)
L_w341:
  buffer_load_dwordx4 v6, s[24:27], s42 offen offset:0 nt lds
  s_bitcmp1_b32 s81, 1
  s_waitcnt vmcnt(11)
  s_cbranch_scc0 L_w342
  s_waitcnt vmcnt(8)
  ds_write_b32 v13, v12
L_w342:
  buffer_load_dwordx4 v7, s[24:27], s42 offen offset:1024 nt lds
  s_add_u32 m0, s51, 2048
  s_nop 0
  buffer_load_dwordx4 v17, s[44:47], s36 offen offset:1024 lds
  s_mov_b32 m0, s41
  s_bitcmp1_b32 s81, 2
  s_waitcnt vmcnt(11)
  s_cbranch_scc0 L_w343
  s_waitcnt vmcnt(8)
L_w343:
  buffer_load_dwordx4 v6, s[24:27], s42 offen offset:2048 nt lds
  s_bitcmp1_b32 s81, 3
  s_waitcnt vmcnt(11)
  ds_write_b32 v13, v12
  s_cbranch_scc0 L_w344
  s_waitcnt vmcnt(8)
L_w344:
  buffer_load_dwordx4 v7, s[24:27], s42 offen offset:3072 nt lds
  s_add_u32 s42, s42, 16384
  s_add_u32 s49, s49, 1
  s_add_u32 s41, s41, 16384
  s_cmp_ge_u32 s41, s53
  s_cselect_b32 s34, s53, 0
  s_sub_u32 s41, s41, s34
  s_sub_u32 s40, s49, s60
  s_cmp_ge_i32 s39, s40
  s_cbranch_scc1 L_go345
  s_mov_b32 s43, 1048576
L_poll345:
  ds_read_b128 v[8:11], v14 offset:0
  s_waitcnt lgkmcnt(0)
  v_min3_u32 v8, v8, v9, v10
  v_min_u32 v8, v8, v11
  s_sub_u32 s43, s43, 1
  v_readfirstlane_b32 s39, v8
  s_cbranch_scc1 L_end
  s_cmp_ge_i32 s39, s40
  s_cbranch_scc1 L_go345
  s_sleep 1
  s_branch L_poll345
L_go345:
  s_xor_b32 s36, s48, 262144
  s_add_u32 m0, s51, 4096
  s_nop 0
  buffer_load_dwordx4 v16, s[44:47], s36 offen offset:0 lds
  s_mov_b32 m0, s41
  v_add_u32 v12, 1, v12
  s_bitcmp1_b32 s81, 0
  s_waitcnt vmcnt(11)
  s_cbranch_scc0 L_w346
  s_waitcnt vmcnt(8)
L_w346:
  buffer_load_dwordx4 v4, s[20:23], s42 offen offset:0 nt lds
  s_bitcmp1_b32 s81, 1
  s_waitcnt vmcnt(11)
  s_cbranch_scc0 L_w347
  s_waitcnt vmcnt(8)
  ds_write_b32 v13, v12
L_w347:
  buffer_load_dwordx4 v4, s[20:23], s42 offen offset:1024 nt lds
  s_add_u32 m0, s51, 4096
  s_nop 0
  buffer_load_dwordx4 v17, s[44:47], s36 offen offset:1024 lds
  s_mov_b32 m0, s41
  s_bitcmp1_b32 s81, 2
  s_waitcnt vmcnt(11)
  s_cbranch_scc0 L_w348
  s_waitcnt vmcnt(8)
L_w348:
  buffer_load_dwordx4 v5, s[20:23], s42 offen offset:2048 nt lds
  s_bitcmp1_b32 s81, 3
  s_waitcnt vmcnt(11)
  ds_write_b32 v13, v12
  s_cbranch_scc0 L_w349
  s_waitcnt vmcnt(8)
L_w349:
  buffer_load_dwordx4 v5, s[20:23], s42 offen offset:3072 nt lds
  s_add_u32 s49, s49, 1
  s_add_u32 s41, s41, 16384
  s_cmp_ge_u32 s41, s53
  s_cselect_b32 s34, s53, 0
  s_sub_u32 s41, s41, s34
  s_sub_u32 s40, s49, s60
  s_cmp_ge_i32 s39, s40
  s_cbranch_scc1 L_go350
  s_mov_b32 s43, 1048576
L_poll350:
  ds_read_b128 v[8:11], v14 offset:0
  s_waitcnt lgkmcnt(0)
  v_min3_u32 v8, v8, v9, v10
  v_min_u32 v8, v8, v11
  s_sub_u32 s43, s43, 1
  v_readfirstlane_b32 s39, v8
  s_cbranch_scc1 L_end
  s_cmp_ge_i32 s39, s40
  s_cbranch_scc1 L_go350
  s_sleep 1
  s_branch L_poll350
L_go350:
  s_xor_b32 s36, s48, 278528
  s_add_u32 m0, s51, 6144
  s_nop 0
  buffer_load_dwordx4 v16, s[44:47], s36 offen offset:0 lds
  s_mov_b32 m0, s41
  v_add_u32 v12, 1, v12
  s_bitcmp1_b32 s81, 0
  s_waitcnt vmcnt(11)
  s_cbranch_scc0 L_w351
  s_waitcnt vmcnt(8)
L_w351:
  buffer_load_dwordx4 v6, s[24:27], s42 offen offset:0 nt lds
  s_bitcmp1_b32 s81, 1
  s_waitcnt vmcnt(11)
  s_cbranch_scc0 L_w352
  s_waitcnt vmcnt(8)
  ds_write_b32 v13, v12
L_w352:
  buffer_load_dwordx4 v7, s[24:27], s42 offen offset:1024 nt lds
  s_add_u32 m0, s51, 6144
  s_nop 0
  buffer_load_dwordx4 v17, s[44:47], s36 offen offset:1024 lds
  s_mov_b32 m0, s41
  s_bitcmp1_b32 s81, 2
  s_waitcnt vmcnt(11)
  s_cbranch_scc0 L_w353
  s_waitcnt vmcnt(8)
L_w353:
  buffer_load_dwordx4 v6, s[24:27], s42 offen offset:2048 nt lds
  s_bitcmp1_b32 s81, 3
  s_waitcnt vmcnt(11)
  ds_write_b32 v13, v12
  s_cbranch_scc0 L_w354
  s_waitcnt vmcnt(8)
L_w354:
  buffer_load_dwordx4 v7, s[24:27], s42 offen offset:3072 nt lds
  s_add_u32 s42, s42, 16384
  s_add_u32 s49, s49, 1
  s_add_u32 s41, s41, 16384
  s_cmp_ge_u32 s41, s53
  s_cselect_b32 s34, s53, 0
  s_sub_u32 s41, s41, s34
  s_sub_u32 s40, s49, s60
  s_cmp_ge_i32 s39, s40
  s_cbranch_scc1 L_go355
  s_mov_b32 s43, 1048576
L_poll355:
  ds_read_b128 v[8:11], v14 offset:0
  s_waitcnt lgkmcnt(0)
  v_min3_u32 v8, v8, v9, v10
  v_min_u32 v8, v8, v11
  s_sub_u32 s43, s43, 1
  v_readfirstlane_b32 s39, v8
  s_cbranch_scc1 L_end
  s_cmp_ge_i32 s39, s40
  s_cbranch_scc1 L_go355
  s_sleep 1
  s_branch L_poll355
L_go355:
  s_xor_b32 s36, s48, 294912
  s_add_u32 m0, s51, 8192
  s_nop 0
  buffer_load_dwordx4 v16, s[44:47], s36 offen offset:0 lds
  s_mov_b32 m0, s41
  v_add_u32 v12, 1, v12
  s_bitcmp1_b32 s81, 0
  s_waitcnt vmcnt(11)
  s_cbranch_scc0 L_w356
  s_waitcnt vmcnt(8)
L_w356:
  buffer_load_dwordx4 v4, s[20:23], s42 offen offset:0 nt lds
  s_bitcmp1_b32 s81, 1
  s_waitcnt vmcnt(11)
  s_cbranch_scc0 L_w357
  s_waitcnt vmcnt(8)
  ds_write_b32 v13, v12
L_w357:
  buffer_load_dwordx4 v4, s[20:23], s42 offen offset:1024 nt lds
  s_add_u32 m0, s51, 8192
  s_nop 0
  buffer_load_dwordx4 v17, s[44:47], s36 offen offset:1024 lds
  s_mov_b32 m0, s41
  s_bitcmp1_b32 s81, 2
  s_waitcnt vmcnt(11)
  s_cbranch_scc0 L_w358
  s_waitcnt vmcnt(8)
L_w358:
  buffer_load_dwordx4 v5, s[20:23], s42 offen offset:2048 nt lds
  s_bitcmp1_b32 s81, 3
  s_waitcnt vmcnt(11)
  ds_write_b32 v13, v12
  s_cbranch_scc0 L_w359
  s_waitcnt vmcnt(8)
L_w359:
  buffer_load_dwordx4 v5, s[20:23], s42 offen offset:3072 nt lds
  s_add_u32 s49, s49, 1
  s_add_u32 s41, s41, 16384
  s_cmp_ge_u32 s41, s53
  s_cselect_b32 s34, s53, 0
  s_sub_u32 s41, s41, s34
  s_sub_u32 s40, s49, s60
  s_cmp_ge_i32 s39, s40
  s_cbranch_scc1 L_go360
  s_mov_b32 s43, 1048576
L_poll360:
  ds_read_b128 v[8:11], v14 offset:0
  s_waitcnt lgkmcnt(0)
  v_min3_u32 v8, v8, v9, v10
  v_min_u32 v8, v8, v11
  s_sub_u32 s43, s43, 1
  v_readfirstlane_b32 s39, v8
  s_cbranch_scc1 L_end
  s_cmp_ge_i32 s39, s40
  s_cbranch_scc1 L_go360
  s_sleep 1
  s_branch L_poll360
L_go360:
  s_xor_b32 s36, s48, 311296
  s_add_u32 m0, s51, 10240
  s_nop 0
  buffer_load_dwordx4 v16, s[44:47], s36 offen offset:0 lds
  s_mov_b32 m0, s41
  v_add_u32 v12, 1, v12
  s_bitcmp1_b32 s81, 0
  s_waitcnt vmcnt(11)
  s_cbranch_scc0 L_w361
  s_waitcnt vmcnt(8)
L_w361:
  buffer_load_dwordx4 v6, s[24:27], s42 offen offset:0 nt lds
  s_bitcmp1_b32 s81, 1
  s_waitcnt vmcnt(11)
  s_cbranch_scc0 L_w362
  s_waitcnt vmcnt(8)
  ds_write_b32 v13, v12
L_w362:
  buffer_load_dwordx4 v7, s[24:27], s42 offen offset:1024 nt lds
  s_add_u32 m0, s51, 10240
  s_nop 0
  buffer_load_dwordx4 v17, s[44:47], s36 offen offset:1024 lds
  s_mov_b32 m0, s41
  s_bitcmp1_b32 s81, 2
  s_waitcnt vmcnt(11)
  s_cbranch_scc0 L_w363
  s_waitcnt vmcnt(8)
L_w363:
  buffer_load_dwordx4 v6, s[24:27], s42 offen offset:2048 nt lds
  s_bitcmp1_b32 s81, 3
  s_waitcnt vmcnt(11)
  ds_write_b32 v13, v12
  s_cbranch_scc0 L_w364
  s_waitcnt vmcnt(8)
L_w364:
  buffer_load_dwordx4 v7, s[24:27], s42 offen offset:3072 nt lds
  s_add_u32 s42, s42, 16384
  s_add_u32 s49, s49, 1
  s_add_u32 s41, s41, 16384
  s_cmp_ge_u32 s41, s53
  s_cselect_b32 s34, s53, 0
  s_sub_u32 s41, s41, s34
  s_sub_u32 s40, s49, s60
  s_cmp_ge_i32 s39, s40
  s_cbranch_scc1 L_go365
  s_mov_b32 s43, 1048576
L_poll365:
  ds_read_b128 v[8:11], v14 offset:0
  s_waitcnt lgkmcnt(0)
  v_min3_u32 v8, v8, v9, v10
  v_min_u32 v8, v8, v11
  s_sub_u32 s43, s43, 1
  v_readfirstlane_b32 s39, v8
  s_cbranch_scc1 L_end
  s_cmp_ge_i32 s39, s40
  s_cbranch_scc1 L_go365
  s_sleep 1
  s_branch L_poll365
L_go365:
  s_xor_b32 s36, s48, 327680
  s_add_u32 m0, s51, 12288
  s_nop 0
  buffer_load_dwordx4 v16, s[44:47], s36 offen offset:0 lds
  s_mov_b32 m0, s41
  v_add_u32 v12, 1, v12
  s_bitcmp1_b32 s81, 0
  s_waitcnt vmcnt(11)
  s_cbranch_scc0 L_w366
  s_waitcnt vmcnt(8)
L_w366:
  buffer_load_dwordx4 v4, s[20:23], s42 offen offset:0 nt lds
  s_bitcmp1_b32 s81, 1
  s_waitcnt vmcnt(11)
  s_cbranch_scc0 L_w367
  s_waitcnt vmcnt(8)
  ds_write_b32 v13, v12
L_w367:
  buffer_load_dwordx4 v4, s[20:23], s42 offen offset:1024 nt lds
  s_add_u32 m0, s51, 12288
  s_nop 0
  buffer_load_dwordx4 v17, s[44:47], s36 offen offset:1024 lds
  s_mov_b32 m0, s41
  s_bitcmp1_b32 s81, 2
  s_waitcnt vmcnt(11)
  s_cbranch_scc0 L_w368
  s_waitcnt vmcnt(8)
L_w368:
  buffer_load_dwordx4 v5, s[20:23], s42 offen offset:2048 nt lds
  s_bitcmp1_b32 s81, 3
  s_waitcnt vmcnt(11)
  ds_write_b32 v13, v12
  s_cbranch_scc0 L_w369
  s_waitcnt vmcnt(8)
L_w369:
  buffer_load_dwordx4 v5, s[20:23], s42 offen offset:3072 nt lds
  s_add_u32 s49, s49, 1
  s_add_u32 s41, s41, 16384
  s_cmp_ge_u32 s41, s53
  s_cselect_b32 s34, s53, 0
  s_sub_u32 s41, s41, s34
  s_sub_u32 s40, s49, s60
  s_cmp_ge_i32 s39, s40
  s_cbranch_scc1 L_go370
  s_mov_b32 s43, 1048576
L_poll370:
  ds_read_b128 v[8:11], v14 offset:0
  s_waitcnt lgkmcnt(0)
  v_min3_u32 v8, v8, v9, v10
  v_min_u32 v8, v8, v11
  s_sub_u32 s43, s43, 1
  v_readfirstlane_b32 s39, v8
  s_cbranch_scc1 L_end
  s_cmp_ge_i32 s39, s40
  s_cbranch_scc1 L_go370
  s_sleep 1
  s_branch L_poll370
L_go370:
  s_xor_b32 s36, s48, 344064
  s_add_u32 m0, s51, 14336
  s_nop 0
  buffer_load_dwordx4 v16, s[44:47], s36 offen offset:0 lds
  s_mov_b32 m0, s41
  v_add_u32 v12, 1, v12
  s_bitcmp1_b32 s81, 0
  s_waitcnt vmcnt(11)
  s_cbranch_scc0 L_w371
  s_waitcnt vmcnt(8)
L_w371:
  buffer_load_dwordx4 v6, s[24:27], s42 offen offset:0 nt lds
  s_bitcmp1_b32 s81, 1
  s_waitcnt vmcnt(11)
  s_cbranch_scc0 L_w372
  s_waitcnt vmcnt(8)
  ds_write_b32 v13, v12
L_w372:
  buffer_load_dwordx4 v7, s[24:27], s42 offen offset:1024 nt lds
  s_add_u32 m0, s51, 14336
  s_nop 0
  buffer_load_dwordx4 v17, s[44:47], s36 offen offset:1024 lds
  s_mov_b32 m0, s41
  s_bitcmp1_b32 s81, 2
  s_waitcnt vmcnt(11)
  s_cbranch_scc0 L_w373
  s_waitcnt vmcnt(8)
L_w373:
  buffer_load_dwordx4 v6, s[24:27], s42 offen offset:2048 nt lds
  s_bitcmp1_b32 s81, 3
  s_waitcnt vmcnt(11)
  ds_write_b32 v13, v12
  s_cbranch_scc0 L_w374
  s_waitcnt vmcnt(8)
L_w374:
  buffer_load_dwordx4 v7, s[24:27], s42 offen offset:3072 nt lds
  s_add_u32 s42, s42, 16384
  s_add_u32 s49, s49, 1
  s_add_u32 s41, s41, 16384
  s_cmp_ge_u32 s41, s53
  s_cselect_b32 s34, s53, 0
  s_sub_u32 s41, s41, s34
  s_sub_u32 s40, s49, s60
  s_cmp_ge_i32 s39, s40
  s_cbranch_scc1 L_go375
  s_mov_b32 s43, 1048576
L_poll375:
  ds_read_b128 v[8:11], v14 offset:0
  s_waitcnt lgkmcnt(0)
  v_min3_u32 v8, v8, v9, v10
  v_min_u32 v8, v8, v11
  s_sub_u32 s43, s43, 1
  v_readfirstlane_b32 s39, v8
  s_cbranch_scc1 L_end
  s_cmp_ge_i32 s39, s40
  s_cbranch_scc1 L_go375
  s_sleep 1
  s_branch L_poll375
L_go375:
  s_mov_b32 m0, s41
  v_add_u32 v12, 1, v12
  s_bitcmp1_b32 s81, 0
  s_waitcnt vmcnt(10)
  s_cbranch_scc0 L_w376
  s_waitcnt vmcnt(7)
L_w376:
  buffer_load_dwordx4 v4, s[20:23], s42 offen offset:0 nt lds
  s_bitcmp1_b32 s81, 1
  s_waitcnt vmcnt(10)
  s_cbranch_scc0 L_w377
  s_waitcnt vmcnt(7)
  ds_write_b32 v13, v12
L_w377:
  buffer_load_dwordx4 v4, s[20:23], s42 offen offset:1024 nt lds
  s_bitcmp1_b32 s81, 2
  s_waitcnt vmcnt(9)
  s_cbranch_scc0 L_w378
  s_waitcnt vmcnt(6)
L_w378:
  buffer_load_dwordx4 v5, s[20:23], s42 offen offset:2048 nt lds
  s_bitcmp1_b32 s81, 3
  s_waitcnt vmcnt(9)
  ds_write_b32 v13, v12
  s_cbranch_scc0 L_w379
  s_waitcnt vmcnt(6)
L_w379:
  buffer_load_dwordx4 v5, s[20:23], s42 offen offset:3072 nt lds
  s_add_u32 s49, s49, 1
  s_add_u32 s41, s41, 16384
  s_cmp_ge_u32 s41, s53
  s_cselect_b32 s34, s53, 0
  s_sub_u32 s41, s41, s34
  s_sub_u32 s40, s49, s60
  s_cmp_ge_i32 s39, s40
  s_cbranch_scc1 L_go380
  s_mov_b32 s43, 1048576
L_poll380:
  ds_read_b128 v[8:11], v14 offset:0
  s_waitcnt lgkmcnt(0)
  v_min3_u32 v8, v8, v9, v10
  v_min_u32 v8, v8, v11
  s_sub_u32 s43, s43, 1
  v_readfirstlane_b32 s39, v8
  s_cbranch_scc1 L_end
  s_cmp_ge_i32 s39, s40
  s_cbranch_scc1 L_go380
  s_sleep 1
  s_branch L_poll380
L_go380:
  s_mov_b32 m0, s41
  v_add_u32 v12, 1, v12
  s_bitcmp1_b32 s81, 0
  s_waitcnt vmcnt(8)
  s_cbranch_scc0 L_w381
  s_waitcnt vmcnt(5)
L_w381:
  buffer_load_dwordx4 v6, s[24:27], s42 offen offset:0 nt lds
  s_bitcmp1_b32 s81, 1
  s_waitcnt vmcnt(8)
  s_cbranch_scc0 L_w382
  s_waitcnt vmcnt(5)
  ds_write_b32 v13, v12
L_w382:
  buffer_load_dwordx4 v7, s[24:27], s42 offen offset:1024 nt lds
  s_bitcmp1_b32 s81, 2
  s_waitcnt vmcnt(7)
  s_cbranch_scc0 L_w383
  s_waitcnt vmcnt(5)
L_w383:
  buffer_load_dwordx4 v6, s[24:27], s42 offen offset:2048 nt lds
  s_bitcmp1_b32 s81, 3
  s_waitcnt vmcnt(7)
  ds_write_b32 v13, v12
  s_cbranch_scc0 L_w384
  s_waitcnt vmcnt(5)
L_w384:
  buffer_load_dwordx4 v7, s[24:27], s42 offen offset:3072 nt lds
  s_add_u32 s42, s42, 16384
  s_add_u32 s49, s49, 1
  s_add_u32 s41, s41, 16384
  s_cmp_ge_u32 s41, s53
  s_cselect_b32 s34, s53, 0
  s_sub_u32 s41, s41, s34
  s_sub_u32 s40, s49, s60
  s_cmp_ge_i32 s39, s40
  s_cbranch_scc1 L_go385
  s_mov_b32 s43, 1048576
L_poll385:
  ds_read_b128 v[8:11], v14 offset:0
  s_waitcnt lgkmcnt(0)
  v_min3_u32 v8, v8, v9, v10
  v_min_u32 v8, v8, v11
  s_sub_u32 s43, s43, 1
  v_readfirstlane_b32 s39, v8
  s_cbranch_scc1 L_end
  s_cmp_ge_i32 s39, s40
  s_cbranch_scc1 L_go385
  s_sleep 1
  s_branch L_poll385
L_go385:
  s_mov_b32 m0, s41
  v_add_u32 v12, 1, v12
  s_bitcmp1_b32 s81, 0
  s_waitcnt vmcnt(7)
  s_cbranch_scc0 L_w386
  s_waitcnt vmcnt(5)
L_w386:
  buffer_load_dwordx4 v4, s[20:23], s42 offen offset:0 nt lds
  s_bitcmp1_b32 s81, 1
  s_waitcnt vmcnt(7)
  s_cbranch_scc0 L_w387
  s_waitcnt vmcnt(5)
  ds_write_b32 v13, v12
L_w387:
  buffer_load_dwordx4 v4, s[20:23], s42 offen offset:1024 nt lds
  s_bitcmp1_b32 s81, 2
  s_waitcnt vmcnt(7)
  s_cbranch_scc0 L_w388
  s_waitcnt vmcnt(5)
L_w388:
  buffer_load_dwordx4 v5, s[20:23], s42 offen offset:2048 nt lds
  s_bitcmp1_b32 s81, 3
  s_waitcnt vmcnt(7)
  ds_write_b32 v13, v12
  s_cbranch_scc0 L_w389
  s_waitcnt vmcnt(5)
L_w389:
  buffer_load_dwordx4 v5, s[20:23], s42 offen offset:3072 nt lds
  s_add_u32 s49, s49, 1
  s_add_u32 s41, s41, 16384
  s_cmp_ge_u32 s41, s53
  s_cselect_b32 s34, s53, 0
  s_sub_u32 s41, s41, s34
  s_sub_u32 s40, s49, s60
  s_cmp_ge_i32 s39, s40
  s_cbranch_scc1 L_go390
  s_mov_b32 s43, 1048576
L_poll390:
  ds_read_b128 v[8:11], v14 offset:0
  s_waitcnt lgkmcnt(0)
  v_min3_u32 v8, v8, v9, v10
  v_min_u32 v8, v8, v11
  s_sub_u32 s43, s43, 1
  v_readfirstlane_b32 s39, v8
  s_cbranch_scc1 L_end
  s_cmp_ge_i32 s39, s40
  s_cbranch_scc1 L_go390
  s_sleep 1
  s_branch L_poll390
L_go390:
  s_mov_b32 m0, s41
  v_add_u32 v12, 1, v12
  s_bitcmp1_b32 s81, 0
  s_waitcnt vmcnt(7)
  s_cbranch_scc0 L_w391
  s_waitcnt vmcnt(5)
L_w391:
  buffer_load_dwordx4 v6, s[24:27], s42 offen offset:0 nt lds
  s_bitcmp1_b32 s81, 1
  s_waitcnt vmcnt(7)
  s_cbranch_scc0 L_w392
  s_waitcnt vmcnt(5)
  ds_write_b32 v13, v12
L_w392:
  buffer_load_dwordx4 v7, s[24:27], s42 offen offset:1024 nt lds
  s_bitcmp1_b32 s81, 2
  s_waitcnt vmcnt(7)
  s_cbranch_scc0 L_w393
  s_waitcnt vmcnt(5)
L_w393:
  buffer_load_dwordx4 v6, s[24:27], s42 offen offset:2048 nt lds
  s_bitcmp1_b32 s81, 3
  s_waitcnt vmcnt(7)
  ds_write_b32 v13, v12
  s_cbranch_scc0 L_w394
  s_waitcnt vmcnt(5)
L_w394:
  buffer_load_dwordx4 v7, s[24:27], s42 offen offset:3072 nt lds
  s_add_u32 s42, s42, 16384
  s_add_u32 s49, s49, 1
  s_add_u32 s41, s41, 16384
  s_cmp_ge_u32 s41, s53
  s_cselect_b32 s34, s53, 0
  s_sub_u32 s41, s41, s34
  s_waitcnt vmcnt(4)
  v_add_u32 v12, 1, v12
  ds_write_b32 v13, v12
  s_sub_u32 s40, s49, s60
  s_cmp_ge_i32 s39, s40
  s_cbranch_scc1 L_go395
  s_mov_b32 s43, 1048576
L_poll395:
  ds_read_b128 v[8:11], v14 offset:0
  s_waitcnt lgkmcnt(0)
  v_min3_u32 v8, v8, v9, v10
  v_min_u32 v8, v8, v11
  s_sub_u32 s43, s43, 1
  v_readfirstlane_b32 s39, v8
  s_cbranch_scc1 L_end
  s_cmp_ge_i32 s39, s40
  s_cbranch_scc1 L_go395
  s_sleep 1
  s_branch L_poll395
L_go395:
  s_mov_b32 s62, s41
  s_add_u32 m0, s41, 0
  s_add_u32 s37, s61, 14336
  buffer_load_dwordx4 v16, s[28:31], s61 offen offset:0 lds
  buffer_load_dwordx4 v17, s[28:31], s61 offen offset:1024 lds
  buffer_load_dwordx4 v16, s[28:31], s37 offen offset:2048 lds
  buffer_load_dwordx4 v17, s[28:31], s37 offen offset:3072 lds
  s_add_u32 s61, s61, 32768
  s_add_u32 s41, s41, 16384
  s_cmp_ge_u32 s41, s53
  s_cselect_b32 s34, s53, 0
  s_sub_u32 s41, s41, s34
  s_waitcnt vmcnt(4)
  v_add_u32 v12, 1, v12
  ds_write_b32 v13, v12
  s_add_u32 s40, s40, 1
  s_cmp_ge_i32 s39, s40
  s_cbranch_scc1 L_go396
  s_mov_b32 s43, 1048576
L_poll396:
  ds_read_b128 v[8:11], v14 offset:0
  s_waitcnt lgkmcnt(0)
  v_min3_u32 v8, v8, v9, v10
  v_min_u32 v8, v8, v11
  s_sub_u32 s43, s43, 1
  v_readfirstlane_b32 s39, v8
  s_cbranch_scc1 L_end
  s_cmp_ge_i32 s39, s40
  s_cbranch_scc1 L_go396
  s_sleep 1
  s_branch L_poll396
L_go396:
  s_add_u32 m0, s41, 0
  s_add_u32 s37, s61, 14336
  buffer_load_dwordx4 v16, s[28:31], s61 offen offset:0 lds
  buffer_load_dwordx4 v17, s[28:31], s61 offen offset:1024 lds
  buffer_load_dwordx4 v16, s[28:31], s37 offen offset:2048 lds
  buffer_load_dwordx4 v17, s[28:31], s37 offen offset:3072 lds
  s_add_u32 s61, s61, 32768
  s_sub_u32 s62, s62, s52
  s_sub_u32 s63, s41, s52
  s_sub_u32 s63, s63, s62
  s_memrealtime s[94:95]
  s_waitcnt lgkmcnt(0)
  s_mul_i32 s34, s3, 16384
  s_mul_i32 s36, s33, 2048
  s_add_u32 s34, s34, s36
  v_lshl_add_u32 v4, v0, 4, s34
  s_mul_i32 s34, s3, 256
  s_lshl_b32 s36, s33, 3
  s_add_u32 s34, s34, s36
  v_mov_b32 v8, s34
  v_mov_b32 v10, s94
  v_mov_b32 v11, s95
  s_barrier
  ds_read_b128 v[24:27], v15 offset:0
  ds_read_b128 v[28:31], v15 offset:1024
  ds_read_b128 v[16:19], v15 offset:2048
  s_waitcnt lgkmcnt(2)
  v_mfma_f32_16x16x32_bf16 v[32:35], v[48:51], v[24:27], 0
  v_mfma_f32_16x16x32_bf16 v[36:39], v[52:55], v[24:27], 0
  v_mfma_f32_16x16x32_bf16 v[40:43], v[56:59], v[24:27], 0
  v_mfma_f32_16x16x32_bf16 v[44:47], v[60:63], v[24:27], 0
  ds_read_b64_tr_b16 v[48:49], v20 offset:0
  ds_read_b64_tr_b16 v[50:51], v20 offset:2048
  ds_read_b64_tr_b16 v[52:53], v21 offset:0
  ds_read_b64_tr_b16 v[54:55], v21 offset:2048
  ds_read_b64_tr_b16 v[56:57], v22 offset:0
  ds_read_b64_tr_b16 v[58:59], v22 offset:2048
  ds_read_b64_tr_b16 v[60:61], v23 offset:0
  ds_read_b64_tr_b16 v[62:63], v23 offset:2048
  ds_read_b128 v[24:27], v15 offset:3072
  s_waitcnt lgkmcnt(10)
  v_mfma_f32_16x16x32_bf16 v[32:35], v[64:67], v[28:31], v[32:35]
  v_mfma_f32_16x16x32_bf16 v[36:39], v[68:71], v[28:31], v[36:39]
  v_mfma_f32_16x16x32_bf16 v[40:43], v[72:75], v[28:31], v[40:43]
  v_mfma_f32_16x16x32_bf16 v[44:47], v[76:79], v[28:31], v[44:47]
  ds_read_b128 v[28:31], v15 offset:4096
  s_waitcnt lgkmcnt(10)
  v_mfma_f32_16x16x32_bf16 v[32:35], v[80:83], v[16:19], v[32:35]
  v_mfma_f32_16x16x32_bf16 v[36:39], v[84:87], v[16:19], v[36:39]
  v_mfma_f32_16x16x32_bf16 v[40:43], v[88:91], v[16:19], v[40:43]
  v_mfma_f32_16x16x32_bf16 v[44:47], v[92:95], v[16:19], v[44:47]
  ds_read_b128 v[16:19], v15 offset:5120
  s_waitcnt lgkmcnt(2)
  v_mfma_f32_16x16x32_bf16 v[32:35], v[96:99], v[24:27], v[32:35]
  v_mfma_f32_16x16x32_bf16 v[36:39], v[100:103], v[24:27], v[36:39]
  v_mfma_f32_16x16x32_bf16 v[40:43], v[104:107], v[24:27], v[40:43]
  v_mfma_f32_16x16x32_bf16 v[44:47], v[108:111], v[24:27], v[44:47]
  ds_read_b128 v[24:27], v15 offset:6144
  s_waitcnt lgkmcnt(2)
  v_mfma_f32_16x16x32_bf16 v[32:35], v[112:115], v[28:31], v[32:35]
  v_add_u32 v20, s62, v20
  v_add_u32 v21, s62, v21
  v_mfma_f32_16x16x32_bf16 v[36:39], v[116:119], v[28:31], v[36:39]
  v_add_u32 v22, s62, v22
  v_add_u32 v23, s62, v23
  v_mfma_f32_16x16x32_bf16 v[40:43], v[120:123], v[28:31], v[40:43]
  v_mfma_f32_16x16x32_bf16 v[44:47], v[124:127], v[28:31], v[44:47]
  ds_read_b128 v[28:31], v15 offset:7168
  s_waitcnt lgkmcnt(2)
  v_mfma_f32_16x16x32_bf16 v[32:35], v[128:131], v[16:19], v[32:35]
  v_mfma_f32_16x16x32_bf16 v[36:39], v[132:135], v[16:19], v[36:39]
  v_mfma_f32_16x16x32_bf16 v[40:43], v[136:139], v[16:19], v[40:43]
  v_mfma_f32_16x16x32_bf16 v[44:47], v[140:143], v[16:19], v[44:47]
  s_waitcnt vmcnt(4)
  ds_read_b64_tr_b16 v[64:65], v20 offset:0
  ds_read_b64_tr_b16 v[66:67], v20 offset:2048
  ds_read_b64_tr_b16 v[68:69], v21 offset:0
  ds_read_b64_tr_b16 v[70:71], v21 offset:2048
  ds_read_b64_tr_b16 v[72:73], v22 offset:0
  ds_read_b64_tr_b16 v[74:75], v22 offset:2048
  ds_read_b64_tr_b16 v[76:77], v23 offset:0
  ds_read_b64_tr_b16 v[78:79], v23 offset:2048
  ds_read_b128 v[16:19], v15 offset:8192
  s_waitcnt lgkmcnt(10)
  v_mfma_f32_16x16x32_bf16 v[32:35], v[144:147], v[24:27], v[32:35]
  v_mfma_f32_16x16x32_bf16 v[36:39], v[148:151], v[24:27], v[36:39]
  v_mfma_f32_16x16x32_bf16 v[40:43], v[152:155], v[24:27], v[40:43]
  v_mfma_f32_16x16x32_bf16 v[44:47], v[156:159], v[24:27], v[44:47]
  ds_read_b128 v[24:27], v15 offset:9216
  s_waitcnt lgkmcnt(10)
  v_mfma_f32_16x16x32_bf16 v[32:35], v[160:163], v[28:31], v[32:35]
  v_mfma_f32_16x16x32_bf16 v[36:39], v[164:167], v[28:31], v[36:39]
  v_mfma_f32_16x16x32_bf16 v[40:43], v[168:171], v[28:31], v[40:43]
  v_mfma_f32_16x16x32_bf16 v[44:47], v[172:175], v[28:31], v[44:47]
  ds_read_b128 v[28:31], v15 offset:10240
  s_waitcnt lgkmcnt(2)
  v_mfma_f32_16x16x32_bf16 v[32:35], v[176:179], v[16:19], v[32:35]
  v_add_u32 v20, s63, v20
  v_add_u32 v21, s63, v21
  v_mfma_f32_16x16x32_bf16 v[36:39], v[180:183], v[16:19], v[36:39]
  v_add_u32 v22, s63, v22
  v_add_u32 v23, s63, v23
  v_mfma_f32_16x16x32_bf16 v[40:43], v[184:187], v[16:19], v[40:43]
  v_mfma_f32_16x16x32_bf16 v[44:47], v[188:191], v[16:19], v[44:47]
  ds_read_b128 v[16:19], v15 offset:11264
  s_waitcnt lgkmcnt(2)
  v_mfma_f32_16x16x32_bf16 v[32:35], v[192:195], v[24:27], v[32:35]
  v_mfma_f32_16x16x32_bf16 v[36:39], v[196:199], v[24:27], v[36:39]
  v_mfma_f32_16x16x32_bf16 v[40:43], v[200:203], v[24:27], v[40:43]
  v_mfma_f32_16x16x32_bf16 v[44:47], v[204:207], v[24:27], v[44:47]
  s_waitcnt vmcnt(0)
  ds_read_b64_tr_b16 v[80:81], v20 offset:0
  ds_read_b64_tr_b16 v[82:83], v20 offset:2048
  ds_read_b64_tr_b16 v[84:85], v21 offset:0
  ds_read_b64_tr_b16 v[86:87], v21 offset:2048
  ds_read_b64_tr_b16 v[88:89], v22 offset:0
  ds_read_b64_tr_b16 v[90:91], v22 offset:2048
  ds_read_b64_tr_b16 v[92:93], v23 offset:0
  ds_read_b64_tr_b16 v[94:95], v23 offset:2048
  ds_read_b128 v[24:27], v15 offset:12288
  s_waitcnt lgkmcnt(10)
  v_mfma_f32_16x16x32_bf16 v[32:35], v[208:211], v[28:31], v[32:35]
  v_mfma_f32_16x16x32_bf16 v[36:39], v[212:215], v[28:31], v[36:39]
  v_mfma_f32_16x16x32_bf16 v[40:43], v[216:219], v[28:31], v[40:43]
  v_mfma_f32_16x16x32_bf16 v[44:47], v[220:223], v[28:31], v[44:47]
  ds_read_b128 v[28:31], v15 offset:13312
  s_waitcnt lgkmcnt(10)
  v_mfma_f32_16x16x32_bf16 v[32:35], v[224:227], v[16:19], v[32:35]
  v_mfma_f32_16x16x32_bf16 v[36:39], v[228:231], v[16:19], v[36:39]
  v_mfma_f32_16x16x32_bf16 v[40:43], v[232:235], v[16:19], v[40:43]
  v_mfma_f32_16x16x32_bf16 v[44:47], v[236:239], v[16:19], v[44:47]
  ds_read_b128 v[16:19], v15 offset:14336
  s_waitcnt lgkmcnt(2)
  v_mfma_f32_16x16x32_bf16 v[32:35], v[240:243], v[24:27], v[32:35]
  v_mfma_f32_16x16x32_bf16 v[36:39], v[244:247], v[24:27], v[36:39]
  v_mfma_f32_16x16x32_bf16 v[40:43], v[248:251], v[24:27], v[40:43]
  v_mfma_f32_16x16x32_bf16 v[44:47], v[252:255], v[24:27], v[44:47]
  ds_read_b128 v[24:27], v15 offset:15360
  s_waitcnt lgkmcnt(2)
  v_mfma_f32_16x16x32_bf16 v[32:35], v[48:51], v[28:31], v[32:35]
  v_mfma_f32_16x16x32_bf16 v[36:39], v[52:55], v[28:31], v[36:39]
  v_mfma_f32_16x16x32_bf16 v[40:43], v[56:59], v[28:31], v[40:43]
  v_mfma_f32_16x16x32_bf16 v[44:47], v[60:63], v[28:31], v[44:47]
  s_waitcnt lgkmcnt(1)
  v_mfma_f32_16x16x32_bf16 v[32:35], v[64:67], v[16:19], v[32:35]
  v_mfma_f32_16x16x32_bf16 v[36:39], v[68:71], v[16:19], v[36:39]
  v_mfma_f32_16x16x32_bf16 v[40:43], v[72:75], v[16:19], v[40:43]
  v_mfma_f32_16x16x32_bf16 v[44:47], v[76:79], v[16:19], v[44:47]
  s_waitcnt lgkmcnt(0)
  v_mfma_f32_16x16x32_bf16 v[32:35], v[80:83], v[24:27], v[32:35]
  v_mfma_f32_16x16x32_bf16 v[36:39], v[84:87], v[24:27], v[36:39]
  v_mfma_f32_16x16x32_bf16 v[40:43], v[88:91], v[24:27], v[40:43]
  v_mfma_f32_16x16x32_bf16 v[44:47], v[92:95], v[24:27], v[44:47]
  s_nop 4
  v_cvt_pk_bf16_f32 v112, v32, v33
  v_cvt_pk_bf16_f32 v113, v34, v35
  v_cvt_pk_bf16_f32 v114, v36, v37
  v_cvt_pk_bf16_f32 v115, v38, v39
  global_store_dwordx4 v4, v[112:115], s[54:55] offset:0 sc1
  v_cvt_pk_bf16_f32 v116, v40, v41
  v_cvt_pk_bf16_f32 v117, v42, v43
  v_cvt_pk_bf16_f32 v118, v44, v45
  v_cvt_pk_bf16_f32 v119, v46, v47
  global_store_dwordx4 v4, v[116:119], s[54:55] offset:1024 sc1
  s_mov_b64 exec, 1
  s_waitcnt vmcnt(0)
  global_store_dwordx2 v8, v[10:11], s[56:57] sc1
  s_mov_b64 exec, -1
L_end:
  s_endpgm
.section .rodata,"a"
.p2align 6
.amdhsa_kernel standalone__gqa_block_cached__sampling_kernel
  .amdhsa_next_free_vgpr 256
  .amdhsa_next_free_sgpr 100
  .amdhsa_accum_offset 256
  .amdhsa_group_segment_fixed_size 0
  .amdhsa_kernarg_size 64
  .amdhsa_user_sgpr_count 2
  .amdhsa_user_sgpr_kernarg_segment_ptr 1
  .amdhsa_system_sgpr_workgroup_id_x 1
.end_amdhsa_kernel
```
